```python
import torch

def _softmax(x, axis=-1):
    return torch.softmax(x, dim=axis)
def _gelu(x):
    return torch.nn.functional.gelu(x, approximate="tanh")
def _silu(x):
    return torch.nn.functional.silu(x)
def _sigmoid(x):
    return torch.sigmoid(x)
def _layernorm(x, axis=-1, eps=1e-5):
    m = x.mean(dim=axis, keepdim=True)
    v = x.var(dim=axis, keepdim=True, unbiased=False)
    return (x - m) / torch.sqrt(v + eps)
def _scatter_add(tgt, idx, src, axis=0):
    return tgt.clone().index_add_(axis, idx, src)
def _segment_sum(src, seg, n):
    out = torch.zeros((n,) + src.shape[1:], dtype=src.dtype)
    return out.index_add_(0, seg, src)
def _pad(x, pw):
    flat = tuple(v for pair in reversed(pw) for v in pair)
    return torch.nn.functional.pad(x, flat)

kernel_name = 'interleave_layers__sliding_local_dilated__glu_gated_glu__prompt'

def setup_inputs():

    _w = (lambda a: (lambda t: t.to(torch.bfloat16) if t.is_floating_point() else t)(torch.as_tensor(a)))
    def _A_setup():
        B, S, D = 1, 2048, 512
        return {
            "x": _w((lambda *s: torch.randn(*s, dtype=torch.bfloat16) * 0.05)(B, S, D)),
            "wqkv": _w((lambda *s: torch.randn(*s, dtype=torch.bfloat16) * 0.05)(D, 3 * D)),
            "wo": _w((lambda *s: torch.randn(*s, dtype=torch.bfloat16) * 0.05)(D, D)),
        }
    _A_in = _A_setup()

    def _B_setup():
        B, S, D, F = 1, 2048, 512, 1376
        return {
            "x": _w((lambda *s: torch.randn(*s, dtype=torch.bfloat16) * 0.05)(B, S, D)),
            "w_gate": _w((lambda *s: torch.randn(*s, dtype=torch.bfloat16) * 0.05)(D, F)),
            "w_up": _w((lambda *s: torch.randn(*s, dtype=torch.bfloat16) * 0.05)(D, F)),
            "w_down": _w((lambda *s: torch.randn(*s, dtype=torch.bfloat16) * 0.05)(F, D)),
        }
    _B_in = _B_setup()

    return {
        "A_x": _A_in["x"],
        "A_wqkv": _A_in["wqkv"],
        "A_wo": _A_in["wo"],
        "B_x": _B_in["x"],
        "B_w_gate": _B_in["w_gate"],
        "B_w_up": _B_in["w_up"],
        "B_w_down": _B_in["w_down"],
    }

def reference(A_x, A_wqkv, A_wo, B_x, B_w_gate, B_w_up, B_w_down):
    def _A_ref(x, wqkv, wo):
        B, S, D = x.shape
        H = 32; Dh = D // H
        W, dil = 8, 2
        qkv = (lambda x, *d: x.permute(*d))((x @ wqkv).reshape(B, S, 3, H, Dh), 2, 0, 3, 1, 4)
        q, k, v = qkv[0], qkv[1], qkv[2]
        scale = Dh ** -0.5
        pos = torch.arange(S)
        off = torch.arange(W) * dil
        idx = pos[:, None] - off[None, :]
        mask = idx >= 0
        idx_c = torch.where(mask, idx, 0).reshape(-1)
        kg = k[:, :, idx_c, :].reshape(B, H, S, W, Dh)
        vg = v[:, :, idx_c, :].reshape(B, H, S, W, Dh)
        logits = torch.einsum("bhsd,bhswd->bhsw", q, kg) * scale
        logits = torch.where(mask[None, None, :, :], logits, -1e9)
        attn = _softmax(logits, axis=-1)
        o = torch.einsum("bhsw,bhswd->bhsd", attn, vg)
        return (lambda x, *d: x.permute(*d))(o, 0, 2, 1, 3).reshape(B, S, D) @ wo

    def _B_ref(x, w_gate, w_up, w_down):
        g = torch.einsum("bsd,df->bsf", x, w_gate)
        u = torch.einsum("bsd,df->bsf", x, w_up)
        h = _sigmoid(g) * u
        return torch.einsum("bsf,fd->bsd", h, w_down)

    x = A_x
    x = x + _A_ref(_layernorm(x, axis=-1), A_wqkv, A_wo)
    x = x + _B_ref(_layernorm(x, axis=-1), B_w_gate, B_w_up, B_w_down)
    x = x + _A_ref(_layernorm(x, axis=-1), A_wqkv, A_wo)
    x = x + _B_ref(_layernorm(x, axis=-1), B_w_gate, B_w_up, B_w_down)
    return x
```

```asm
; @launch grid=(256,1,1) block=(256,1,1) lds=163840
.amdgcn_target "amdgcn-amd-amdhsa--gfx950"
.text
.globl interleave_layers__sliding_local_dilated__glu_gated_glu__prompt_kernel
.p2align 8
.type interleave_layers__sliding_local_dilated__glu_gated_glu__prompt_kernel,@function
interleave_layers__sliding_local_dilated__glu_gated_glu__prompt_kernel:
  s_cmp_ge_u32 s2, 256
  s_cbranch_scc1 L_exit
  s_load_dwordx16 s[44:59], s[0:1], 0
  s_load_dwordx4 s[60:63], s[0:1], 64
L_pcbase:
  s_getpc_b64 s[64:65]
  s_lshr_b32 s4, s2, 3
  s_and_b32 s4, s4, 31
  s_lshl_b32 s4, s4, 9
  v_lshrrev_b32 v2, 6, v0
  v_lshlrev_b32 v2, 2, v2
  v_and_b32 v1, 3, v0
  v_add_u32 v1, v1, v2
  v_lshlrev_b32 v1, 7, v1
  s_lshl_b32 s4, s4, 2
  v_add_u32 v1, s4, v1
  v_min_u32 v1, (L_codeend-L_pcbase-4), v1
  global_load_dword v2, v1, s[64:65]
  v_lshrrev_b32 v11, 6, v0
  v_and_b32 v1, 63, v0
  v_readfirstlane_b32 s66, v11
  v_and_b32 v3, 15, v1
  v_lshrrev_b32 v4, 4, v1
  v_lshlrev_b32 v5, 4, v1
  v_mov_b32 v10, 0
  v_mov_b32 v6, 1065369472
  v_mov_b32 v7, 1065369472
  v_mov_b32 v8, 1065369472
  v_mov_b32 v9, 1065369472
  s_getreg_b32 s67, hwreg(HW_REG_XCC_ID, 0, 4)
  s_and_b32 s4, s2, 7
  s_lshl_b32 s4, s4, 1
  s_lshr_b32 s5, s2, 7
  s_add_u32 s64, s4, s5
  s_lshr_b32 s65, s2, 3
  s_and_b32 s65, s65, 15
  s_lshr_b32 s71, s65, 3
  s_and_b32 s72, s65, 7
  s_lshr_b32 s73, s66, 1
  s_and_b32 s74, s66, 1
  s_lshl_b32 s80, s66, 10
  s_mul_i32 s81, s66, 3072
  s_lshl_b32 s82, s66, 12
  s_mov_b32 s70, 0
  s_mov_b32 s69, 0
  s_mov_b32 s75, 0
  s_lshl_b32 s76, s64, 21
  s_add_u32 s76, s76, 6291456
  s_lshl_b32 s4, s71, 2
  s_lshl_b32 s5, s73, 1
  s_add_u32 s4, s4, s5
  s_add_u32 s4, s4, s74
  s_add_u32 s77, s4, 1
  s_waitcnt lgkmcnt(0)
  s_mov_b32 s8, s44
  s_and_b32 s9, s45, 65535
  s_mov_b32 s10, 2097152
  s_mov_b32 s11, 131072
  s_mov_b32 s12, s46
  s_and_b32 s13, s47, 65535
  s_mov_b32 s14, 1572864
  s_mov_b32 s15, 131072
  s_mov_b32 s40, s60
  s_and_b32 s41, s61, 65535
  s_mov_b32 s42, 256
  s_mov_b32 s43, 131072
  s_mov_b32 s36, s62
  s_and_b32 s37, s63, 65535
  s_mov_b32 s38, 39845888
  s_mov_b32 s39, 131072
  s_mov_b32 s20, s52
  s_and_b32 s21, s53, 65535
  s_mov_b32 s22, 1409024
  s_mov_b32 s23, 131072
  s_mov_b32 s24, s54
  s_and_b32 s25, s55, 65535
  s_mov_b32 s26, 1409024
  s_mov_b32 s27, 131072
  s_mov_b32 s16, s48
  s_and_b32 s17, s49, 65535
  s_mov_b32 s18, 524288
  s_mov_b32 s19, 131072
  s_mov_b32 s28, s56
  s_and_b32 s29, s57, 65535
  s_mov_b32 s30, 1409024
  s_mov_b32 s31, 131072
  s_mov_b32 s32, s58
  s_and_b32 s33, s59, 65535
  s_mov_b32 s34, 2097152
  s_mov_b32 s35, 131072
  s_or_b32 s4, s65, s66
  s_cmp_lg_u32 s4, 0
  s_cbranch_scc1 Li_1
  s_memrealtime s[6:7]
  s_waitcnt lgkmcnt(0)
  s_or_b32 s4, s6, 1
  v_mov_b32 v11, s4
  s_lshl_b32 s5, s64, 2
  s_add_u32 s5, s5, 128
  v_mov_b32 v12, s5
  s_mov_b64 exec, 1
  buffer_store_dword v11, v12, s[40:43], 0 offen
  s_cmp_lg_u32 s2, 0
  s_cbranch_scc1 Li_2
  buffer_store_dword v11, v10, s[40:43], 0 offen sc0 sc1
Li_2:
  s_mov_b64 exec, -1
Li_1:
  s_cmp_eq_u32 s66, 3
  s_cbranch_scc1 Ls3_3
  s_lshl_b32 s4, s64, 7
  s_mul_i32 s5, s71, 5
  s_add_u32 s5, s5, s66
  s_lshl_b32 s5, s5, 4
  s_add_u32 s4, s4, s5
  s_sub_u32 s4, s4, 16
  v_add_u32 v82, s4, v3
  v_lshlrev_b32 v82, 10, v82
  v_lshlrev_b32 v66, 4, v4
  v_add_u32 v82, v82, v66
  s_lshl_b32 s4, s72, 7
  v_add_u32 v82, s4, v82
  buffer_load_dwordx4 v[66:69], v82, s[8:11], 0 offen
  buffer_load_dwordx4 v[70:73], v82, s[8:11], 0 offen offset:64
  s_add_u32 s57, s66, s71
  s_cmp_gt_u32 s57, 1
  s_cbranch_scc1 Li_5
  v_add_u32 v82, 49152, v82
  buffer_load_dwordx4 v[74:77], v82, s[8:11], 0 offen
  buffer_load_dwordx4 v[78:81], v82, s[8:11], 0 offen offset:64
Li_5:
  s_lshl_b32 s4, s64, 2
  s_add_u32 s4, s4, 128
  v_mov_b32 v103, s4
  buffer_load_dword v102, v103, s[40:43], 0 offen sc1
  buffer_load_dword v83, v10, s[40:43], 0 offen sc1
  s_mul_i32 s4, s71, 5
  s_add_u32 s4, s4, s66
  s_lshl_b32 s5, s4, 14
  s_add_u32 s61, s5, s76
  s_lshl_b32 s5, s72, 11
  s_add_u32 s61, s61, s5
  s_lshl_b32 s5, s4, 10
  s_add_u32 s62, s5, s76
  s_lshl_b32 s5, s72, 7
  s_add_u32 s62, s62, s5
  s_add_u32 s62, s62, 163840
  v_lshrrev_b32 v104, 4, v1
  v_mul_u32_u24 v104, 49152, v104
  v_lshlrev_b32 v105, 7, v3
  v_add3_u32 v104, v104, v105, s61
  v_and_b32 v105, 1, v1
  v_mul_u32_u24 v106, 3072, v105
  v_add_u32 v106, s62, v106
  v_cmp_lt_u32 vcc, 31, v1
  s_nop 1
  v_cndmask_b32 v104, v104, v106, vcc
  s_lshl_b32 s4, s64, 8
  s_add_u32 s4, s4, 28672
  v_lshlrev_b32 v106, 7, v105
  v_add_u32 v106, s4, v106
  v_cmp_lt_u32 vcc, 33, v1
  s_nop 1
  v_cndmask_b32 v104, v104, v106, vcc
  s_lshl_b32 s4, s64, 8
  s_add_u32 s4, s4, 0
  v_mov_b32 v106, s4
  v_cmp_lt_u32 vcc, 35, v1
  s_nop 1
  v_cndmask_b32 v104, v104, v106, vcc
  v_mov_b32 v106, 2147483632
  v_cmp_lt_u32 vcc, 36, v1
  s_nop 1
  v_cndmask_b32 v104, v104, v106, vcc
  buffer_load_dword v107, v104, s[36:39], 0 offen sc1
  s_cmp_lg_u32 s66, 1
  s_cbranch_scc1 Lw_7
  s_mul_i32 s4, s65, 176
  s_mul_i32 s3, s64, 88064
  v_add_u32 v108, 0, v1
  v_mul_u32_u24 v109, 5958, v108
  v_lshrrev_b32 v109, 16, v109
  v_mul_u32_u24 v110, 11, v109
  v_sub_u32 v110, v108, v110
  v_and_b32 v111, 16, v109
  v_and_b32 v108, 1, v109
  v_lshlrev_b32 v108, 3, v108
  v_add_u32 v111, v111, v108
  v_and_b32 v108, 15, v109
  v_lshrrev_b32 v108, 1, v108
  v_add_u32 v111, v111, v108
  v_mul_u32_u24 v111, 2752, v111
  v_lshlrev_b32 v110, 4, v110
  v_add_u32 v111, v111, v110
  v_add_u32 v84, s4, v111
  s_mov_b32 m0, 114688
  s_nop 0
  buffer_load_dwordx4 v84, s[20:23], s3 offen lds
  v_add_u32 v108, 64, v1
  v_mul_u32_u24 v109, 5958, v108
  v_lshrrev_b32 v109, 16, v109
  v_mul_u32_u24 v110, 11, v109
  v_sub_u32 v110, v108, v110
  v_and_b32 v111, 16, v109
  v_and_b32 v108, 1, v109
  v_lshlrev_b32 v108, 3, v108
  v_add_u32 v111, v111, v108
  v_and_b32 v108, 15, v109
  v_lshrrev_b32 v108, 1, v108
  v_add_u32 v111, v111, v108
  v_mul_u32_u24 v111, 2752, v111
  v_lshlrev_b32 v110, 4, v110
  v_add_u32 v111, v111, v110
  v_add_u32 v85, s4, v111
  s_mov_b32 m0, 115712
  s_nop 0
  buffer_load_dwordx4 v85, s[20:23], s3 offen lds
  v_add_u32 v108, 128, v1
  v_mul_u32_u24 v109, 5958, v108
  v_lshrrev_b32 v109, 16, v109
  v_mul_u32_u24 v110, 11, v109
  v_sub_u32 v110, v108, v110
  v_and_b32 v111, 16, v109
  v_and_b32 v108, 1, v109
  v_lshlrev_b32 v108, 3, v108
  v_add_u32 v111, v111, v108
  v_and_b32 v108, 15, v109
  v_lshrrev_b32 v108, 1, v108
  v_add_u32 v111, v111, v108
  v_mul_u32_u24 v111, 2752, v111
  v_lshlrev_b32 v110, 4, v110
  v_add_u32 v111, v111, v110
  v_add_u32 v86, s4, v111
  s_mov_b32 m0, 116736
  s_nop 0
  buffer_load_dwordx4 v86, s[20:23], s3 offen lds
  v_add_u32 v108, 192, v1
  v_mul_u32_u24 v109, 5958, v108
  v_lshrrev_b32 v109, 16, v109
  v_mul_u32_u24 v110, 11, v109
  v_sub_u32 v110, v108, v110
  v_and_b32 v111, 16, v109
  v_and_b32 v108, 1, v109
  v_lshlrev_b32 v108, 3, v108
  v_add_u32 v111, v111, v108
  v_and_b32 v108, 15, v109
  v_lshrrev_b32 v108, 1, v108
  v_add_u32 v111, v111, v108
  v_mul_u32_u24 v111, 2752, v111
  v_lshlrev_b32 v110, 4, v110
  v_add_u32 v111, v111, v110
  v_add_u32 v87, s4, v111
  s_mov_b32 m0, 117760
  s_nop 0
  buffer_load_dwordx4 v87, s[20:23], s3 offen lds
  v_add_u32 v108, 256, v1
  v_mul_u32_u24 v109, 5958, v108
  v_lshrrev_b32 v109, 16, v109
  v_mul_u32_u24 v110, 11, v109
  v_sub_u32 v110, v108, v110
  v_and_b32 v111, 16, v109
  v_and_b32 v108, 1, v109
  v_lshlrev_b32 v108, 3, v108
  v_add_u32 v111, v111, v108
  v_and_b32 v108, 15, v109
  v_lshrrev_b32 v108, 1, v108
  v_add_u32 v111, v111, v108
  v_mul_u32_u24 v111, 2752, v111
  v_lshlrev_b32 v110, 4, v110
  v_add_u32 v111, v111, v110
  v_add_u32 v88, s4, v111
  s_mov_b32 m0, 118784
  s_nop 0
  buffer_load_dwordx4 v88, s[20:23], s3 offen lds
  v_add_u32 v108, 320, v1
  v_mul_u32_u24 v109, 5958, v108
  v_lshrrev_b32 v109, 16, v109
  v_mul_u32_u24 v110, 11, v109
  v_sub_u32 v110, v108, v110
  v_and_b32 v111, 16, v109
  v_and_b32 v108, 1, v109
  v_lshlrev_b32 v108, 3, v108
  v_add_u32 v111, v111, v108
  v_and_b32 v108, 15, v109
  v_lshrrev_b32 v108, 1, v108
  v_add_u32 v111, v111, v108
  v_mul_u32_u24 v111, 2752, v111
  v_lshlrev_b32 v110, 4, v110
  v_add_u32 v111, v111, v110
  v_add_u32 v89, s4, v111
  v_cmp_gt_u32 vcc, 32, v1
  v_mov_b32 v108, 2147483632
  s_nop 0
  v_cndmask_b32 v89, v108, v89, vcc
  s_mov_b32 m0, 119808
  s_nop 0
  buffer_load_dwordx4 v89, s[20:23], s3 offen lds
  s_branch Lwe_6
Lw_7:
  s_cmp_lg_u32 s66, 2
  s_cbranch_scc1 Lw_8
  s_mul_i32 s4, s65, 176
  s_mul_i32 s3, s64, 88064
  v_add_u32 v108, 0, v1
  v_mul_u32_u24 v109, 5958, v108
  v_lshrrev_b32 v109, 16, v109
  v_mul_u32_u24 v110, 11, v109
  v_sub_u32 v110, v108, v110
  v_and_b32 v111, 16, v109
  v_and_b32 v108, 1, v109
  v_lshlrev_b32 v108, 3, v108
  v_add_u32 v111, v111, v108
  v_and_b32 v108, 15, v109
  v_lshrrev_b32 v108, 1, v108
  v_add_u32 v111, v111, v108
  v_mul_u32_u24 v111, 2752, v111
  v_lshlrev_b32 v110, 4, v110
  v_add_u32 v111, v111, v110
  v_add_u32 v84, s4, v111
  s_mov_b32 m0, 120832
  s_nop 0
  buffer_load_dwordx4 v84, s[24:27], s3 offen lds
  v_add_u32 v108, 64, v1
  v_mul_u32_u24 v109, 5958, v108
  v_lshrrev_b32 v109, 16, v109
  v_mul_u32_u24 v110, 11, v109
  v_sub_u32 v110, v108, v110
  v_and_b32 v111, 16, v109
  v_and_b32 v108, 1, v109
  v_lshlrev_b32 v108, 3, v108
  v_add_u32 v111, v111, v108
  v_and_b32 v108, 15, v109
  v_lshrrev_b32 v108, 1, v108
  v_add_u32 v111, v111, v108
  v_mul_u32_u24 v111, 2752, v111
  v_lshlrev_b32 v110, 4, v110
  v_add_u32 v111, v111, v110
  v_add_u32 v85, s4, v111
  s_mov_b32 m0, 121856
  s_nop 0
  buffer_load_dwordx4 v85, s[24:27], s3 offen lds
  v_add_u32 v108, 128, v1
  v_mul_u32_u24 v109, 5958, v108
  v_lshrrev_b32 v109, 16, v109
  v_mul_u32_u24 v110, 11, v109
  v_sub_u32 v110, v108, v110
  v_and_b32 v111, 16, v109
  v_and_b32 v108, 1, v109
  v_lshlrev_b32 v108, 3, v108
  v_add_u32 v111, v111, v108
  v_and_b32 v108, 15, v109
  v_lshrrev_b32 v108, 1, v108
  v_add_u32 v111, v111, v108
  v_mul_u32_u24 v111, 2752, v111
  v_lshlrev_b32 v110, 4, v110
  v_add_u32 v111, v111, v110
  v_add_u32 v86, s4, v111
  s_mov_b32 m0, 122880
  s_nop 0
  buffer_load_dwordx4 v86, s[24:27], s3 offen lds
  v_add_u32 v108, 192, v1
  v_mul_u32_u24 v109, 5958, v108
  v_lshrrev_b32 v109, 16, v109
  v_mul_u32_u24 v110, 11, v109
  v_sub_u32 v110, v108, v110
  v_and_b32 v111, 16, v109
  v_and_b32 v108, 1, v109
  v_lshlrev_b32 v108, 3, v108
  v_add_u32 v111, v111, v108
  v_and_b32 v108, 15, v109
  v_lshrrev_b32 v108, 1, v108
  v_add_u32 v111, v111, v108
  v_mul_u32_u24 v111, 2752, v111
  v_lshlrev_b32 v110, 4, v110
  v_add_u32 v111, v111, v110
  v_add_u32 v87, s4, v111
  s_mov_b32 m0, 123904
  s_nop 0
  buffer_load_dwordx4 v87, s[24:27], s3 offen lds
  v_add_u32 v108, 256, v1
  v_mul_u32_u24 v109, 5958, v108
  v_lshrrev_b32 v109, 16, v109
  v_mul_u32_u24 v110, 11, v109
  v_sub_u32 v110, v108, v110
  v_and_b32 v111, 16, v109
  v_and_b32 v108, 1, v109
  v_lshlrev_b32 v108, 3, v108
  v_add_u32 v111, v111, v108
  v_and_b32 v108, 15, v109
  v_lshrrev_b32 v108, 1, v108
  v_add_u32 v111, v111, v108
  v_mul_u32_u24 v111, 2752, v111
  v_lshlrev_b32 v110, 4, v110
  v_add_u32 v111, v111, v110
  v_add_u32 v88, s4, v111
  s_mov_b32 m0, 124928
  s_nop 0
  buffer_load_dwordx4 v88, s[24:27], s3 offen lds
  v_add_u32 v108, 320, v1
  v_mul_u32_u24 v109, 5958, v108
  v_lshrrev_b32 v109, 16, v109
  v_mul_u32_u24 v110, 11, v109
  v_sub_u32 v110, v108, v110
  v_and_b32 v111, 16, v109
  v_and_b32 v108, 1, v109
  v_lshlrev_b32 v108, 3, v108
  v_add_u32 v111, v111, v108
  v_and_b32 v108, 15, v109
  v_lshrrev_b32 v108, 1, v108
  v_add_u32 v111, v111, v108
  v_mul_u32_u24 v111, 2752, v111
  v_lshlrev_b32 v110, 4, v110
  v_add_u32 v111, v111, v110
  v_add_u32 v89, s4, v111
  v_cmp_gt_u32 vcc, 32, v1
  v_mov_b32 v108, 2147483632
  s_nop 0
  v_cndmask_b32 v89, v108, v89, vcc
  s_mov_b32 m0, 125952
  s_nop 0
  buffer_load_dwordx4 v89, s[24:27], s3 offen lds
  s_lshl_b32 s4, s65, 6
  v_add_u32 v112, 0, v1
  v_mul_u32_u24 v113, 21846, v112
  v_lshrrev_b32 v113, 18, v113
  v_mul_u32_u24 v114, 12, v113
  v_sub_u32 v114, v112, v114
  v_lshrrev_b32 v115, 2, v113
  v_and_b32 v115, 1, v115
  v_lshlrev_b32 v115, 1, v115
  v_xor_b32 v114, v114, v115
  v_mul_u32_u24 v113, 3072, v113
  v_lshrrev_b32 v115, 2, v114
  v_lshlrev_b32 v115, 10, v115
  v_add_u32 v113, v113, v115
  v_and_b32 v114, 3, v114
  v_lshlrev_b32 v114, 4, v114
  v_add_u32 v113, v113, v114
  v_add_u32 v113, s4, v113
  v_mov_b32 v16, v113
  v_add_u32 v112, 64, v1
  v_mul_u32_u24 v113, 21846, v112
  v_lshrrev_b32 v113, 18, v113
  v_mul_u32_u24 v114, 12, v113
  v_sub_u32 v114, v112, v114
  v_lshrrev_b32 v115, 2, v113
  v_and_b32 v115, 1, v115
  v_lshlrev_b32 v115, 1, v115
  v_xor_b32 v114, v114, v115
  v_mul_u32_u24 v113, 3072, v113
  v_lshrrev_b32 v115, 2, v114
  v_lshlrev_b32 v115, 10, v115
  v_add_u32 v113, v113, v115
  v_and_b32 v114, 3, v114
  v_lshlrev_b32 v114, 4, v114
  v_add_u32 v113, v113, v114
  v_add_u32 v113, s4, v113
  v_subrev_u32 v17, 1024, v113
  v_add_u32 v112, 128, v1
  v_mul_u32_u24 v113, 21846, v112
  v_lshrrev_b32 v113, 18, v113
  v_mul_u32_u24 v114, 12, v113
  v_sub_u32 v114, v112, v114
  v_lshrrev_b32 v115, 2, v113
  v_and_b32 v115, 1, v115
  v_lshlrev_b32 v115, 1, v115
  v_xor_b32 v114, v114, v115
  v_mul_u32_u24 v113, 3072, v113
  v_lshrrev_b32 v115, 2, v114
  v_lshlrev_b32 v115, 10, v115
  v_add_u32 v113, v113, v115
  v_and_b32 v114, 3, v114
  v_lshlrev_b32 v114, 4, v114
  v_add_u32 v113, v113, v114
  v_add_u32 v113, s4, v113
  v_subrev_u32 v18, 2048, v113
  s_and_b32 s4, s66, 1
  s_lshl_b32 s5, s64, 1
  s_add_u32 s4, s4, s5
  s_mul_i32 s3, s4, 49152
  buffer_load_dwordx4 v[90:93], v16, s[12:15], s3 offen
  buffer_load_dwordx4 v[94:97], v17, s[12:15], s3 offen offset:1024
  buffer_load_dwordx4 v[98:101], v18, s[12:15], s3 offen offset:2048
Lw_8:
Lwe_6:
  v_lshrrev_b32 v113, 1, v4
  v_lshlrev_b32 v113, 6, v113
  v_lshlrev_b32 v13, 2, v3
  v_add_u32 v13, v13, v113
  v_and_b32 v112, 1, v4
  v_cmp_eq_u32 vcc, 0, v112
  v_mov_b32 v113, 2147483632
  s_nop 0
  v_cndmask_b32 v14, v113, v13, vcc
  v_lshlrev_b32 v112, 7, v112
  v_add_u32 v13, v13, v112
  s_waitcnt vmcnt(4)
  v_permlane16_swap_b32 v66, v68
  v_permlane16_swap_b32 v67, v69
  s_waitcnt vmcnt(3)
  v_permlane16_swap_b32 v70, v72
  v_permlane16_swap_b32 v71, v73
  v_permlane32_swap_b32 v66, v68
  v_permlane32_swap_b32 v67, v69
  v_permlane32_swap_b32 v70, v72
  v_permlane32_swap_b32 v71, v73
  s_mul_i32 s4, s71, 5
  s_add_u32 s4, s4, s66
  s_add_u32 s4, s4, 0
  s_lshl_b32 s5, s4, 14
  s_add_u32 s61, s5, s76
  s_lshl_b32 s5, s72, 11
  s_add_u32 s61, s61, s5
  s_lshl_b32 s5, s4, 10
  s_add_u32 s62, s5, s76
  s_lshl_b32 s5, s72, 7
  s_add_u32 s62, s62, s5
  s_add_u32 s62, s62, 163840
  buffer_store_dwordx4 v[66:69], v5, s[36:39], s61 offen
  buffer_store_dwordx4 v[70:73], v5, s[36:39], s61 offen offset:1024
  v_dot2_f32_bf16 v112, v66, v6, v10
  v_dot2_f32_bf16 v113, v66, v66, v10
  v_dot2_f32_bf16 v114, v70, v6, v10
  v_dot2_f32_bf16 v115, v70, v70, v10
  v_dot2_f32_bf16 v112, v67, v6, v112
  v_dot2_f32_bf16 v113, v67, v67, v113
  v_dot2_f32_bf16 v114, v71, v6, v114
  v_dot2_f32_bf16 v115, v71, v71, v115
  v_dot2_f32_bf16 v112, v68, v6, v112
  v_dot2_f32_bf16 v113, v68, v68, v113
  v_dot2_f32_bf16 v114, v72, v6, v114
  v_dot2_f32_bf16 v115, v72, v72, v115
  v_dot2_f32_bf16 v112, v69, v6, v112
  v_dot2_f32_bf16 v113, v69, v69, v113
  v_dot2_f32_bf16 v114, v73, v6, v114
  v_dot2_f32_bf16 v115, v73, v73, v115
  s_nop 1
  v_add_f32 v112, v112, v114
  v_add_f32 v113, v113, v115
  s_nop 1
  v_permlane32_swap_b32 v112, v113
  v_add_f32 v112, v112, v113
  v_mov_b32 v113, v112
  s_nop 1
  v_permlane16_swap_b32 v112, v113
  v_add_f32 v116, v112, v113
  buffer_store_dword v116, v14, s[36:39], s62 offen
  s_cmp_gt_u32 s57, 1
  s_cbranch_scc1 Li_9
  v_permlane16_swap_b32 v74, v76
  v_permlane16_swap_b32 v75, v77
  v_permlane16_swap_b32 v78, v80
  v_permlane16_swap_b32 v79, v81
  v_permlane32_swap_b32 v74, v76
  v_permlane32_swap_b32 v75, v77
  v_permlane32_swap_b32 v78, v80
  v_permlane32_swap_b32 v79, v81
  s_mul_i32 s4, s71, 5
  s_add_u32 s4, s4, s66
  s_add_u32 s4, s4, 3
  s_lshl_b32 s5, s4, 14
  s_add_u32 s61, s5, s76
  s_lshl_b32 s5, s72, 11
  s_add_u32 s61, s61, s5
  s_lshl_b32 s5, s4, 10
  s_add_u32 s62, s5, s76
  s_lshl_b32 s5, s72, 7
  s_add_u32 s62, s62, s5
  s_add_u32 s62, s62, 163840
  buffer_store_dwordx4 v[74:77], v5, s[36:39], s61 offen
  buffer_store_dwordx4 v[78:81], v5, s[36:39], s61 offen offset:1024
  v_dot2_f32_bf16 v112, v74, v6, v10
  v_dot2_f32_bf16 v113, v74, v74, v10
  v_dot2_f32_bf16 v114, v78, v6, v10
  v_dot2_f32_bf16 v115, v78, v78, v10
  v_dot2_f32_bf16 v112, v75, v6, v112
  v_dot2_f32_bf16 v113, v75, v75, v113
  v_dot2_f32_bf16 v114, v79, v6, v114
  v_dot2_f32_bf16 v115, v79, v79, v115
  v_dot2_f32_bf16 v112, v76, v6, v112
  v_dot2_f32_bf16 v113, v76, v76, v113
  v_dot2_f32_bf16 v114, v80, v6, v114
  v_dot2_f32_bf16 v115, v80, v80, v115
  v_dot2_f32_bf16 v112, v77, v6, v112
  v_dot2_f32_bf16 v113, v77, v77, v113
  v_dot2_f32_bf16 v114, v81, v6, v114
  v_dot2_f32_bf16 v115, v81, v81, v115
  s_nop 1
  v_add_f32 v112, v112, v114
  v_add_f32 v113, v113, v115
  s_nop 1
  v_permlane32_swap_b32 v112, v113
  v_add_f32 v112, v112, v113
  v_mov_b32 v113, v112
  s_nop 1
  v_permlane16_swap_b32 v112, v113
  v_add_f32 v117, v112, v113
  buffer_store_dword v117, v14, s[36:39], s62 offen
Li_9:
  s_mov_b32 s78, 0
  s_memrealtime s[6:7]
  s_waitcnt vmcnt(5)
  v_readfirstlane_b32 s63, v102
  s_nop 3
  s_cmp_eq_u32 s63, 0
  s_cbranch_scc1 Lnonce_10
  s_waitcnt lgkmcnt(0)
  s_sub_u32 s4, s6, s63
  s_add_u32 s4, s4, 200
  s_cmp_gt_u32 s4, 1900
  s_cbranch_scc1 Lnonce_10
Lnok_11:
  s_lshl_b32 s4, s65, 2
  s_add_u32 s4, s4, s66
  s_lshl_b32 s4, s4, 2
  s_lshl_b32 s60, s64, 8
  s_add_u32 s60, s60, s4
  s_add_u32 s60, s60, 28672
  s_waitcnt vmcnt(0)
  s_cmp_eq_u32 s63, 0
  s_cbranch_scc1 Li_14
  v_mov_b32 v118, s60
  s_add_u32 s4, s63, 16
  s_add_u32 s4, s4, s67
  v_mov_b32 v119, s4
  s_mov_b64 exec, 1
  buffer_store_dword v119, v118, s[36:39], 0 offen
  s_mov_b64 exec, -1
Li_14:
  v_lshrrev_b32 v112, 3, v1
  v_lshrrev_b32 v113, 1, v112
  v_and_b32 v113, 3, v113
  v_lshlrev_b32 v113, 1, v113
  v_and_b32 v114, 7, v1
  v_xor_b32 v114, v114, v113
  v_lshlrev_b32 v114, 4, v114
  v_lshlrev_b32 v112, 10, v112
  v_add_u32 v112, v112, v114
  s_lshl_b32 s4, s72, 7
  v_add_u32 v24, s4, v112
  v_add_u32 v25, 7168, v24
  v_add_u32 v26, 14336, v24
  v_add_u32 v27, 21504, v24
  v_lshrrev_b32 v112, 2, v3
  v_and_b32 v113, 3, v1
  v_lshlrev_b32 v12, 3, v113
  v_lshlrev_b32 v11, 2, v4
  v_add_u32 v11, v11, v112
  v_mul_u32_u24 v15, 192, v11
  v_add_u32 v15, v15, v12
  v_and_b32 v113, 1, v4
  v_lshlrev_b32 v113, 5, v113
  v_add_u32 v28, v15, v113
  v_sub_u32 v30, v15, v113
  v_add_u32 v29, 49152, v28
  v_add_u32 v31, 49152, v30
  v_and_b32 v113, 1, v4
  v_lshlrev_b32 v113, 1, v113
  v_lshrrev_b32 v114, 1, v112
  v_add_u32 v113, v113, v114
  v_lshlrev_b32 v114, 7, v11
  v_add_u32 v114, v114, v12
  s_lshl_b32 s4, s74, 12
  v_add_u32 v114, s4, v114
  v_xor_b32 v115, 0, v113
  v_lshlrev_b32 v115, 5, v115
  v_add_u32 v32, v114, v115
  v_xor_b32 v115, 1, v113
  v_lshlrev_b32 v115, 5, v115
  v_add_u32 v33, v114, v115
  v_xor_b32 v115, 2, v113
  v_lshlrev_b32 v115, 5, v115
  v_add_u32 v34, v114, v115
  v_xor_b32 v115, 3, v113
  v_lshlrev_b32 v115, 5, v115
  v_add_u32 v35, v114, v115
  v_mov_b32 v114, 4048155338
  v_lshlrev_b32 v112, 2, v4
  v_add_u32 v112, 0, v112
  v_sub_u32 v113, v3, v112
  v_and_b32 v113, 2147483649, v113
  v_cmp_eq_u32 vcc, 0, v113
  s_nop 1
  v_cndmask_b32 v40, v114, v10, vcc
  v_cmp_eq_u32 vcc, 2147483648, v113
  s_nop 1
  v_cndmask_b32 v36, v114, v10, vcc
  v_lshlrev_b32 v112, 2, v4
  v_add_u32 v112, 1, v112
  v_sub_u32 v113, v3, v112
  v_and_b32 v113, 2147483649, v113
  v_cmp_eq_u32 vcc, 0, v113
  s_nop 1
  v_cndmask_b32 v41, v114, v10, vcc
  v_cmp_eq_u32 vcc, 2147483648, v113
  s_nop 1
  v_cndmask_b32 v37, v114, v10, vcc
  v_lshlrev_b32 v112, 2, v4
  v_add_u32 v112, 2, v112
  v_sub_u32 v113, v3, v112
  v_and_b32 v113, 2147483649, v113
  v_cmp_eq_u32 vcc, 0, v113
  s_nop 1
  v_cndmask_b32 v42, v114, v10, vcc
  v_cmp_eq_u32 vcc, 2147483648, v113
  s_nop 1
  v_cndmask_b32 v38, v114, v10, vcc
  v_lshlrev_b32 v112, 2, v4
  v_add_u32 v112, 3, v112
  v_sub_u32 v113, v3, v112
  v_and_b32 v113, 2147483649, v113
  v_cmp_eq_u32 vcc, 0, v113
  s_nop 1
  v_cndmask_b32 v43, v114, v10, vcc
  v_cmp_eq_u32 vcc, 2147483648, v113
  s_nop 1
  v_cndmask_b32 v39, v114, v10, vcc
  s_or_b32 s4, s64, s66
  s_cmp_eq_u32 s4, 0
  s_cselect_b64 vcc, -1, 0
  v_cndmask_b32 v44, v36, v114, vcc
  v_cndmask_b32 v45, v37, v114, vcc
  v_cndmask_b32 v46, v38, v114, vcc
  v_cndmask_b32 v47, v39, v114, vcc
  s_add_u32 s4, s66, 0
  s_mul_i32 s5, s4, 43
  s_lshr_b32 s5, s5, 7
  s_mul_i32 s3, s5, 3
  s_sub_u32 s4, s4, s3
  s_mul_i32 s5, s5, 88
  s_lshl_b32 s4, s4, 3
  s_add_u32 s4, s4, s5
  s_add_u32 s4, s4, 64
  s_lshl_b32 s44, s4, 10
  s_add_u32 s4, s66, 4
  s_mul_i32 s5, s4, 43
  s_lshr_b32 s5, s5, 7
  s_mul_i32 s3, s5, 3
  s_sub_u32 s4, s4, s3
  s_mul_i32 s5, s5, 88
  s_lshl_b32 s4, s4, 3
  s_add_u32 s4, s4, s5
  s_add_u32 s4, s4, 64
  s_lshl_b32 s45, s4, 10
  s_add_u32 s4, s66, 8
  s_mul_i32 s5, s4, 43
  s_lshr_b32 s5, s5, 7
  s_mul_i32 s3, s5, 3
  s_sub_u32 s4, s4, s3
  s_mul_i32 s5, s5, 88
  s_lshl_b32 s4, s4, 3
  s_add_u32 s4, s4, s5
  s_add_u32 s4, s4, 64
  s_lshl_b32 s46, s4, 10
  s_add_u32 s4, s66, 12
  s_mul_i32 s5, s4, 43
  s_lshr_b32 s5, s5, 7
  s_mul_i32 s3, s5, 3
  s_sub_u32 s4, s4, s3
  s_mul_i32 s5, s5, 88
  s_lshl_b32 s4, s4, 3
  s_add_u32 s4, s4, s5
  s_add_u32 s4, s4, 64
  s_lshl_b32 s47, s4, 10
  s_add_u32 s4, s66, 16
  s_mul_i32 s5, s4, 43
  s_lshr_b32 s5, s5, 7
  s_mul_i32 s3, s5, 3
  s_sub_u32 s4, s4, s3
  s_mul_i32 s5, s5, 88
  s_lshl_b32 s4, s4, 3
  s_add_u32 s4, s4, s5
  s_add_u32 s4, s4, 64
  s_lshl_b32 s48, s4, 10
  s_add_u32 s4, s66, 20
  s_mul_i32 s5, s4, 43
  s_lshr_b32 s5, s5, 7
  s_mul_i32 s3, s5, 3
  s_sub_u32 s4, s4, s3
  s_mul_i32 s5, s5, 88
  s_lshl_b32 s4, s4, 3
  s_add_u32 s4, s4, s5
  s_add_u32 s4, s4, 64
  s_lshl_b32 s49, s4, 10
  s_mul_i32 s50, s65, 180224
  s_add_u32 s50, s50, 2097152
  s_mul_i32 s51, s65, 98304
  s_add_u32 s51, s51, 524288
  s_mul_i32 s52, s66, 3
  s_min_u32 s52, s52, 8
  s_lshl_b32 s52, s52, 10
  s_add_u32 s53, s50, s52
  s_lshl_b32 s54, s73, 13
  s_lshl_b32 s4, s74, 12
  s_add_u32 s54, s54, s4
  s_lshl_b32 s4, s73, 15
  s_lshl_b32 s55, s74, 18
  s_add_u32 s55, s55, s4
  s_mul_i32 s56, s74, 720896
  s_add_u32 s56, s56, s4
  s_mov_b32 s58, 1069066811
  s_mov_b32 s59, 3216550459
  s_mul_i32 s3, s71, 22
  s_add_u32 s3, s3, 16
  s_mul_i32 s4, s72, 3
  v_lshrrev_b32 v112, 1, v4
  v_add_u32 v112, s4, v112
  v_lshrrev_b32 v113, 2, v112
  v_add_u32 v113, s3, v113
  v_lshlrev_b32 v113, 10, v113
  v_and_b32 v114, 1, v112
  v_lshlrev_b32 v114, 1, v114
  v_and_b32 v115, 1, v4
  v_add_u32 v114, v114, v115
  v_lshlrev_b32 v114, 4, v114
  v_add_u32 v114, v114, v3
  v_lshlrev_b32 v114, 4, v114
  v_add_u32 v113, v113, v114
  v_and_b32 v114, 2, v112
  v_lshlrev_b32 v114, 2, v114
  v_add_u32 v19, v113, v114
  s_add_u32 s4, s4, 2
  v_mov_b32 v112, s4
  v_lshrrev_b32 v113, 2, v112
  v_add_u32 v113, s3, v113
  v_lshlrev_b32 v113, 10, v113
  v_and_b32 v114, 1, v112
  v_lshlrev_b32 v114, 1, v114
  v_and_b32 v115, 1, v4
  v_add_u32 v114, v114, v115
  v_lshlrev_b32 v114, 4, v114
  v_add_u32 v114, v114, v3
  v_lshlrev_b32 v114, 4, v114
  v_add_u32 v113, v113, v114
  v_and_b32 v114, 2, v112
  v_lshlrev_b32 v114, 2, v114
  v_add_u32 v20, v113, v114
  v_lshrrev_b32 v112, 5, v1
  v_mul_u32_u24 v112, 45056, v112
  v_add_u32 v20, v20, v112
  v_mov_b32 v21, 2147483632
  s_lshl_b32 s85, s66, 15
  s_lshl_b32 s4, s65, 10
  s_add_u32 s85, s85, s4
  s_add_u32 s85, s85, 0
  v_subrev_u32 v112, 0, v1
  v_lshrrev_b32 v113, 3, v112
  v_lshlrev_b32 v113, 14, v113
  v_and_b32 v114, 7, v112
  v_lshlrev_b32 v114, 7, v114
  v_add3_u32 v113, v113, v114, s85
  v_cmp_gt_u32 vcc, 16, v112
  s_nop 1
  v_cndmask_b32 v21, v21, v113, vcc
  s_lshl_b32 s85, s66, 1
  s_mul_i32 s85, s85, 45056
  s_mul_i32 s4, s71, 22528
  s_add_u32 s85, s85, s4
  s_add_u32 s85, s85, 131072
  s_lshl_b32 s4, s72, 11
  s_add_u32 s86, s85, s4
  v_mov_b32 v22, 2147483632
  v_subrev_u32 v112, 0, v1
  v_lshrrev_b32 v113, 4, v112
  v_mul_u32_u24 v113, 45056, v113
  v_and_b32 v114, 15, v112
  v_lshlrev_b32 v114, 7, v114
  v_add3_u32 v113, v113, v114, s86
  v_cmp_gt_u32 vcc, 32, v112
  s_nop 1
  v_cndmask_b32 v22, v22, v113, vcc
  s_mul_i32 s83, s72, 3
  v_subrev_u32 v112, 32, v1
  v_lshrrev_b32 v113, 3, v112
  v_and_b32 v113, 1, v113
  v_lshlrev_b32 v113, 1, v113
  v_add_u32 v113, s83, v113
  v_lshrrev_b32 v113, 2, v113
  v_add_u32 v113, 16, v113
  v_lshlrev_b32 v113, 10, v113
  v_lshrrev_b32 v114, 4, v112
  v_and_b32 v114, 1, v114
  v_mul_u32_u24 v114, 45056, v114
  v_add_u32 v113, v113, v114
  v_and_b32 v114, 7, v112
  v_lshlrev_b32 v114, 7, v114
  v_add3_u32 v113, v113, v114, s85
  v_cmp_gt_u32 vcc, 32, v112
  s_nop 1
  v_cndmask_b32 v22, v22, v113, vcc
  s_lshl_b32 s4, s64, 8
  s_add_u32 s4, s4, 0
  v_and_b32 v65, 15, v1
  v_lshlrev_b32 v65, 2, v65
  v_add_u32 v65, s4, v65
  s_lshl_b32 s5, s65, 2
  s_add_u32 s4, s4, s5
  v_mov_b32 v64, s4
  s_mov_b32 s78, 0
  s_memrealtime s[6:7]
  v_readfirstlane_b32 s68, v83
  s_nop 3
  s_cmp_eq_u32 s68, 0
  s_cbranch_scc1 Lnonce_15
  s_waitcnt lgkmcnt(0)
  s_sub_u32 s4, s6, s68
  s_add_u32 s4, s4, 200
  s_cmp_gt_u32 s4, 1900
  s_cbranch_scc1 Lnonce_15
Lnok_16:
  v_mov_b32 v108, 161984
  ds_write_b32 v108, v83
  s_add_u32 s60, s60, -4096
  s_cmp_lg_u32 s66, 0
  s_cbranch_scc1 Lw_19
  v_and_b32 v108, 3, v1
  v_cmp_eq_u32 s[84:85], 3, v108
  s_lshl_b32 s4, s64, 8
  s_add_u32 s4, s4, 28672
  v_lshlrev_b32 v108, 2, v1
  v_add_u32 v108, s4, v108
  s_add_u32 s83, s68, 16
  s_add_u32 s86, s63, 16
  s_mov_b32 s78, 0
Lfp_20:
  s_add_u32 s78, s78, 1
  s_cmp_gt_u32 s78, 400000
  s_cbranch_scc1 L_exit
  s_cmp_eq_u32 s63, 0
  s_cbranch_scc1 Lfps_21
  buffer_load_dword v109, v108, s[36:39], 0 offen sc1
  s_waitcnt vmcnt(0)
  v_subrev_u32 v110, s86, v109
  v_cmp_gt_u32 vcc, 240, v110
  s_nop 3
  s_or_b64 vcc, vcc, s[84:85]
  s_cmp_eq_u64 vcc, exec
  s_cbranch_scc0 Lfps_21
  v_and_b32 v110, 15, v110
  v_cmp_eq_u32 vcc, s67, v110
  s_nop 3
  s_or_b64 vcc, vcc, s[84:85]
  s_cmp_eq_u64 vcc, exec
  s_cbranch_scc1 Lfpf_23
Lfps_21:
  s_cmp_lt_u32 s78, 12
  s_cbranch_scc1 Lfp_20
  s_mov_b32 s4, 2
  s_branch Lfpd_22
Lfpf_23:
  s_mov_b32 s4, 1
Lfpd_22:
  v_mov_b32 v109, s4
  v_mov_b32 v110, 161988
  ds_write_b32 v110, v109
Lw_19:
  s_cmp_lg_u32 s66, 2
  s_cbranch_scc1 Lw_24
  s_mul_i32 s4, s2, 5504
  v_lshlrev_b32 v108, 7, v1
  v_add_u32 v108, s4, v108
  v_cmp_gt_u32 vcc, 43, v1
  v_mov_b32 v109, 2147483632
  s_nop 0
  v_cndmask_b32 v108, v109, v108, vcc
  buffer_load_dword v23, v108, s[28:31], 0 offen
  s_lshl_b32 s4, s2, 11
  v_lshlrev_b32 v108, 7, v1
  v_add_u32 v108, s4, v108
  v_cmp_gt_u32 vcc, 16, v1
  s_nop 1
  v_cndmask_b32 v108, v109, v108, vcc
  s_waitcnt vmcnt(0)
  buffer_load_dword v23, v108, s[16:19], 0 offen
Lw_24:
  s_branch Lse_4
Ls3_3:
  s_lshl_b32 s4, s65, 6
  v_add_u32 v108, 0, v1
  v_mul_u32_u24 v109, 21846, v108
  v_lshrrev_b32 v109, 18, v109
  v_mul_u32_u24 v110, 12, v109
  v_sub_u32 v110, v108, v110
  v_lshrrev_b32 v111, 2, v109
  v_and_b32 v111, 1, v111
  v_lshlrev_b32 v111, 1, v111
  v_xor_b32 v110, v110, v111
  v_mul_u32_u24 v109, 3072, v109
  v_lshrrev_b32 v111, 2, v110
  v_lshlrev_b32 v111, 10, v111
  v_add_u32 v109, v109, v111
  v_and_b32 v110, 3, v110
  v_lshlrev_b32 v110, 4, v110
  v_add_u32 v109, v109, v110
  v_add_u32 v109, s4, v109
  v_mov_b32 v16, v109
  v_add_u32 v108, 64, v1
  v_mul_u32_u24 v109, 21846, v108
  v_lshrrev_b32 v109, 18, v109
  v_mul_u32_u24 v110, 12, v109
  v_sub_u32 v110, v108, v110
  v_lshrrev_b32 v111, 2, v109
  v_and_b32 v111, 1, v111
  v_lshlrev_b32 v111, 1, v111
  v_xor_b32 v110, v110, v111
  v_mul_u32_u24 v109, 3072, v109
  v_lshrrev_b32 v111, 2, v110
  v_lshlrev_b32 v111, 10, v111
  v_add_u32 v109, v109, v111
  v_and_b32 v110, 3, v110
  v_lshlrev_b32 v110, 4, v110
  v_add_u32 v109, v109, v110
  v_add_u32 v109, s4, v109
  v_subrev_u32 v17, 1024, v109
  v_add_u32 v108, 128, v1
  v_mul_u32_u24 v109, 21846, v108
  v_lshrrev_b32 v109, 18, v109
  v_mul_u32_u24 v110, 12, v109
  v_sub_u32 v110, v108, v110
  v_lshrrev_b32 v111, 2, v109
  v_and_b32 v111, 1, v111
  v_lshlrev_b32 v111, 1, v111
  v_xor_b32 v110, v110, v111
  v_mul_u32_u24 v109, 3072, v109
  v_lshrrev_b32 v111, 2, v110
  v_lshlrev_b32 v111, 10, v111
  v_add_u32 v109, v109, v111
  v_and_b32 v110, 3, v110
  v_lshlrev_b32 v110, 4, v110
  v_add_u32 v109, v109, v110
  v_add_u32 v109, s4, v109
  v_subrev_u32 v18, 2048, v109
  s_and_b32 s83, s65, 1
  s_and_b32 s4, s64, 1
  s_lshl_b32 s4, s4, 1
  s_add_u32 s83, s83, s4
  s_lshl_b32 s83, s83, 3
  s_add_u32 s84, s83, 0
  s_and_b32 s84, s84, 31
  s_mul_i32 m0, s84, 3072
  s_mul_i32 s79, s84, 49152
  buffer_load_dwordx4 v16, s[12:15], s79 offen lds
  v_lshrrev_b32 v109, 1, v4
  v_lshlrev_b32 v109, 6, v109
  buffer_load_dwordx4 v17, s[12:15], s79 offen offset:1024 lds
  v_lshlrev_b32 v13, 2, v3
  v_add_u32 v13, v13, v109
  buffer_load_dwordx4 v18, s[12:15], s79 offen offset:2048 lds
  v_and_b32 v108, 1, v4
  v_cmp_eq_u32 vcc, 0, v108
  s_add_u32 s84, s83, 1
  s_and_b32 s84, s84, 31
  s_mul_i32 m0, s84, 3072
  s_mul_i32 s79, s84, 49152
  buffer_load_dwordx4 v16, s[12:15], s79 offen lds
  v_mov_b32 v109, 2147483632
  v_cndmask_b32 v14, v109, v13, vcc
  buffer_load_dwordx4 v17, s[12:15], s79 offen offset:1024 lds
  v_lshlrev_b32 v108, 7, v108
  v_add_u32 v13, v13, v108
  buffer_load_dwordx4 v18, s[12:15], s79 offen offset:2048 lds
  v_lshrrev_b32 v108, 3, v1
  v_lshrrev_b32 v109, 1, v108
  s_add_u32 s84, s83, 2
  s_and_b32 s84, s84, 31
  s_mul_i32 m0, s84, 3072
  s_mul_i32 s79, s84, 49152
  buffer_load_dwordx4 v16, s[12:15], s79 offen lds
  v_and_b32 v109, 3, v109
  v_lshlrev_b32 v109, 1, v109
  buffer_load_dwordx4 v17, s[12:15], s79 offen offset:1024 lds
  v_and_b32 v110, 7, v1
  v_xor_b32 v110, v110, v109
  buffer_load_dwordx4 v18, s[12:15], s79 offen offset:2048 lds
  v_lshlrev_b32 v110, 4, v110
  v_lshlrev_b32 v108, 10, v108
  s_add_u32 s84, s83, 3
  s_and_b32 s84, s84, 31
  s_mul_i32 m0, s84, 3072
  s_mul_i32 s79, s84, 49152
  buffer_load_dwordx4 v16, s[12:15], s79 offen lds
  v_add_u32 v108, v108, v110
  s_lshl_b32 s4, s72, 7
  buffer_load_dwordx4 v17, s[12:15], s79 offen offset:1024 lds
  v_add_u32 v24, s4, v108
  v_add_u32 v25, 7168, v24
  buffer_load_dwordx4 v18, s[12:15], s79 offen offset:2048 lds
  v_add_u32 v26, 14336, v24
  v_add_u32 v27, 21504, v24
  s_add_u32 s84, s83, 4
  s_and_b32 s84, s84, 31
  s_mul_i32 m0, s84, 3072
  s_mul_i32 s79, s84, 49152
  buffer_load_dwordx4 v16, s[12:15], s79 offen lds
  v_lshrrev_b32 v108, 2, v3
  v_and_b32 v109, 3, v1
  buffer_load_dwordx4 v17, s[12:15], s79 offen offset:1024 lds
  v_lshlrev_b32 v12, 3, v109
  v_lshlrev_b32 v11, 2, v4
  buffer_load_dwordx4 v18, s[12:15], s79 offen offset:2048 lds
  v_add_u32 v11, v11, v108
  v_mul_u32_u24 v15, 192, v11
  s_add_u32 s84, s83, 5
  s_and_b32 s84, s84, 31
  s_mul_i32 m0, s84, 3072
  s_mul_i32 s79, s84, 49152
  buffer_load_dwordx4 v16, s[12:15], s79 offen lds
  v_add_u32 v15, v15, v12
  v_and_b32 v109, 1, v4
  buffer_load_dwordx4 v17, s[12:15], s79 offen offset:1024 lds
  v_lshlrev_b32 v109, 5, v109
  v_add_u32 v28, v15, v109
  buffer_load_dwordx4 v18, s[12:15], s79 offen offset:2048 lds
  v_sub_u32 v30, v15, v109
  v_add_u32 v29, 49152, v28
  s_add_u32 s84, s83, 6
  s_and_b32 s84, s84, 31
  s_mul_i32 m0, s84, 3072
  s_mul_i32 s79, s84, 49152
  buffer_load_dwordx4 v16, s[12:15], s79 offen lds
  v_add_u32 v31, 49152, v30
  v_and_b32 v109, 1, v4
  buffer_load_dwordx4 v17, s[12:15], s79 offen offset:1024 lds
  v_lshlrev_b32 v109, 1, v109
  v_lshrrev_b32 v110, 1, v108
  buffer_load_dwordx4 v18, s[12:15], s79 offen offset:2048 lds
  v_add_u32 v109, v109, v110
  v_lshlrev_b32 v110, 7, v11
  s_add_u32 s84, s83, 7
  s_and_b32 s84, s84, 31
  s_mul_i32 m0, s84, 3072
  s_mul_i32 s79, s84, 49152
  buffer_load_dwordx4 v16, s[12:15], s79 offen lds
  v_add_u32 v110, v110, v12
  s_lshl_b32 s4, s74, 12
  buffer_load_dwordx4 v17, s[12:15], s79 offen offset:1024 lds
  v_add_u32 v110, s4, v110
  v_xor_b32 v111, 0, v109
  buffer_load_dwordx4 v18, s[12:15], s79 offen offset:2048 lds
  v_lshlrev_b32 v111, 5, v111
  v_add_u32 v32, v110, v111
  s_add_u32 s84, s83, 8
  s_and_b32 s84, s84, 31
  s_mul_i32 m0, s84, 3072
  s_mul_i32 s79, s84, 49152
  buffer_load_dwordx4 v16, s[12:15], s79 offen lds
  v_xor_b32 v111, 1, v109
  v_lshlrev_b32 v111, 5, v111
  buffer_load_dwordx4 v17, s[12:15], s79 offen offset:1024 lds
  v_add_u32 v33, v110, v111
  v_xor_b32 v111, 2, v109
  buffer_load_dwordx4 v18, s[12:15], s79 offen offset:2048 lds
  v_lshlrev_b32 v111, 5, v111
  v_add_u32 v34, v110, v111
  s_add_u32 s84, s83, 9
  s_and_b32 s84, s84, 31
  s_mul_i32 m0, s84, 3072
  s_mul_i32 s79, s84, 49152
  buffer_load_dwordx4 v16, s[12:15], s79 offen lds
  v_xor_b32 v111, 3, v109
  v_lshlrev_b32 v111, 5, v111
  buffer_load_dwordx4 v17, s[12:15], s79 offen offset:1024 lds
  v_add_u32 v35, v110, v111
  v_mov_b32 v110, 4048155338
  buffer_load_dwordx4 v18, s[12:15], s79 offen offset:2048 lds
  v_lshlrev_b32 v108, 2, v4
  v_add_u32 v108, 0, v108
  s_add_u32 s84, s83, 10
  s_and_b32 s84, s84, 31
  s_mul_i32 m0, s84, 3072
  s_mul_i32 s79, s84, 49152
  buffer_load_dwordx4 v16, s[12:15], s79 offen lds
  v_sub_u32 v109, v3, v108
  v_and_b32 v109, 2147483649, v109
  buffer_load_dwordx4 v17, s[12:15], s79 offen offset:1024 lds
  v_cmp_eq_u32 vcc, 0, v109
  s_nop 1
  v_cndmask_b32 v40, v110, v10, vcc
  buffer_load_dwordx4 v18, s[12:15], s79 offen offset:2048 lds
  v_cmp_eq_u32 vcc, 2147483648, v109
  s_nop 1
  v_cndmask_b32 v36, v110, v10, vcc
  s_add_u32 s84, s83, 11
  s_and_b32 s84, s84, 31
  s_mul_i32 m0, s84, 3072
  s_mul_i32 s79, s84, 49152
  buffer_load_dwordx4 v16, s[12:15], s79 offen lds
  v_lshlrev_b32 v108, 2, v4
  v_add_u32 v108, 1, v108
  buffer_load_dwordx4 v17, s[12:15], s79 offen offset:1024 lds
  v_sub_u32 v109, v3, v108
  v_and_b32 v109, 2147483649, v109
  buffer_load_dwordx4 v18, s[12:15], s79 offen offset:2048 lds
  v_cmp_eq_u32 vcc, 0, v109
  s_nop 1
  v_cndmask_b32 v41, v110, v10, vcc
  s_add_u32 s84, s83, 12
  s_and_b32 s84, s84, 31
  s_mul_i32 m0, s84, 3072
  s_mul_i32 s79, s84, 49152
  buffer_load_dwordx4 v16, s[12:15], s79 offen lds
  v_cmp_eq_u32 vcc, 2147483648, v109
  s_nop 1
  v_cndmask_b32 v37, v110, v10, vcc
  buffer_load_dwordx4 v17, s[12:15], s79 offen offset:1024 lds
  v_lshlrev_b32 v108, 2, v4
  v_add_u32 v108, 2, v108
  buffer_load_dwordx4 v18, s[12:15], s79 offen offset:2048 lds
  v_sub_u32 v109, v3, v108
  v_and_b32 v109, 2147483649, v109
  s_add_u32 s84, s83, 13
  s_and_b32 s84, s84, 31
  s_mul_i32 m0, s84, 3072
  s_mul_i32 s79, s84, 49152
  buffer_load_dwordx4 v16, s[12:15], s79 offen lds
  v_cmp_eq_u32 vcc, 0, v109
  s_nop 1
  v_cndmask_b32 v42, v110, v10, vcc
  buffer_load_dwordx4 v17, s[12:15], s79 offen offset:1024 lds
  v_cmp_eq_u32 vcc, 2147483648, v109
  s_nop 1
  v_cndmask_b32 v38, v110, v10, vcc
  buffer_load_dwordx4 v18, s[12:15], s79 offen offset:2048 lds
  v_lshlrev_b32 v108, 2, v4
  v_add_u32 v108, 3, v108
  s_add_u32 s84, s83, 14
  s_and_b32 s84, s84, 31
  s_mul_i32 m0, s84, 3072
  s_mul_i32 s79, s84, 49152
  buffer_load_dwordx4 v16, s[12:15], s79 offen lds
  v_sub_u32 v109, v3, v108
  v_and_b32 v109, 2147483649, v109
  buffer_load_dwordx4 v17, s[12:15], s79 offen offset:1024 lds
  v_cmp_eq_u32 vcc, 0, v109
  s_nop 1
  v_cndmask_b32 v43, v110, v10, vcc
  buffer_load_dwordx4 v18, s[12:15], s79 offen offset:2048 lds
  v_cmp_eq_u32 vcc, 2147483648, v109
  s_nop 1
  v_cndmask_b32 v39, v110, v10, vcc
  s_add_u32 s84, s83, 15
  s_and_b32 s84, s84, 31
  s_mul_i32 m0, s84, 3072
  s_mul_i32 s79, s84, 49152
  buffer_load_dwordx4 v16, s[12:15], s79 offen lds
  s_or_b32 s4, s64, s66
  s_cmp_eq_u32 s4, 0
  s_cselect_b64 vcc, -1, 0
  buffer_load_dwordx4 v17, s[12:15], s79 offen offset:1024 lds
  v_cndmask_b32 v44, v36, v110, vcc
  v_cndmask_b32 v45, v37, v110, vcc
  buffer_load_dwordx4 v18, s[12:15], s79 offen offset:2048 lds
  v_cndmask_b32 v46, v38, v110, vcc
  v_cndmask_b32 v47, v39, v110, vcc
  s_add_u32 s84, s83, 16
  s_and_b32 s84, s84, 31
  s_mul_i32 m0, s84, 3072
  s_mul_i32 s79, s84, 49152
  buffer_load_dwordx4 v16, s[12:15], s79 offen lds
  s_add_u32 s4, s66, 0
  s_mul_i32 s5, s4, 43
  buffer_load_dwordx4 v17, s[12:15], s79 offen offset:1024 lds
  s_lshr_b32 s5, s5, 7
  s_mul_i32 s3, s5, 3
  buffer_load_dwordx4 v18, s[12:15], s79 offen offset:2048 lds
  s_sub_u32 s4, s4, s3
  s_mul_i32 s5, s5, 88
  s_add_u32 s84, s83, 17
  s_and_b32 s84, s84, 31
  s_mul_i32 m0, s84, 3072
  s_mul_i32 s79, s84, 49152
  buffer_load_dwordx4 v16, s[12:15], s79 offen lds
  s_lshl_b32 s4, s4, 3
  s_add_u32 s4, s4, s5
  buffer_load_dwordx4 v17, s[12:15], s79 offen offset:1024 lds
  s_add_u32 s4, s4, 64
  s_lshl_b32 s44, s4, 10
  buffer_load_dwordx4 v18, s[12:15], s79 offen offset:2048 lds
  s_add_u32 s4, s66, 4
  s_mul_i32 s5, s4, 43
  s_add_u32 s84, s83, 18
  s_and_b32 s84, s84, 31
  s_mul_i32 m0, s84, 3072
  s_mul_i32 s79, s84, 49152
  buffer_load_dwordx4 v16, s[12:15], s79 offen lds
  s_lshr_b32 s5, s5, 7
  s_mul_i32 s3, s5, 3
  buffer_load_dwordx4 v17, s[12:15], s79 offen offset:1024 lds
  s_sub_u32 s4, s4, s3
  s_mul_i32 s5, s5, 88
  buffer_load_dwordx4 v18, s[12:15], s79 offen offset:2048 lds
  s_lshl_b32 s4, s4, 3
  s_add_u32 s4, s4, s5
  s_add_u32 s84, s83, 19
  s_and_b32 s84, s84, 31
  s_mul_i32 m0, s84, 3072
  s_mul_i32 s79, s84, 49152
  buffer_load_dwordx4 v16, s[12:15], s79 offen lds
  s_add_u32 s4, s4, 64
  s_lshl_b32 s45, s4, 10
  buffer_load_dwordx4 v17, s[12:15], s79 offen offset:1024 lds
  s_add_u32 s4, s66, 8
  s_mul_i32 s5, s4, 43
  buffer_load_dwordx4 v18, s[12:15], s79 offen offset:2048 lds
  s_lshr_b32 s5, s5, 7
  s_mul_i32 s3, s5, 3
  s_add_u32 s84, s83, 20
  s_and_b32 s84, s84, 31
  s_mul_i32 m0, s84, 3072
  s_mul_i32 s79, s84, 49152
  buffer_load_dwordx4 v16, s[12:15], s79 offen lds
  s_sub_u32 s4, s4, s3
  s_mul_i32 s5, s5, 88
  buffer_load_dwordx4 v17, s[12:15], s79 offen offset:1024 lds
  s_lshl_b32 s4, s4, 3
  s_add_u32 s4, s4, s5
  buffer_load_dwordx4 v18, s[12:15], s79 offen offset:2048 lds
  s_add_u32 s4, s4, 64
  s_lshl_b32 s46, s4, 10
  s_add_u32 s84, s83, 21
  s_and_b32 s84, s84, 31
  s_mul_i32 m0, s84, 3072
  s_mul_i32 s79, s84, 49152
  buffer_load_dwordx4 v16, s[12:15], s79 offen lds
  s_add_u32 s4, s66, 12
  s_mul_i32 s5, s4, 43
  buffer_load_dwordx4 v17, s[12:15], s79 offen offset:1024 lds
  s_lshr_b32 s5, s5, 7
  s_mul_i32 s3, s5, 3
  buffer_load_dwordx4 v18, s[12:15], s79 offen offset:2048 lds
  s_sub_u32 s4, s4, s3
  s_mul_i32 s5, s5, 88
  s_add_u32 s84, s83, 22
  s_and_b32 s84, s84, 31
  s_mul_i32 m0, s84, 3072
  s_mul_i32 s79, s84, 49152
  buffer_load_dwordx4 v16, s[12:15], s79 offen lds
  s_lshl_b32 s4, s4, 3
  s_add_u32 s4, s4, s5
  buffer_load_dwordx4 v17, s[12:15], s79 offen offset:1024 lds
  s_add_u32 s4, s4, 64
  s_lshl_b32 s47, s4, 10
  buffer_load_dwordx4 v18, s[12:15], s79 offen offset:2048 lds
  s_add_u32 s4, s66, 16
  s_mul_i32 s5, s4, 43
  s_add_u32 s84, s83, 23
  s_and_b32 s84, s84, 31
  s_mul_i32 m0, s84, 3072
  s_mul_i32 s79, s84, 49152
  buffer_load_dwordx4 v16, s[12:15], s79 offen lds
  s_lshr_b32 s5, s5, 7
  s_mul_i32 s3, s5, 3
  buffer_load_dwordx4 v17, s[12:15], s79 offen offset:1024 lds
  s_sub_u32 s4, s4, s3
  s_mul_i32 s5, s5, 88
  buffer_load_dwordx4 v18, s[12:15], s79 offen offset:2048 lds
  s_lshl_b32 s4, s4, 3
  s_add_u32 s4, s4, s5
  s_add_u32 s84, s83, 24
  s_and_b32 s84, s84, 31
  s_mul_i32 m0, s84, 3072
  s_mul_i32 s79, s84, 49152
  buffer_load_dwordx4 v16, s[12:15], s79 offen lds
  s_add_u32 s4, s4, 64
  s_lshl_b32 s48, s4, 10
  buffer_load_dwordx4 v17, s[12:15], s79 offen offset:1024 lds
  s_add_u32 s4, s66, 20
  s_mul_i32 s5, s4, 43
  buffer_load_dwordx4 v18, s[12:15], s79 offen offset:2048 lds
  s_lshr_b32 s5, s5, 7
  s_mul_i32 s3, s5, 3
  s_add_u32 s84, s83, 25
  s_and_b32 s84, s84, 31
  s_mul_i32 m0, s84, 3072
  s_mul_i32 s79, s84, 49152
  buffer_load_dwordx4 v16, s[12:15], s79 offen lds
  s_sub_u32 s4, s4, s3
  s_mul_i32 s5, s5, 88
  buffer_load_dwordx4 v17, s[12:15], s79 offen offset:1024 lds
  s_lshl_b32 s4, s4, 3
  s_add_u32 s4, s4, s5
  buffer_load_dwordx4 v18, s[12:15], s79 offen offset:2048 lds
  s_add_u32 s4, s4, 64
  s_lshl_b32 s49, s4, 10
  s_add_u32 s84, s83, 26
  s_and_b32 s84, s84, 31
  s_mul_i32 m0, s84, 3072
  s_mul_i32 s79, s84, 49152
  buffer_load_dwordx4 v16, s[12:15], s79 offen lds
  s_mul_i32 s50, s65, 180224
  s_add_u32 s50, s50, 2097152
  buffer_load_dwordx4 v17, s[12:15], s79 offen offset:1024 lds
  s_mul_i32 s51, s65, 98304
  s_add_u32 s51, s51, 524288
  buffer_load_dwordx4 v18, s[12:15], s79 offen offset:2048 lds
  s_mul_i32 s52, s66, 3
  s_min_u32 s52, s52, 8
  s_add_u32 s84, s83, 27
  s_and_b32 s84, s84, 31
  s_mul_i32 m0, s84, 3072
  s_mul_i32 s79, s84, 49152
  buffer_load_dwordx4 v16, s[12:15], s79 offen lds
  s_lshl_b32 s52, s52, 10
  s_add_u32 s53, s50, s52
  buffer_load_dwordx4 v17, s[12:15], s79 offen offset:1024 lds
  s_lshl_b32 s54, s73, 13
  s_lshl_b32 s4, s74, 12
  buffer_load_dwordx4 v18, s[12:15], s79 offen offset:2048 lds
  s_add_u32 s54, s54, s4
  s_lshl_b32 s4, s73, 15
  s_add_u32 s84, s83, 28
  s_and_b32 s84, s84, 31
  s_mul_i32 m0, s84, 3072
  s_mul_i32 s79, s84, 49152
  buffer_load_dwordx4 v16, s[12:15], s79 offen lds
  s_lshl_b32 s55, s74, 18
  s_add_u32 s55, s55, s4
  buffer_load_dwordx4 v17, s[12:15], s79 offen offset:1024 lds
  s_mul_i32 s56, s74, 720896
  s_add_u32 s56, s56, s4
  buffer_load_dwordx4 v18, s[12:15], s79 offen offset:2048 lds
  s_mov_b32 s58, 1069066811
  s_mov_b32 s59, 3216550459
  s_add_u32 s84, s83, 29
  s_and_b32 s84, s84, 31
  s_mul_i32 m0, s84, 3072
  s_mul_i32 s79, s84, 49152
  buffer_load_dwordx4 v16, s[12:15], s79 offen lds
  s_mul_i32 s3, s71, 22
  s_add_u32 s3, s3, 16
  buffer_load_dwordx4 v17, s[12:15], s79 offen offset:1024 lds
  s_mul_i32 s4, s72, 3
  v_lshrrev_b32 v108, 1, v4
  buffer_load_dwordx4 v18, s[12:15], s79 offen offset:2048 lds
  v_add_u32 v108, s4, v108
  v_lshrrev_b32 v109, 2, v108
  s_add_u32 s84, s83, 30
  s_and_b32 s84, s84, 31
  s_mul_i32 m0, s84, 3072
  s_mul_i32 s79, s84, 49152
  buffer_load_dwordx4 v16, s[12:15], s79 offen lds
  v_add_u32 v109, s3, v109
  v_lshlrev_b32 v109, 10, v109
  buffer_load_dwordx4 v17, s[12:15], s79 offen offset:1024 lds
  v_and_b32 v110, 1, v108
  v_lshlrev_b32 v110, 1, v110
  buffer_load_dwordx4 v18, s[12:15], s79 offen offset:2048 lds
  v_and_b32 v111, 1, v4
  v_add_u32 v110, v110, v111
  s_add_u32 s84, s83, 31
  s_and_b32 s84, s84, 31
  s_mul_i32 m0, s84, 3072
  s_mul_i32 s79, s84, 49152
  buffer_load_dwordx4 v16, s[12:15], s79 offen lds
  v_lshlrev_b32 v110, 4, v110
  v_add_u32 v110, v110, v3
  buffer_load_dwordx4 v17, s[12:15], s79 offen offset:1024 lds
  v_lshlrev_b32 v110, 4, v110
  v_add_u32 v109, v109, v110
  buffer_load_dwordx4 v18, s[12:15], s79 offen offset:2048 lds
  v_and_b32 v110, 2, v108
  v_lshlrev_b32 v110, 2, v110
  v_add_u32 v19, v109, v110
  s_add_u32 s4, s4, 2
  v_mov_b32 v108, s4
  v_lshrrev_b32 v109, 2, v108
  v_add_u32 v109, s3, v109
  v_lshlrev_b32 v109, 10, v109
  v_and_b32 v110, 1, v108
  v_lshlrev_b32 v110, 1, v110
  v_and_b32 v111, 1, v4
  v_add_u32 v110, v110, v111
  v_lshlrev_b32 v110, 4, v110
  v_add_u32 v110, v110, v3
  v_lshlrev_b32 v110, 4, v110
  v_add_u32 v109, v109, v110
  v_and_b32 v110, 2, v108
  v_lshlrev_b32 v110, 2, v110
  v_add_u32 v20, v109, v110
  v_lshrrev_b32 v108, 5, v1
  v_mul_u32_u24 v108, 45056, v108
  v_add_u32 v20, v20, v108
  v_mov_b32 v21, 2147483632
  s_lshl_b32 s87, s66, 15
  s_lshl_b32 s4, s65, 10
  s_add_u32 s87, s87, s4
  s_add_u32 s87, s87, 0
  v_subrev_u32 v108, 0, v1
  v_lshrrev_b32 v109, 3, v108
  v_lshlrev_b32 v109, 14, v109
  v_and_b32 v110, 7, v108
  v_lshlrev_b32 v110, 7, v110
  v_add3_u32 v109, v109, v110, s87
  v_cmp_gt_u32 vcc, 16, v108
  s_nop 1
  v_cndmask_b32 v21, v21, v109, vcc
  s_lshl_b32 s87, s66, 1
  s_mul_i32 s87, s87, 45056
  s_mul_i32 s4, s71, 22528
  s_add_u32 s87, s87, s4
  s_add_u32 s87, s87, 131072
  s_lshl_b32 s4, s72, 11
  s_add_u32 s88, s87, s4
  v_mov_b32 v22, 2147483632
  v_subrev_u32 v108, 0, v1
  v_lshrrev_b32 v109, 4, v108
  v_mul_u32_u24 v109, 45056, v109
  v_and_b32 v110, 15, v108
  v_lshlrev_b32 v110, 7, v110
  v_add3_u32 v109, v109, v110, s88
  v_cmp_gt_u32 vcc, 32, v108
  s_nop 1
  v_cndmask_b32 v22, v22, v109, vcc
  s_mul_i32 s85, s72, 3
  v_subrev_u32 v108, 32, v1
  v_lshrrev_b32 v109, 3, v108
  v_and_b32 v109, 1, v109
  v_lshlrev_b32 v109, 1, v109
  v_add_u32 v109, s85, v109
  v_lshrrev_b32 v109, 2, v109
  v_add_u32 v109, 16, v109
  v_lshlrev_b32 v109, 10, v109
  v_lshrrev_b32 v110, 4, v108
  v_and_b32 v110, 1, v110
  v_mul_u32_u24 v110, 45056, v110
  v_add_u32 v109, v109, v110
  v_and_b32 v110, 7, v108
  v_lshlrev_b32 v110, 7, v110
  v_add3_u32 v109, v109, v110, s87
  v_cmp_gt_u32 vcc, 32, v108
  s_nop 1
  v_cndmask_b32 v22, v22, v109, vcc
  s_lshl_b32 s4, s64, 8
  s_add_u32 s4, s4, 0
  v_and_b32 v65, 15, v1
  v_lshlrev_b32 v65, 2, v65
  v_add_u32 v65, s4, v65
  s_lshl_b32 s5, s65, 2
  s_add_u32 s4, s4, s5
  v_mov_b32 v64, s4
  s_and_b32 s4, s66, 1
  s_lshl_b32 s5, s64, 1
  s_add_u32 s4, s4, s5
  s_mul_i32 s3, s4, 49152
  buffer_load_dwordx4 v[90:93], v16, s[12:15], s3 offen
  buffer_load_dwordx4 v[94:97], v17, s[12:15], s3 offen offset:1024
  buffer_load_dwordx4 v[98:101], v18, s[12:15], s3 offen offset:2048
Lse_4:
  s_waitcnt vmcnt(3) lgkmcnt(0)
  s_barrier
  v_mov_b32 v108, 161984
  ds_read_b64 v[108:109], v108
  s_waitcnt lgkmcnt(0)
  v_readfirstlane_b32 s68, v108
  v_readfirstlane_b32 s69, v109
  s_nop 3
  s_cmp_lg_u32 s69, 2
  s_cbranch_scc1 Li_25
  s_waitcnt lgkmcnt(0)
  s_barrier
  s_cmp_eq_u32 s66, 3
  s_cbranch_scc1 Lw_26
  s_mul_i32 s4, s71, 5
  s_add_u32 s4, s4, s66
  s_add_u32 s4, s4, 0
  s_lshl_b32 s5, s4, 14
  s_add_u32 s61, s5, s76
  s_lshl_b32 s5, s72, 11
  s_add_u32 s61, s61, s5
  s_add_u32 s61, s61, 1179648
  s_lshl_b32 s5, s4, 10
  s_add_u32 s62, s5, s76
  s_lshl_b32 s5, s72, 7
  s_add_u32 s62, s62, s5
  s_add_u32 s62, s62, 1343488
  buffer_store_dwordx4 v[66:69], v5, s[36:39], s61 offen sc0 sc1
  buffer_store_dwordx4 v[70:73], v5, s[36:39], s61 offen offset:1024 sc0 sc1
  buffer_store_dword v116, v14, s[36:39], s62 offen sc0 sc1
  s_cmp_gt_u32 s57, 1
  s_cbranch_scc1 Li_27
  s_mul_i32 s4, s71, 5
  s_add_u32 s4, s4, s66
  s_add_u32 s4, s4, 3
  s_lshl_b32 s5, s4, 14
  s_add_u32 s61, s5, s76
  s_lshl_b32 s5, s72, 11
  s_add_u32 s61, s61, s5
  s_add_u32 s61, s61, 1179648
  s_lshl_b32 s5, s4, 10
  s_add_u32 s62, s5, s76
  s_lshl_b32 s5, s72, 7
  s_add_u32 s62, s62, s5
  s_add_u32 s62, s62, 1343488
  buffer_store_dwordx4 v[74:77], v5, s[36:39], s61 offen sc0 sc1
  buffer_store_dwordx4 v[78:81], v5, s[36:39], s61 offen offset:1024 sc0 sc1
  buffer_store_dword v117, v14, s[36:39], s62 offen sc0 sc1
Li_27:
  s_waitcnt vmcnt(0)
  v_mov_b32 v110, s60
  s_add_u32 s4, s68, 16
  s_add_u32 s4, s4, s67
  v_mov_b32 v111, s4
  s_mov_b64 exec, 1
  buffer_store_dword v111, v110, s[36:39], 0 offen sc0 sc1
  s_mov_b64 exec, -1
  s_cmp_lg_u32 s66, 0
  s_cbranch_scc1 Lw_28
  v_and_b32 v110, 3, v1
  v_cmp_eq_u32 s[84:85], 3, v110
  s_lshl_b32 s4, s64, 8
  s_add_u32 s4, s4, 28672
  v_lshlrev_b32 v110, 2, v1
  v_add_u32 v110, s4, v110
  s_add_u32 s83, s68, 16
  s_add_u32 s86, s63, 16
  s_mov_b32 s78, 0
Lfp_29:
  s_add_u32 s78, s78, 1
  s_cmp_gt_u32 s78, 400000
  s_cbranch_scc1 L_exit
  s_cmp_eq_u32 s63, 0
  s_cbranch_scc1 Lfps_30
  buffer_load_dword v111, v110, s[36:39], 0 offen sc1
  s_waitcnt vmcnt(0)
  v_subrev_u32 v112, s86, v111
  v_cmp_gt_u32 vcc, 240, v112
  s_nop 3
  s_or_b64 vcc, vcc, s[84:85]
  s_cmp_eq_u64 vcc, exec
  s_cbranch_scc0 Lfps_30
  v_and_b32 v112, 15, v112
  v_cmp_eq_u32 vcc, s67, v112
  s_nop 3
  s_or_b64 vcc, vcc, s[84:85]
  s_cmp_eq_u64 vcc, exec
  s_cbranch_scc1 Lfpf_32
Lfps_30:
  v_subrev_u32 v113, 4096, v110
  buffer_load_dword v111, v113, s[36:39], 0 offen sc1
  s_waitcnt vmcnt(0)
  v_subrev_u32 v112, s83, v111
  v_cmp_gt_u32 vcc, 240, v112
  s_nop 3
  s_or_b64 vcc, vcc, s[84:85]
  s_cmp_eq_u64 vcc, exec
  s_cbranch_scc0 Lfp_29
  s_mov_b32 s4, 0
  s_branch Lfpd_31
Lfpf_32:
  s_mov_b32 s4, 1
Lfpd_31:
  v_mov_b32 v111, s4
  v_mov_b32 v112, 161988
  ds_write_b32 v112, v111
Lw_28:
Lw_26:
  s_waitcnt lgkmcnt(0)
  s_barrier
  v_mov_b32 v108, 161984
  ds_read_b64 v[108:109], v108
  s_waitcnt lgkmcnt(0)
  v_readfirstlane_b32 s69, v109
Li_25:
  s_nop 3
  s_cmp_eq_u32 s69, 0
  s_cselect_b32 s57, 1179648, 0
  s_mov_b32 s5, 163840
  s_cselect_b32 s60, 1343488, s5
  s_add_u32 s57, s57, s76
  s_add_u32 s60, s60, s76
  s_lshl_b32 s4, s77, 14
  s_add_u32 s61, s4, s57
  s_lshl_b32 s5, s72, 11
  s_add_u32 s61, s61, s5
  s_lshl_b32 s4, s77, 10
  s_add_u32 s62, s4, s60
  s_lshl_b32 s5, s72, 7
  s_add_u32 s62, s62, s5
L_layer:
  s_add_u32 s63, s76, 180224
  s_lshl_b32 s83, s70, 2
  s_cmp_eq_u32 s69, 0
  s_cselect_b32 s84, 1073741824, s63
  s_lshl_b32 s4, s66, 15
  s_add_u32 s85, s4, s57
  s_add_u32 s85, s85, 16384
  s_add_u32 s86, s85, 16384
  buffer_load_dwordx4 a[0:3], v5, s[36:39], s85 offen offset:0 sc1
  buffer_load_dwordx4 a[64:67], v5, s[36:39], s86 offen offset:0 sc1
  buffer_load_dwordx4 a[4:7], v5, s[36:39], s85 offen offset:1024 sc1
  buffer_load_dwordx4 a[68:71], v5, s[36:39], s86 offen offset:1024 sc1
  buffer_load_dwordx4 a[8:11], v5, s[36:39], s85 offen offset:2048 sc1
  buffer_load_dwordx4 a[72:75], v5, s[36:39], s86 offen offset:2048 sc1
  buffer_load_dwordx4 a[12:15], v5, s[36:39], s85 offen offset:3072 sc1
  buffer_load_dwordx4 a[76:79], v5, s[36:39], s86 offen offset:3072 sc1
  s_add_u32 s85, s85, 4096
  buffer_load_dwordx4 a[16:19], v5, s[36:39], s85 offen offset:0 sc1
  s_add_u32 s86, s86, 4096
  buffer_load_dwordx4 a[80:83], v5, s[36:39], s86 offen offset:0 sc1
  s_lshl_b32 s4, s66, 11
  s_add_u32 s87, s4, s60
  s_add_u32 s87, s87, 1024
  s_add_u32 s88, s76, 1327104
  s_add_u32 s89, s76, 1352704
  s_min_u32 s4, s64, s70
  s_cmp_eq_u32 s4, 0
  s_cselect_b32 s88, s57, s88
  s_cselect_b32 s89, s60, s89
  s_add_u32 s88, s88, s82
  s_min_u32 s3, s64, s70
  s_cmp_lg_u32 s3, 0
  s_min_u32 s3, s64, s70
  s_cmp_lg_u32 s3, 0
  s_cselect_b32 s91, 176, -1
  s_lshl_b32 s4, s64, 8
  s_add_u32 s4, s4, 16384
  v_and_b32 v138, 7, v1
  v_lshlrev_b32 v138, 2, v138
  v_add_u32 v138, s4, v138
  s_add_u32 s90, s68, 80
  s_add_u32 s92, s51, s81
  ds_read_b64_tr_b16 a[128:129], v28 offset:0
  ds_read_b64_tr_b16 a[130:131], v28 offset:3072
  ds_read_b64_tr_b16 a[132:133], v30 offset:32
  ds_read_b64_tr_b16 a[134:135], v30 offset:3104
  ds_read_b64_tr_b16 a[136:137], v28 offset:64
  ds_read_b64_tr_b16 a[138:139], v28 offset:3136
  ds_read_b64_tr_b16 a[140:141], v30 offset:96
  ds_read_b64_tr_b16 a[142:143], v30 offset:3168
  ds_read_b64_tr_b16 a[144:145], v28 offset:128
  ds_read_b64_tr_b16 a[146:147], v28 offset:3200
  s_waitcnt vmcnt(8)
  s_waitcnt lgkmcnt(8)
  v_mfma_f32_16x16x32_bf16 v[66:69], a[128:131], a[0:3], 0
  ds_read_b64_tr_b16 a[148:149], v30 offset:160
  buffer_load_dwordx4 a[20:23], v5, s[36:39], s85 offen offset:1024 sc1
  v_mfma_f32_16x16x32_bf16 v[102:105], a[128:131], a[64:67], 0
  ds_read_b64_tr_b16 a[150:151], v30 offset:3232
  s_waitcnt lgkmcnt(8)
  v_mfma_f32_16x16x32_bf16 v[70:73], a[132:135], a[0:3], 0
  ds_read_b64_tr_b16 a[128:129], v28 offset:6144
  v_mfma_f32_16x16x32_bf16 v[106:109], a[132:135], a[64:67], 0
  ds_read_b64_tr_b16 a[130:131], v28 offset:9216
  s_waitcnt lgkmcnt(8)
  v_mfma_f32_16x16x32_bf16 v[74:77], a[136:139], a[0:3], 0
  ds_read_b64_tr_b16 a[132:133], v30 offset:6176
  v_mfma_f32_16x16x32_bf16 v[110:113], a[136:139], a[64:67], 0
  ds_read_b64_tr_b16 a[134:135], v30 offset:9248
  s_waitcnt lgkmcnt(8)
  v_mfma_f32_16x16x32_bf16 v[78:81], a[140:143], a[0:3], 0
  ds_read_b64_tr_b16 a[136:137], v28 offset:6208
  buffer_load_dwordx4 a[84:87], v5, s[36:39], s86 offen offset:1024 sc1
  v_mfma_f32_16x16x32_bf16 v[114:117], a[140:143], a[64:67], 0
  ds_read_b64_tr_b16 a[138:139], v28 offset:9280
  s_waitcnt lgkmcnt(8)
  v_mfma_f32_16x16x32_bf16 v[82:85], a[0:3], a[144:147], 0
  ds_read_b64_tr_b16 a[140:141], v30 offset:6240
  v_mfma_f32_16x16x32_bf16 v[118:121], a[64:67], a[144:147], 0
  ds_read_b64_tr_b16 a[142:143], v30 offset:9312
  s_waitcnt lgkmcnt(8)
  v_mfma_f32_16x16x32_bf16 v[86:89], a[0:3], a[148:151], 0
  ds_read_b64_tr_b16 a[144:145], v28 offset:6272
  s_cmp_lg_u32 s70, 1
  s_cbranch_scc1 Li_33
  s_add_u32 m0, s81, 73728
  s_add_u32 s79, s92, 73728
  buffer_load_dwordx4 v5, s[36:39], s79 offen sc1 lds
Li_33:
  v_mfma_f32_16x16x32_bf16 v[122:125], a[64:67], a[148:151], 0
  ds_read_b64_tr_b16 a[146:147], v28 offset:9344
  s_waitcnt vmcnt(8) lgkmcnt(8)
  v_mfma_f32_16x16x32_bf16 v[66:69], a[128:131], a[4:7], v[66:69]
  ds_read_b64_tr_b16 a[148:149], v30 offset:6304
  buffer_load_dwordx4 a[24:27], v5, s[36:39], s85 offen offset:2048 sc1
  v_mfma_f32_16x16x32_bf16 v[102:105], a[128:131], a[68:71], v[102:105]
  ds_read_b64_tr_b16 a[150:151], v30 offset:9376
  s_waitcnt lgkmcnt(8)
  v_mfma_f32_16x16x32_bf16 v[70:73], a[132:135], a[4:7], v[70:73]
  ds_read_b64_tr_b16 a[128:129], v28 offset:12288
  v_mfma_f32_16x16x32_bf16 v[106:109], a[132:135], a[68:71], v[106:109]
  ds_read_b64_tr_b16 a[130:131], v28 offset:15360
  s_waitcnt lgkmcnt(8)
  v_mfma_f32_16x16x32_bf16 v[74:77], a[136:139], a[4:7], v[74:77]
  ds_read_b64_tr_b16 a[132:133], v30 offset:12320
  v_mfma_f32_16x16x32_bf16 v[110:113], a[136:139], a[68:71], v[110:113]
  ds_read_b64_tr_b16 a[134:135], v30 offset:15392
  s_waitcnt lgkmcnt(8)
  v_mfma_f32_16x16x32_bf16 v[78:81], a[140:143], a[4:7], v[78:81]
  ds_read_b64_tr_b16 a[136:137], v28 offset:12352
  buffer_load_dwordx4 a[88:91], v5, s[36:39], s86 offen offset:2048 sc1
  v_mfma_f32_16x16x32_bf16 v[114:117], a[140:143], a[68:71], v[114:117]
  ds_read_b64_tr_b16 a[138:139], v28 offset:15424
  s_waitcnt lgkmcnt(8)
  v_mfma_f32_16x16x32_bf16 v[82:85], a[4:7], a[144:147], v[82:85]
  ds_read_b64_tr_b16 a[140:141], v30 offset:12384
  v_mfma_f32_16x16x32_bf16 v[118:121], a[68:71], a[144:147], v[118:121]
  ds_read_b64_tr_b16 a[142:143], v30 offset:15456
  s_waitcnt lgkmcnt(8)
  v_mfma_f32_16x16x32_bf16 v[86:89], a[4:7], a[148:151], v[86:89]
  ds_read_b64_tr_b16 a[144:145], v28 offset:12416
  s_cmp_lg_u32 s70, 1
  s_cbranch_scc1 Li_34
  buffer_load_dwordx4 v5, s[36:39], s79 offen offset:1024 sc1 lds
Li_34:
  v_mfma_f32_16x16x32_bf16 v[122:125], a[68:71], a[148:151], v[122:125]
  ds_read_b64_tr_b16 a[146:147], v28 offset:15488
  s_waitcnt vmcnt(8) lgkmcnt(8)
  v_mfma_f32_16x16x32_bf16 v[66:69], a[128:131], a[8:11], v[66:69]
  ds_read_b64_tr_b16 a[148:149], v30 offset:12448
  buffer_load_dwordx4 a[28:31], v5, s[36:39], s85 offen offset:3072 sc1
  v_mfma_f32_16x16x32_bf16 v[102:105], a[128:131], a[72:75], v[102:105]
  ds_read_b64_tr_b16 a[150:151], v30 offset:15520
  s_waitcnt lgkmcnt(8)
  v_mfma_f32_16x16x32_bf16 v[70:73], a[132:135], a[8:11], v[70:73]
  ds_read_b64_tr_b16 a[128:129], v28 offset:18432
  v_mfma_f32_16x16x32_bf16 v[106:109], a[132:135], a[72:75], v[106:109]
  ds_read_b64_tr_b16 a[130:131], v28 offset:21504
  s_waitcnt lgkmcnt(8)
  v_mfma_f32_16x16x32_bf16 v[74:77], a[136:139], a[8:11], v[74:77]
  ds_read_b64_tr_b16 a[132:133], v30 offset:18464
  buffer_load_dword v126, v13, s[36:39], s87 offen offset:0 sc1
  v_mfma_f32_16x16x32_bf16 v[110:113], a[136:139], a[72:75], v[110:113]
  ds_read_b64_tr_b16 a[134:135], v30 offset:21536
  s_waitcnt lgkmcnt(8)
  v_mfma_f32_16x16x32_bf16 v[78:81], a[140:143], a[8:11], v[78:81]
  ds_read_b64_tr_b16 a[136:137], v28 offset:18496
  buffer_load_dwordx4 a[92:95], v5, s[36:39], s86 offen offset:3072 sc1
  v_mfma_f32_16x16x32_bf16 v[114:117], a[140:143], a[72:75], v[114:117]
  ds_read_b64_tr_b16 a[138:139], v28 offset:21568
  s_waitcnt lgkmcnt(8)
  v_mfma_f32_16x16x32_bf16 v[82:85], a[8:11], a[144:147], v[82:85]
  ds_read_b64_tr_b16 a[140:141], v30 offset:18528
  buffer_load_dword v127, v13, s[36:39], s87 offen offset:256 sc1
  v_mfma_f32_16x16x32_bf16 v[118:121], a[72:75], a[144:147], v[118:121]
  ds_read_b64_tr_b16 a[142:143], v30 offset:21600
  s_waitcnt lgkmcnt(8)
  v_mfma_f32_16x16x32_bf16 v[86:89], a[8:11], a[148:151], v[86:89]
  ds_read_b64_tr_b16 a[144:145], v28 offset:18560
  s_cmp_lg_u32 s70, 1
  s_cbranch_scc1 Li_35
  buffer_load_dwordx4 v5, s[36:39], s79 offen offset:2048 sc1 lds
Li_35:
  v_mfma_f32_16x16x32_bf16 v[122:125], a[72:75], a[148:151], v[122:125]
  ds_read_b64_tr_b16 a[146:147], v28 offset:21632
  s_waitcnt lgkmcnt(8)
  s_barrier
  s_cmp_lg_u32 s70, 0
  s_cbranch_scc1 Li_36
  s_cmp_lg_u32 s66, 2
  s_cbranch_scc1 Lw_38
  s_and_b32 s4, s66, 1
  s_lshl_b32 s5, s64, 1
  s_add_u32 s4, s4, s5
  s_mul_i32 s3, s4, 3072
  s_add_u32 s3, s3, s51
  buffer_store_dwordx4 v[90:93], v5, s[36:39], s3 offen offset:0 sc0 sc1
  buffer_store_dwordx4 v[94:97], v5, s[36:39], s3 offen offset:1024 sc0 sc1
  buffer_store_dwordx4 v[98:101], v5, s[36:39], s3 offen offset:2048 sc0 sc1
  s_branch Lwe_37
Lw_38:
  s_cmp_lg_u32 s66, 3
  s_cbranch_scc1 Lw_39
  s_and_b32 s4, s66, 1
  s_lshl_b32 s5, s64, 1
  s_add_u32 s4, s4, s5
  s_mul_i32 s3, s4, 3072
  s_add_u32 s3, s3, s51
  buffer_store_dwordx4 v[90:93], v5, s[36:39], s3 offen offset:0 sc0 sc1
  buffer_store_dwordx4 v[94:97], v5, s[36:39], s3 offen offset:1024 sc0 sc1
  buffer_store_dwordx4 v[98:101], v5, s[36:39], s3 offen offset:2048 sc0 sc1
Lw_39:
Lwe_37:
  v_and_b32 v162, 1, v4
  v_lshlrev_b32 v162, 2, v162
  v_lshrrev_b32 v163, 2, v3
  v_add_u32 v162, v162, v163
  v_lshlrev_b32 v162, 1, v162
  v_lshrrev_b32 v163, 1, v4
  v_add_u32 v162, v162, v163
  v_mul_u32_u24 v157, 176, v162
  v_add_u32 v157, 114688, v157
  s_mul_i32 s4, s64, 11264
  s_add_u32 s93, s50, s4
  s_lshl_b32 s94, s65, 4
  s_add_u32 s94, s94, s64
  s_lshl_b32 s94, s94, 10
  s_add_u32 s94, s94, 131072
  v_lshlrev_b32 v179, 4, v4
  v_mov_b32 v162, 2147483632
  v_cmp_eq_u32 vcc, 0, v3
  s_nop 1
  v_cndmask_b32 v179, v162, v179, vcc
  s_cmp_lg_u32 s66, 0
  s_cbranch_scc1 Lw_41
  v_add_u32 v178, v157, v12
  ds_read_b64_tr_b16 v[166:167], v178 offset:0
  ds_read_b64_tr_b16 v[168:169], v178 offset:2816
  v_add_u32 v178, v157, v12
  ds_read_b64_tr_b16 v[170:171], v178 offset:64
  ds_read_b64_tr_b16 v[172:173], v178 offset:2880
  v_add_u32 v178, v157, v12
  ds_read_b64_tr_b16 v[174:175], v178 offset:128
  ds_read_b64_tr_b16 v[176:177], v178 offset:2944
  s_add_u32 s4, s93, 0
  s_waitcnt lgkmcnt(4)
  buffer_store_dwordx4 v[166:169], v5, s[36:39], s4 offen sc0 sc1
  v_mfma_f32_16x16x32_bf16 v[180:183], v[166:169], v[6:9], 0
  s_add_u32 s4, s93, 4096
  s_waitcnt lgkmcnt(2)
  buffer_store_dwordx4 v[170:173], v5, s[36:39], s4 offen sc0 sc1
  v_mfma_f32_16x16x32_bf16 v[184:187], v[170:173], v[6:9], 0
  s_add_u32 s4, s93, 8192
  s_waitcnt lgkmcnt(0)
  buffer_store_dwordx4 v[174:177], v5, s[36:39], s4 offen sc0 sc1
  v_mfma_f32_16x16x32_bf16 v[188:191], v[174:177], v[6:9], 0
  buffer_store_dwordx4 v[180:183], v179, s[36:39], s94 offen offset:0 sc0 sc1
  s_nop 2
  buffer_store_dwordx4 v[184:187], v179, s[36:39], s94 offen offset:256 sc0 sc1
  s_nop 2
  buffer_store_dwordx4 v[188:191], v179, s[36:39], s94 offen offset:512 sc0 sc1
  s_branch Lwe_40
Lw_41:
  s_cmp_lg_u32 s66, 1
  s_cbranch_scc1 Lw_42
  v_add_u32 v178, v157, v12
  ds_read_b64_tr_b16 v[166:167], v178 offset:6144
  ds_read_b64_tr_b16 v[168:169], v178 offset:8960
  v_add_u32 v178, v157, v12
  ds_read_b64_tr_b16 v[170:171], v178 offset:6208
  ds_read_b64_tr_b16 v[172:173], v178 offset:9024
  v_add_u32 v178, v157, v12
  ds_read_b64_tr_b16 v[174:175], v178 offset:6272
  ds_read_b64_tr_b16 v[176:177], v178 offset:9088
  s_add_u32 s4, s93, 1024
  s_waitcnt lgkmcnt(4)
  buffer_store_dwordx4 v[166:169], v5, s[36:39], s4 offen sc0 sc1
  v_mfma_f32_16x16x32_bf16 v[180:183], v[166:169], v[6:9], 0
  s_add_u32 s4, s93, 5120
  s_waitcnt lgkmcnt(2)
  buffer_store_dwordx4 v[170:173], v5, s[36:39], s4 offen sc0 sc1
  v_mfma_f32_16x16x32_bf16 v[184:187], v[170:173], v[6:9], 0
  s_add_u32 s4, s93, 9216
  s_waitcnt lgkmcnt(0)
  buffer_store_dwordx4 v[174:177], v5, s[36:39], s4 offen sc0 sc1
  v_mfma_f32_16x16x32_bf16 v[188:191], v[174:177], v[6:9], 0
  buffer_store_dwordx4 v[180:183], v179, s[36:39], s94 offen offset:64 sc0 sc1
  s_nop 2
  buffer_store_dwordx4 v[184:187], v179, s[36:39], s94 offen offset:320 sc0 sc1
  s_nop 2
  buffer_store_dwordx4 v[188:191], v179, s[36:39], s94 offen offset:576 sc0 sc1
  s_branch Lwe_40
Lw_42:
  s_cmp_lg_u32 s66, 2
  s_cbranch_scc1 Lw_43
  v_add_u32 v178, v157, v12
  ds_read_b64_tr_b16 v[166:167], v178 offset:32
  ds_read_b64_tr_b16 v[168:169], v178 offset:2848
  v_add_u32 v178, v157, v12
  ds_read_b64_tr_b16 v[170:171], v178 offset:96
  ds_read_b64_tr_b16 v[172:173], v178 offset:2912
  v_and_b32 v162, 1, v1
  v_lshlrev_b32 v162, 3, v162
  v_and_b32 v163, 2, v1
  v_mul_u32_u24 v163, 3072, v163
  v_add3_u32 v178, v157, v162, v163
  ds_read_b64_tr_b16 v[174:175], v178 offset:160
  ds_read_b64_tr_b16 v[176:177], v178 offset:2976
  s_add_u32 s4, s93, 2048
  s_waitcnt lgkmcnt(4)
  buffer_store_dwordx4 v[166:169], v5, s[36:39], s4 offen sc0 sc1
  v_mfma_f32_16x16x32_bf16 v[180:183], v[166:169], v[6:9], 0
  s_add_u32 s4, s93, 6144
  s_waitcnt lgkmcnt(2)
  buffer_store_dwordx4 v[170:173], v5, s[36:39], s4 offen sc0 sc1
  v_mfma_f32_16x16x32_bf16 v[184:187], v[170:173], v[6:9], 0
  s_add_u32 s4, s93, 10240
  s_waitcnt lgkmcnt(0)
  buffer_store_dwordx4 v[174:177], v5, s[36:39], s4 offen sc0 sc1
  v_mfma_f32_16x16x32_bf16 v[188:191], v[174:177], v[6:9], 0
  buffer_store_dwordx4 v[180:183], v179, s[36:39], s94 offen offset:128 sc0 sc1
  s_nop 2
  buffer_store_dwordx4 v[184:187], v179, s[36:39], s94 offen offset:384 sc0 sc1
  s_nop 2
  buffer_store_dwordx4 v[188:191], v179, s[36:39], s94 offen offset:640 sc0 sc1
  s_branch Lwe_40
Lw_43:
  s_cmp_lg_u32 s66, 3
  s_cbranch_scc1 Lw_44
  v_add_u32 v178, v157, v12
  ds_read_b64_tr_b16 v[166:167], v178 offset:6176
  ds_read_b64_tr_b16 v[168:169], v178 offset:8992
  v_add_u32 v178, v157, v12
  ds_read_b64_tr_b16 v[170:171], v178 offset:6240
  ds_read_b64_tr_b16 v[172:173], v178 offset:9056
  s_add_u32 s4, s93, 3072
  s_waitcnt lgkmcnt(2)
  buffer_store_dwordx4 v[166:169], v5, s[36:39], s4 offen sc0 sc1
  v_mfma_f32_16x16x32_bf16 v[180:183], v[166:169], v[6:9], 0
  s_add_u32 s4, s93, 7168
  s_waitcnt lgkmcnt(0)
  buffer_store_dwordx4 v[170:173], v5, s[36:39], s4 offen sc0 sc1
  v_mfma_f32_16x16x32_bf16 v[184:187], v[170:173], v[6:9], 0
  s_nop 3
  buffer_store_dwordx4 v[180:183], v179, s[36:39], s94 offen offset:192 sc0 sc1
  s_nop 2
  buffer_store_dwordx4 v[184:187], v179, s[36:39], s94 offen offset:448 sc0 sc1
Lw_44:
Lwe_40:
Li_36:
  s_waitcnt vmcnt(10)
  v_mfma_f32_16x16x32_bf16 v[66:69], a[128:131], a[12:15], v[66:69]
  ds_read_b64_tr_b16 a[148:149], v30 offset:18592
  s_add_u32 s85, s85, 4096
  buffer_load_dwordx4 a[32:35], v5, s[36:39], s85 offen offset:0 sc1
  v_mfma_f32_16x16x32_bf16 v[102:105], a[128:131], a[76:79], v[102:105]
  ds_read_b64_tr_b16 a[150:151], v30 offset:21664
  s_waitcnt lgkmcnt(8)
  v_mfma_f32_16x16x32_bf16 v[70:73], a[132:135], a[12:15], v[70:73]
  ds_read_b64_tr_b16 a[128:129], v28 offset:24576
  v_mfma_f32_16x16x32_bf16 v[106:109], a[132:135], a[76:79], v[106:109]
  ds_read_b64_tr_b16 a[130:131], v28 offset:27648
  s_waitcnt lgkmcnt(8)
  v_mfma_f32_16x16x32_bf16 v[74:77], a[136:139], a[12:15], v[74:77]
  ds_read_b64_tr_b16 a[132:133], v30 offset:24608
  buffer_load_dword v128, v13, s[36:39], s87 offen offset:512 sc1
  v_mfma_f32_16x16x32_bf16 v[110:113], a[136:139], a[76:79], v[110:113]
  ds_read_b64_tr_b16 a[134:135], v30 offset:27680
  s_waitcnt lgkmcnt(8)
  v_mfma_f32_16x16x32_bf16 v[78:81], a[140:143], a[12:15], v[78:81]
  ds_read_b64_tr_b16 a[136:137], v28 offset:24640
  s_add_u32 s86, s86, 4096
  buffer_load_dwordx4 a[96:99], v5, s[36:39], s86 offen offset:0 sc1
  v_mfma_f32_16x16x32_bf16 v[114:117], a[140:143], a[76:79], v[114:117]
  ds_read_b64_tr_b16 a[138:139], v28 offset:27712
  s_waitcnt lgkmcnt(8)
  v_mfma_f32_16x16x32_bf16 v[82:85], a[12:15], a[144:147], v[82:85]
  ds_read_b64_tr_b16 a[140:141], v30 offset:24672
  buffer_load_dword v129, v13, s[36:39], s87 offen offset:768 sc1
  v_mfma_f32_16x16x32_bf16 v[118:121], a[76:79], a[144:147], v[118:121]
  ds_read_b64_tr_b16 a[142:143], v30 offset:27744
  s_waitcnt lgkmcnt(8)
  v_mfma_f32_16x16x32_bf16 v[86:89], a[12:15], a[148:151], v[86:89]
  ds_read_b64_tr_b16 a[144:145], v28 offset:24704
  s_cmp_lg_u32 s70, 1
  s_cbranch_scc1 Li_45
  s_add_u32 m0, s81, 86016
  s_add_u32 s79, s92, 86016
  buffer_load_dwordx4 v5, s[36:39], s79 offen sc1 lds
Li_45:
  v_mfma_f32_16x16x32_bf16 v[122:125], a[76:79], a[148:151], v[122:125]
  ds_read_b64_tr_b16 a[146:147], v28 offset:27776
  s_waitcnt vmcnt(12) lgkmcnt(8)
  v_mfma_f32_16x16x32_bf16 v[66:69], a[128:131], a[16:19], v[66:69]
  ds_read_b64_tr_b16 a[148:149], v30 offset:24736
  buffer_load_dwordx4 a[36:39], v5, s[36:39], s85 offen offset:1024 sc1
  v_mfma_f32_16x16x32_bf16 v[102:105], a[128:131], a[80:83], v[102:105]
  ds_read_b64_tr_b16 a[150:151], v30 offset:27808
  s_waitcnt lgkmcnt(8)
  v_mfma_f32_16x16x32_bf16 v[70:73], a[132:135], a[16:19], v[70:73]
  ds_read_b64_tr_b16 a[128:129], v28 offset:30720
  v_mfma_f32_16x16x32_bf16 v[106:109], a[132:135], a[80:83], v[106:109]
  ds_read_b64_tr_b16 a[130:131], v28 offset:33792
  s_waitcnt lgkmcnt(8)
  v_mfma_f32_16x16x32_bf16 v[74:77], a[136:139], a[16:19], v[74:77]
  ds_read_b64_tr_b16 a[132:133], v30 offset:30752
  buffer_load_dword v130, v13, s[36:39], s87 offen offset:1024 sc1
  v_mfma_f32_16x16x32_bf16 v[110:113], a[136:139], a[80:83], v[110:113]
  ds_read_b64_tr_b16 a[134:135], v30 offset:33824
  s_waitcnt lgkmcnt(8)
  v_mfma_f32_16x16x32_bf16 v[78:81], a[140:143], a[16:19], v[78:81]
  ds_read_b64_tr_b16 a[136:137], v28 offset:30784
  buffer_load_dwordx4 a[100:103], v5, s[36:39], s86 offen offset:1024 sc1
  v_mfma_f32_16x16x32_bf16 v[114:117], a[140:143], a[80:83], v[114:117]
  ds_read_b64_tr_b16 a[138:139], v28 offset:33856
  s_waitcnt lgkmcnt(8)
  v_mfma_f32_16x16x32_bf16 v[82:85], a[16:19], a[144:147], v[82:85]
  ds_read_b64_tr_b16 a[140:141], v30 offset:30816
  buffer_load_dword v131, v13, s[36:39], s87 offen offset:1280 sc1
  v_mfma_f32_16x16x32_bf16 v[118:121], a[80:83], a[144:147], v[118:121]
  ds_read_b64_tr_b16 a[142:143], v30 offset:33888
  s_waitcnt lgkmcnt(8)
  v_mfma_f32_16x16x32_bf16 v[86:89], a[16:19], a[148:151], v[86:89]
  ds_read_b64_tr_b16 a[144:145], v28 offset:30848
  s_cmp_lg_u32 s70, 1
  s_cbranch_scc1 Li_46
  buffer_load_dwordx4 v5, s[36:39], s79 offen offset:1024 sc1 lds
Li_46:
  v_mfma_f32_16x16x32_bf16 v[122:125], a[80:83], a[148:151], v[122:125]
  ds_read_b64_tr_b16 a[146:147], v28 offset:33920
  s_waitcnt vmcnt(14) lgkmcnt(8)
  v_mfma_f32_16x16x32_bf16 v[66:69], a[128:131], a[20:23], v[66:69]
  ds_read_b64_tr_b16 a[148:149], v30 offset:30880
  buffer_load_dwordx4 a[40:43], v5, s[36:39], s85 offen offset:2048 sc1
  v_mfma_f32_16x16x32_bf16 v[102:105], a[128:131], a[84:87], v[102:105]
  ds_read_b64_tr_b16 a[150:151], v30 offset:33952
  s_waitcnt lgkmcnt(8)
  v_mfma_f32_16x16x32_bf16 v[70:73], a[132:135], a[20:23], v[70:73]
  ds_read_b64_tr_b16 a[128:129], v28 offset:36864
  v_mfma_f32_16x16x32_bf16 v[106:109], a[132:135], a[84:87], v[106:109]
  ds_read_b64_tr_b16 a[130:131], v28 offset:39936
  s_waitcnt lgkmcnt(8)
  v_mfma_f32_16x16x32_bf16 v[74:77], a[136:139], a[20:23], v[74:77]
  ds_read_b64_tr_b16 a[132:133], v30 offset:36896
  buffer_load_dword v132, v13, s[36:39], s87 offen offset:1536 sc1
  v_mfma_f32_16x16x32_bf16 v[110:113], a[136:139], a[84:87], v[110:113]
  ds_read_b64_tr_b16 a[134:135], v30 offset:39968
  s_waitcnt lgkmcnt(8)
  v_mfma_f32_16x16x32_bf16 v[78:81], a[140:143], a[20:23], v[78:81]
  ds_read_b64_tr_b16 a[136:137], v28 offset:36928
  buffer_load_dwordx4 a[104:107], v5, s[36:39], s86 offen offset:2048 sc1
  v_mfma_f32_16x16x32_bf16 v[114:117], a[140:143], a[84:87], v[114:117]
  ds_read_b64_tr_b16 a[138:139], v28 offset:40000
  s_waitcnt lgkmcnt(8)
  v_mfma_f32_16x16x32_bf16 v[82:85], a[20:23], a[144:147], v[82:85]
  ds_read_b64_tr_b16 a[140:141], v30 offset:36960
  buffer_load_dword v133, v13, s[36:39], s87 offen offset:1792 sc1
  v_mfma_f32_16x16x32_bf16 v[118:121], a[84:87], a[144:147], v[118:121]
  ds_read_b64_tr_b16 a[142:143], v30 offset:40032
  s_waitcnt lgkmcnt(8)
  v_mfma_f32_16x16x32_bf16 v[86:89], a[20:23], a[148:151], v[86:89]
  ds_read_b64_tr_b16 a[144:145], v28 offset:36992
  s_cmp_lg_u32 s70, 1
  s_cbranch_scc1 Li_47
  buffer_load_dwordx4 v5, s[36:39], s79 offen offset:2048 sc1 lds
Li_47:
  v_mfma_f32_16x16x32_bf16 v[122:125], a[84:87], a[148:151], v[122:125]
  ds_read_b64_tr_b16 a[146:147], v28 offset:40064
  s_waitcnt vmcnt(16) lgkmcnt(8)
  v_mfma_f32_16x16x32_bf16 v[66:69], a[128:131], a[24:27], v[66:69]
  ds_read_b64_tr_b16 a[148:149], v30 offset:37024
  buffer_load_dwordx4 a[44:47], v5, s[36:39], s85 offen offset:3072 sc1
  v_mfma_f32_16x16x32_bf16 v[102:105], a[128:131], a[88:91], v[102:105]
  ds_read_b64_tr_b16 a[150:151], v30 offset:40096
  s_waitcnt lgkmcnt(8)
  v_mfma_f32_16x16x32_bf16 v[70:73], a[132:135], a[24:27], v[70:73]
  ds_read_b64_tr_b16 a[128:129], v28 offset:43008
  s_cmp_lg_u32 s70, 0
  s_cbranch_scc1 Li_48
  s_lshl_b32 s4, s77, 14
  s_add_u32 s4, s4, s57
  s_lshl_b32 s5, s72, 11
  s_add_u32 s4, s4, s5
  buffer_load_dwordx4 v[140:143], v5, s[36:39], s4 offen sc1
  buffer_load_dwordx4 v[144:147], v5, s[36:39], s4 offen offset:1024 sc1
Li_48:
  v_mfma_f32_16x16x32_bf16 v[106:109], a[132:135], a[88:91], v[106:109]
  ds_read_b64_tr_b16 a[130:131], v28 offset:46080
  s_waitcnt lgkmcnt(8)
  v_mfma_f32_16x16x32_bf16 v[74:77], a[136:139], a[24:27], v[74:77]
  ds_read_b64_tr_b16 a[132:133], v30 offset:43040
  v_mfma_f32_16x16x32_bf16 v[110:113], a[136:139], a[88:91], v[110:113]
  ds_read_b64_tr_b16 a[134:135], v30 offset:46112
  s_waitcnt lgkmcnt(8)
  v_mfma_f32_16x16x32_bf16 v[78:81], a[140:143], a[24:27], v[78:81]
  ds_read_b64_tr_b16 a[136:137], v28 offset:43072
  buffer_load_dwordx4 a[108:111], v5, s[36:39], s86 offen offset:3072 sc1
  v_mfma_f32_16x16x32_bf16 v[114:117], a[140:143], a[88:91], v[114:117]
  ds_read_b64_tr_b16 a[138:139], v28 offset:46144
  s_waitcnt lgkmcnt(8)
  v_mfma_f32_16x16x32_bf16 v[82:85], a[24:27], a[144:147], v[82:85]
  ds_read_b64_tr_b16 a[140:141], v30 offset:43104
  v_mfma_f32_16x16x32_bf16 v[118:121], a[88:91], a[144:147], v[118:121]
  ds_read_b64_tr_b16 a[142:143], v30 offset:46176
  s_waitcnt lgkmcnt(8)
  v_mfma_f32_16x16x32_bf16 v[86:89], a[24:27], a[148:151], v[86:89]
  ds_read_b64_tr_b16 a[144:145], v28 offset:43136
  v_mfma_f32_16x16x32_bf16 v[122:125], a[88:91], a[148:151], v[122:125]
  ds_read_b64_tr_b16 a[146:147], v28 offset:46208
  s_waitcnt vmcnt(15) lgkmcnt(8)
  v_mfma_f32_16x16x32_bf16 v[66:69], a[128:131], a[28:31], v[66:69]
  ds_read_b64_tr_b16 a[148:149], v30 offset:43168
  s_add_u32 s85, s85, 4096
  buffer_load_dwordx4 a[48:51], v5, s[36:39], s85 offen offset:0 sc1
  v_mfma_f32_16x16x32_bf16 v[102:105], a[128:131], a[92:95], v[102:105]
  ds_read_b64_tr_b16 a[150:151], v30 offset:46240
  s_waitcnt lgkmcnt(8)
  v_mfma_f32_16x16x32_bf16 v[70:73], a[132:135], a[28:31], v[70:73]
  ds_read_b64_tr_b16 a[128:129], v29 offset:0
  buffer_load_dword v139, v138, s[36:39], 0 offen sc1
  v_mfma_f32_16x16x32_bf16 v[106:109], a[132:135], a[92:95], v[106:109]
  ds_read_b64_tr_b16 a[130:131], v29 offset:3072
  s_waitcnt lgkmcnt(8)
  v_mfma_f32_16x16x32_bf16 v[74:77], a[136:139], a[28:31], v[74:77]
  ds_read_b64_tr_b16 a[132:133], v31 offset:32
  s_waitcnt vmcnt(16)
  v_add_f32 v126, v126, v127
  v_mfma_f32_16x16x32_bf16 v[110:113], a[136:139], a[92:95], v[110:113]
  ds_read_b64_tr_b16 a[134:135], v31 offset:3104
  s_waitcnt lgkmcnt(8)
  v_mfma_f32_16x16x32_bf16 v[78:81], a[140:143], a[28:31], v[78:81]
  ds_read_b64_tr_b16 a[136:137], v29 offset:64
  s_add_u32 s86, s86, 4096
  buffer_load_dwordx4 a[112:115], v5, s[36:39], s86 offen offset:0 sc1
  v_mfma_f32_16x16x32_bf16 v[114:117], a[140:143], a[92:95], v[114:117]
  ds_read_b64_tr_b16 a[138:139], v29 offset:3136
  s_waitcnt lgkmcnt(8)
  v_mfma_f32_16x16x32_bf16 v[82:85], a[28:31], a[144:147], v[82:85]
  ds_read_b64_tr_b16 a[140:141], v31 offset:96
  s_waitcnt vmcnt(13)
  v_add_f32 v128, v128, v129
  v_mfma_f32_16x16x32_bf16 v[118:121], a[92:95], a[144:147], v[118:121]
  ds_read_b64_tr_b16 a[142:143], v31 offset:3168
  s_waitcnt lgkmcnt(8)
  v_mfma_f32_16x16x32_bf16 v[86:89], a[28:31], a[148:151], v[86:89]
  ds_read_b64_tr_b16 a[144:145], v29 offset:128
  v_add_f32 v126, v126, v128
  v_mfma_f32_16x16x32_bf16 v[122:125], a[92:95], a[148:151], v[122:125]
  ds_read_b64_tr_b16 a[146:147], v29 offset:3200
  s_waitcnt lgkmcnt(8)
  v_mfma_f32_16x16x32_bf16 v[66:69], a[128:131], a[32:35], v[66:69]
  ds_read_b64_tr_b16 a[148:149], v31 offset:160
  buffer_load_dwordx4 a[52:55], v5, s[36:39], s85 offen offset:1024 sc1
  v_mfma_f32_16x16x32_bf16 v[102:105], a[128:131], a[96:99], v[102:105]
  ds_read_b64_tr_b16 a[150:151], v31 offset:3232
  s_waitcnt lgkmcnt(8)
  v_mfma_f32_16x16x32_bf16 v[70:73], a[132:135], a[32:35], v[70:73]
  ds_read_b64_tr_b16 a[128:129], v29 offset:6144
  v_mov_b32 v156, v126
  v_mfma_f32_16x16x32_bf16 v[106:109], a[132:135], a[96:99], v[106:109]
  ds_read_b64_tr_b16 a[130:131], v29 offset:9216
  s_waitcnt lgkmcnt(8)
  v_mfma_f32_16x16x32_bf16 v[74:77], a[136:139], a[32:35], v[74:77]
  ds_read_b64_tr_b16 a[132:133], v31 offset:6176
  v_permlane16_swap_b32 v126, v156
  v_mfma_f32_16x16x32_bf16 v[110:113], a[136:139], a[96:99], v[110:113]
  ds_read_b64_tr_b16 a[134:135], v31 offset:9248
  s_waitcnt lgkmcnt(8)
  v_mfma_f32_16x16x32_bf16 v[78:81], a[140:143], a[32:35], v[78:81]
  ds_read_b64_tr_b16 a[136:137], v29 offset:6208
  buffer_load_dwordx4 a[116:119], v5, s[36:39], s86 offen offset:1024 sc1
  v_mfma_f32_16x16x32_bf16 v[114:117], a[140:143], a[96:99], v[114:117]
  ds_read_b64_tr_b16 a[138:139], v29 offset:9280
  s_waitcnt lgkmcnt(8)
  v_mfma_f32_16x16x32_bf16 v[82:85], a[32:35], a[144:147], v[82:85]
  ds_read_b64_tr_b16 a[140:141], v31 offset:6240
  v_add_f32 v126, v126, v156
  v_mfma_f32_16x16x32_bf16 v[118:121], a[96:99], a[144:147], v[118:121]
  ds_read_b64_tr_b16 a[142:143], v31 offset:9312
  s_waitcnt lgkmcnt(8)
  v_mfma_f32_16x16x32_bf16 v[86:89], a[32:35], a[148:151], v[86:89]
  ds_read_b64_tr_b16 a[144:145], v29 offset:6272
  v_mov_b32 v156, v126
  v_mfma_f32_16x16x32_bf16 v[122:125], a[96:99], a[148:151], v[122:125]
  ds_read_b64_tr_b16 a[146:147], v29 offset:9344
  s_waitcnt vmcnt(12) lgkmcnt(8)
  v_mfma_f32_16x16x32_bf16 v[66:69], a[128:131], a[36:39], v[66:69]
  ds_read_b64_tr_b16 a[148:149], v31 offset:6304
  buffer_load_dwordx4 a[56:59], v5, s[36:39], s85 offen offset:2048 sc1
  v_mfma_f32_16x16x32_bf16 v[102:105], a[128:131], a[100:103], v[102:105]
  ds_read_b64_tr_b16 a[150:151], v31 offset:9376
  s_waitcnt lgkmcnt(8)
  v_mfma_f32_16x16x32_bf16 v[70:73], a[132:135], a[36:39], v[70:73]
  ds_read_b64_tr_b16 a[128:129], v29 offset:12288
  s_waitcnt vmcnt(4)
  v_subrev_u32 v90, s90, v139
  v_cmp_gt_u32 vcc, s91, v90
  s_nop 3
  s_cmp_eq_u64 vcc, exec
  s_cbranch_scc1 Lok_50
  s_mov_b32 s78, 0
Lpoll_49:
  s_add_u32 s78, s78, 1
  s_cmp_gt_u32 s78, 400000
  s_cbranch_scc1 L_exit
  buffer_load_dword v139, v138, s[36:39], 0 offen sc1
  s_waitcnt vmcnt(0)
  v_subrev_u32 v90, s90, v139
  v_cmp_gt_u32 vcc, s91, v90
  s_nop 3
  s_cmp_eq_u64 vcc, exec
  s_cbranch_scc0 Lpoll_49
Lok_50:
  v_mfma_f32_16x16x32_bf16 v[106:109], a[132:135], a[100:103], v[106:109]
  ds_read_b64_tr_b16 a[130:131], v29 offset:15360
  s_waitcnt lgkmcnt(8)
  v_mfma_f32_16x16x32_bf16 v[74:77], a[136:139], a[36:39], v[74:77]
  ds_read_b64_tr_b16 a[132:133], v31 offset:12320
  v_permlane32_swap_b32 v126, v156
  v_mfma_f32_16x16x32_bf16 v[110:113], a[136:139], a[100:103], v[110:113]
  ds_read_b64_tr_b16 a[134:135], v31 offset:15392
  s_waitcnt lgkmcnt(8)
  v_mfma_f32_16x16x32_bf16 v[78:81], a[140:143], a[36:39], v[78:81]
  ds_read_b64_tr_b16 a[136:137], v29 offset:12352
  buffer_load_dwordx4 a[120:123], v5, s[36:39], s86 offen offset:2048 sc1
  v_mfma_f32_16x16x32_bf16 v[114:117], a[140:143], a[100:103], v[114:117]
  ds_read_b64_tr_b16 a[138:139], v29 offset:15424
  s_waitcnt lgkmcnt(8)
  v_mfma_f32_16x16x32_bf16 v[82:85], a[36:39], a[144:147], v[82:85]
  ds_read_b64_tr_b16 a[140:141], v31 offset:12384
  s_add_u32 m0, s82, 98304
  s_add_u32 s79, s88, 0
  buffer_load_dwordx4 v5, s[36:39], s79 offen sc1 lds
  v_mfma_f32_16x16x32_bf16 v[118:121], a[100:103], a[144:147], v[118:121]
  ds_read_b64_tr_b16 a[142:143], v31 offset:15456
  s_waitcnt lgkmcnt(8)
  v_mfma_f32_16x16x32_bf16 v[86:89], a[36:39], a[148:151], v[86:89]
  ds_read_b64_tr_b16 a[144:145], v29 offset:12416
  v_mul_f32 v148, 989855744, v126
  v_mfma_f32_16x16x32_bf16 v[122:125], a[100:103], a[148:151], v[122:125]
  ds_read_b64_tr_b16 a[146:147], v29 offset:15488
  s_waitcnt lgkmcnt(8)
  s_barrier
  v_mfma_f32_16x16x32_bf16 v[66:69], a[128:131], a[40:43], v[66:69]
  ds_read_b64_tr_b16 a[148:149], v31 offset:12448
  buffer_load_dwordx4 a[60:63], v5, s[36:39], s85 offen offset:3072 sc1
  v_mfma_f32_16x16x32_bf16 v[102:105], a[128:131], a[104:107], v[102:105]
  ds_read_b64_tr_b16 a[150:151], v31 offset:15520
  s_waitcnt lgkmcnt(8)
  v_mfma_f32_16x16x32_bf16 v[70:73], a[132:135], a[40:43], v[70:73]
  ds_read_b64_tr_b16 a[128:129], v29 offset:18432
  buffer_load_dwordx4 v5, s[36:39], s79 offen offset:1024 sc1 lds
  v_mfma_f32_16x16x32_bf16 v[106:109], a[132:135], a[104:107], v[106:109]
  ds_read_b64_tr_b16 a[130:131], v29 offset:21504
  s_waitcnt lgkmcnt(8)
  v_mfma_f32_16x16x32_bf16 v[74:77], a[136:139], a[40:43], v[74:77]
  ds_read_b64_tr_b16 a[132:133], v31 offset:18464
  v_mul_f32 v156, 989855744, v156
  v_mfma_f32_16x16x32_bf16 v[110:113], a[136:139], a[104:107], v[110:113]
  ds_read_b64_tr_b16 a[134:135], v31 offset:21536
  s_waitcnt lgkmcnt(8)
  v_mfma_f32_16x16x32_bf16 v[78:81], a[140:143], a[40:43], v[78:81]
  ds_read_b64_tr_b16 a[136:137], v29 offset:18496
  buffer_load_dwordx4 a[124:127], v5, s[36:39], s86 offen offset:3072 sc1
  v_mfma_f32_16x16x32_bf16 v[114:117], a[140:143], a[104:107], v[114:117]
  ds_read_b64_tr_b16 a[138:139], v29 offset:21568
  s_waitcnt lgkmcnt(8)
  v_mfma_f32_16x16x32_bf16 v[82:85], a[40:43], a[144:147], v[82:85]
  ds_read_b64_tr_b16 a[140:141], v31 offset:18528
  buffer_load_dwordx4 v5, s[36:39], s79 offen offset:2048 sc1 lds
  v_mfma_f32_16x16x32_bf16 v[118:121], a[104:107], a[144:147], v[118:121]
  ds_read_b64_tr_b16 a[142:143], v31 offset:21600
  s_waitcnt lgkmcnt(8)
  v_mfma_f32_16x16x32_bf16 v[86:89], a[40:43], a[148:151], v[86:89]
  ds_read_b64_tr_b16 a[144:145], v29 offset:18560
  v_fma_f32 v156, -v148, v148, v156
  v_mfma_f32_16x16x32_bf16 v[122:125], a[104:107], a[148:151], v[122:125]
  ds_read_b64_tr_b16 a[146:147], v29 offset:21632
  s_waitcnt lgkmcnt(8)
  v_mfma_f32_16x16x32_bf16 v[66:69], a[128:131], a[44:47], v[66:69]
  ds_read_b64_tr_b16 a[148:149], v31 offset:18592
  v_max_f32 v156, 0, v156
  v_mfma_f32_16x16x32_bf16 v[102:105], a[128:131], a[108:111], v[102:105]
  ds_read_b64_tr_b16 a[150:151], v31 offset:21664
  s_waitcnt lgkmcnt(8)
  v_mfma_f32_16x16x32_bf16 v[70:73], a[132:135], a[44:47], v[70:73]
  ds_read_b64_tr_b16 a[128:129], v29 offset:24576
  buffer_load_dwordx4 v5, s[36:39], s79 offen offset:3072 sc1 lds
  v_mfma_f32_16x16x32_bf16 v[106:109], a[132:135], a[108:111], v[106:109]
  ds_read_b64_tr_b16 a[130:131], v29 offset:27648
  s_waitcnt lgkmcnt(8)
  v_mfma_f32_16x16x32_bf16 v[74:77], a[136:139], a[44:47], v[74:77]
  ds_read_b64_tr_b16 a[132:133], v31 offset:24608
  v_add_f32 v156, 925353388, v156
  v_mfma_f32_16x16x32_bf16 v[110:113], a[136:139], a[108:111], v[110:113]
  ds_read_b64_tr_b16 a[134:135], v31 offset:27680
  s_waitcnt lgkmcnt(8)
  v_mfma_f32_16x16x32_bf16 v[78:81], a[140:143], a[44:47], v[78:81]
  ds_read_b64_tr_b16 a[136:137], v29 offset:24640
  v_rsq_f32 v149, v156
  v_mfma_f32_16x16x32_bf16 v[114:117], a[140:143], a[108:111], v[114:117]
  ds_read_b64_tr_b16 a[138:139], v29 offset:27712
  s_waitcnt lgkmcnt(8)
  v_mfma_f32_16x16x32_bf16 v[82:85], a[44:47], a[144:147], v[82:85]
  ds_read_b64_tr_b16 a[140:141], v31 offset:24672
  buffer_load_dword v134, v13, s[36:39], s89 offen offset:0 sc1
  v_mfma_f32_16x16x32_bf16 v[118:121], a[108:111], a[144:147], v[118:121]
  ds_read_b64_tr_b16 a[142:143], v31 offset:27744
  s_waitcnt lgkmcnt(8)
  v_mfma_f32_16x16x32_bf16 v[86:89], a[44:47], a[148:151], v[86:89]
  ds_read_b64_tr_b16 a[144:145], v29 offset:24704
  buffer_load_dword v135, v13, s[36:39], s89 offen offset:256 sc1
  v_mfma_f32_16x16x32_bf16 v[122:125], a[108:111], a[148:151], v[122:125]
  ds_read_b64_tr_b16 a[146:147], v29 offset:27776
  s_waitcnt vmcnt(12) lgkmcnt(8)
  v_mfma_f32_16x16x32_bf16 v[66:69], a[128:131], a[48:51], v[66:69]
  ds_read_b64_tr_b16 a[148:149], v31 offset:24736
  v_mul_f32 v150, 1048576000, v149
  v_mfma_f32_16x16x32_bf16 v[102:105], a[128:131], a[112:115], v[102:105]
  ds_read_b64_tr_b16 a[150:151], v31 offset:27808
  s_waitcnt lgkmcnt(8)
  v_mfma_f32_16x16x32_bf16 v[70:73], a[132:135], a[48:51], v[70:73]
  ds_read_b64_tr_b16 a[128:129], v29 offset:30720
  buffer_load_dword v136, v13, s[36:39], s89 offen offset:512 sc1
  v_mfma_f32_16x16x32_bf16 v[106:109], a[132:135], a[112:115], v[106:109]
  ds_read_b64_tr_b16 a[130:131], v29 offset:33792
  s_waitcnt lgkmcnt(8)
  v_mfma_f32_16x16x32_bf16 v[74:77], a[136:139], a[48:51], v[74:77]
  ds_read_b64_tr_b16 a[132:133], v31 offset:30752
  buffer_load_dword v137, v13, s[36:39], s89 offen offset:768 sc1
  v_mfma_f32_16x16x32_bf16 v[110:113], a[136:139], a[112:115], v[110:113]
  ds_read_b64_tr_b16 a[134:135], v31 offset:33824
  s_waitcnt lgkmcnt(8)
  v_mfma_f32_16x16x32_bf16 v[78:81], a[140:143], a[48:51], v[78:81]
  ds_read_b64_tr_b16 a[136:137], v29 offset:30784
  v_add_f32 v130, v130, v131
  v_mfma_f32_16x16x32_bf16 v[114:117], a[140:143], a[112:115], v[114:117]
  ds_read_b64_tr_b16 a[138:139], v29 offset:33856
  s_waitcnt lgkmcnt(8)
  v_mfma_f32_16x16x32_bf16 v[82:85], a[48:51], a[144:147], v[82:85]
  ds_read_b64_tr_b16 a[140:141], v31 offset:30816
  s_add_u32 m0, s54, 126976
  s_add_u32 s79, s55, 0
  buffer_load_dwordx4 v24, s[16:19], s79 offen lds
  v_mfma_f32_16x16x32_bf16 v[118:121], a[112:115], a[144:147], v[118:121]
  ds_read_b64_tr_b16 a[142:143], v31 offset:33888
  s_waitcnt lgkmcnt(8)
  v_mfma_f32_16x16x32_bf16 v[86:89], a[48:51], a[148:151], v[86:89]
  ds_read_b64_tr_b16 a[144:145], v29 offset:30848
  v_add_f32 v132, v132, v133
  v_mfma_f32_16x16x32_bf16 v[122:125], a[112:115], a[148:151], v[122:125]
  ds_read_b64_tr_b16 a[146:147], v29 offset:33920
  s_waitcnt vmcnt(13) lgkmcnt(8)
  v_mfma_f32_16x16x32_bf16 v[66:69], a[128:131], a[52:55], v[66:69]
  ds_read_b64_tr_b16 a[148:149], v31 offset:30880
  v_add_f32 v130, v130, v132
  v_mfma_f32_16x16x32_bf16 v[102:105], a[128:131], a[116:119], v[102:105]
  ds_read_b64_tr_b16 a[150:151], v31 offset:33952
  s_waitcnt lgkmcnt(8)
  v_mfma_f32_16x16x32_bf16 v[70:73], a[132:135], a[52:55], v[70:73]
  ds_read_b64_tr_b16 a[128:129], v29 offset:36864
  buffer_load_dword v23, v21, s[36:39], s84 offen sc1
  v_mfma_f32_16x16x32_bf16 v[106:109], a[132:135], a[116:119], v[106:109]
  ds_read_b64_tr_b16 a[130:131], v29 offset:39936
  s_waitcnt lgkmcnt(8)
  v_mfma_f32_16x16x32_bf16 v[74:77], a[136:139], a[52:55], v[74:77]
  ds_read_b64_tr_b16 a[132:133], v31 offset:36896
  v_mov_b32 v156, v130
  v_mfma_f32_16x16x32_bf16 v[110:113], a[136:139], a[116:119], v[110:113]
  ds_read_b64_tr_b16 a[134:135], v31 offset:39968
  s_waitcnt lgkmcnt(8)
  v_mfma_f32_16x16x32_bf16 v[78:81], a[140:143], a[52:55], v[78:81]
  ds_read_b64_tr_b16 a[136:137], v29 offset:36928
  buffer_load_dwordx4 v25, s[16:19], s79 offen offset:1024 lds
  v_mfma_f32_16x16x32_bf16 v[114:117], a[140:143], a[116:119], v[114:117]
  ds_read_b64_tr_b16 a[138:139], v29 offset:40000
  s_waitcnt lgkmcnt(8)
  v_mfma_f32_16x16x32_bf16 v[82:85], a[52:55], a[144:147], v[82:85]
  ds_read_b64_tr_b16 a[140:141], v31 offset:36960
  v_permlane16_swap_b32 v130, v156
  v_mfma_f32_16x16x32_bf16 v[118:121], a[116:119], a[144:147], v[118:121]
  ds_read_b64_tr_b16 a[142:143], v31 offset:40032
  s_waitcnt lgkmcnt(8)
  v_mfma_f32_16x16x32_bf16 v[86:89], a[52:55], a[148:151], v[86:89]
  ds_read_b64_tr_b16 a[144:145], v29 offset:36992
  buffer_load_dwordx4 v26, s[16:19], s79 offen offset:2048 lds
  v_mfma_f32_16x16x32_bf16 v[122:125], a[116:119], a[148:151], v[122:125]
  ds_read_b64_tr_b16 a[146:147], v29 offset:40064
  s_waitcnt vmcnt(14) lgkmcnt(8)
  v_mfma_f32_16x16x32_bf16 v[66:69], a[128:131], a[56:59], v[66:69]
  ds_read_b64_tr_b16 a[148:149], v31 offset:37024
  buffer_load_dwordx4 v27, s[16:19], s79 offen offset:3072 lds
  v_mfma_f32_16x16x32_bf16 v[102:105], a[128:131], a[120:123], v[102:105]
  ds_read_b64_tr_b16 a[150:151], v31 offset:40096
  s_waitcnt lgkmcnt(8)
  v_mfma_f32_16x16x32_bf16 v[70:73], a[132:135], a[56:59], v[70:73]
  ds_read_b64_tr_b16 a[128:129], v29 offset:43008
  v_add_f32 v130, v130, v156
  v_mfma_f32_16x16x32_bf16 v[106:109], a[132:135], a[120:123], v[106:109]
  ds_read_b64_tr_b16 a[130:131], v29 offset:46080
  s_waitcnt lgkmcnt(8)
  v_mfma_f32_16x16x32_bf16 v[74:77], a[136:139], a[56:59], v[74:77]
  ds_read_b64_tr_b16 a[132:133], v31 offset:43040
  v_mov_b32 v156, v130
  v_mfma_f32_16x16x32_bf16 v[110:113], a[136:139], a[120:123], v[110:113]
  ds_read_b64_tr_b16 a[134:135], v31 offset:46112
  s_waitcnt lgkmcnt(8)
  v_mfma_f32_16x16x32_bf16 v[78:81], a[140:143], a[56:59], v[78:81]
  ds_read_b64_tr_b16 a[136:137], v29 offset:43072
  s_add_u32 m0, s54, 143360
  s_add_u32 s79, s55, 65536
  buffer_load_dwordx4 v24, s[16:19], s79 offen lds
  v_mfma_f32_16x16x32_bf16 v[114:117], a[140:143], a[120:123], v[114:117]
  ds_read_b64_tr_b16 a[138:139], v29 offset:46144
  s_waitcnt lgkmcnt(8)
  v_mfma_f32_16x16x32_bf16 v[82:85], a[56:59], a[144:147], v[82:85]
  ds_read_b64_tr_b16 a[140:141], v31 offset:43104
  v_permlane32_swap_b32 v130, v156
  v_mfma_f32_16x16x32_bf16 v[118:121], a[120:123], a[144:147], v[118:121]
  ds_read_b64_tr_b16 a[142:143], v31 offset:46176
  s_waitcnt lgkmcnt(8)
  v_mfma_f32_16x16x32_bf16 v[86:89], a[56:59], a[148:151], v[86:89]
  ds_read_b64_tr_b16 a[144:145], v29 offset:43136
  v_mul_f32 v152, 989855744, v130
  v_mfma_f32_16x16x32_bf16 v[122:125], a[120:123], a[148:151], v[122:125]
  ds_read_b64_tr_b16 a[146:147], v29 offset:46208
  s_waitcnt vmcnt(12) lgkmcnt(8)
  v_mfma_f32_16x16x32_bf16 v[66:69], a[128:131], a[60:63], v[66:69]
  ds_read_b64_tr_b16 a[148:149], v31 offset:43168
  buffer_load_dwordx4 v25, s[16:19], s79 offen offset:1024 lds
  v_mfma_f32_16x16x32_bf16 v[102:105], a[128:131], a[124:127], v[102:105]
  ds_read_b64_tr_b16 a[150:151], v31 offset:46240
  s_waitcnt lgkmcnt(8)
  v_mfma_f32_16x16x32_bf16 v[70:73], a[132:135], a[60:63], v[70:73]
  v_mul_f32 v156, 989855744, v156
  v_mfma_f32_16x16x32_bf16 v[106:109], a[132:135], a[124:127], v[106:109]
  s_waitcnt lgkmcnt(6)
  v_mfma_f32_16x16x32_bf16 v[74:77], a[136:139], a[60:63], v[74:77]
  buffer_load_dwordx4 v26, s[16:19], s79 offen offset:2048 lds
  v_mfma_f32_16x16x32_bf16 v[110:113], a[136:139], a[124:127], v[110:113]
  s_waitcnt lgkmcnt(4)
  v_mfma_f32_16x16x32_bf16 v[78:81], a[140:143], a[60:63], v[78:81]
  v_fma_f32 v156, -v152, v152, v156
  v_mfma_f32_16x16x32_bf16 v[114:117], a[140:143], a[124:127], v[114:117]
  s_waitcnt lgkmcnt(2)
  v_mfma_f32_16x16x32_bf16 v[82:85], a[60:63], a[144:147], v[82:85]
  buffer_load_dwordx4 v27, s[16:19], s79 offen offset:3072 lds
  v_mfma_f32_16x16x32_bf16 v[118:121], a[124:127], a[144:147], v[118:121]
  s_waitcnt lgkmcnt(0)
  v_mfma_f32_16x16x32_bf16 v[86:89], a[60:63], a[148:151], v[86:89]
  v_max_f32 v156, 0, v156
  v_mfma_f32_16x16x32_bf16 v[122:125], a[124:127], a[148:151], v[122:125]
  v_add_f32 v156, 925353388, v156
  v_rsq_f32 v153, v156
  s_nop 0
  v_mul_f32 v154, 1048576000, v153
  s_cmp_lg_u32 s70, 0
  s_cbranch_scc1 Li_51
  v_lshlrev_b32 v48, 16, v140
  v_and_b32 v49, 4294901760, v140
  v_lshlrev_b32 v50, 16, v141
  v_and_b32 v51, 4294901760, v141
  v_lshlrev_b32 v52, 16, v142
  v_and_b32 v53, 4294901760, v142
  v_lshlrev_b32 v54, 16, v143
  v_and_b32 v55, 4294901760, v143
  v_lshlrev_b32 v56, 16, v144
  v_and_b32 v57, 4294901760, v144
  v_lshlrev_b32 v58, 16, v145
  v_and_b32 v59, 4294901760, v145
  v_lshlrev_b32 v60, 16, v146
  v_and_b32 v61, 4294901760, v146
  v_lshlrev_b32 v62, 16, v147
  v_and_b32 v63, 4294901760, v147
  v_and_b32 v94, 1, v4
  v_xor_b32 v94, s66, v94
  v_lshlrev_b32 v94, 5, v94
  v_add_u32 v90, v15, v94
  v_add_u32 v91, 49152, v90
  s_and_b32 s4, s66, 1
  s_add_u32 s4, s4, 4
  v_and_b32 v94, 1, v4
  v_xor_b32 v94, s4, v94
  v_lshlrev_b32 v94, 5, v94
  v_add_u32 v92, v15, v94
  v_add_u32 v93, 49152, v92
  ds_read_b64_tr_b16 a[0:1], v90 offset:0
  ds_read_b64_tr_b16 a[2:3], v90 offset:3072
  ds_read_b64_tr_b16 a[16:17], v92 offset:0
  ds_read_b64_tr_b16 a[18:19], v92 offset:3072
  ds_read_b64_tr_b16 a[4:5], v90 offset:6144
  ds_read_b64_tr_b16 a[6:7], v90 offset:9216
  ds_read_b64_tr_b16 a[20:21], v92 offset:6144
  ds_read_b64_tr_b16 a[22:23], v92 offset:9216
  ds_read_b64_tr_b16 a[8:9], v90 offset:12288
  ds_read_b64_tr_b16 a[10:11], v90 offset:15360
  ds_read_b64_tr_b16 a[24:25], v92 offset:12288
  ds_read_b64_tr_b16 a[26:27], v92 offset:15360
  s_waitcnt lgkmcnt(10)
  v_mfma_f32_16x16x32_bf16 v[94:97], a[0:3], v[6:9], 0
  s_waitcnt lgkmcnt(8)
  v_mfma_f32_16x16x32_bf16 v[98:101], v[6:9], a[16:19], 0
  ds_read_b64_tr_b16 a[12:13], v90 offset:18432
  ds_read_b64_tr_b16 a[14:15], v90 offset:21504
  ds_read_b64_tr_b16 a[28:29], v92 offset:18432
  ds_read_b64_tr_b16 a[30:31], v92 offset:21504
  s_waitcnt lgkmcnt(10)
  v_mfma_f32_16x16x32_bf16 v[94:97], a[4:7], v[6:9], v[94:97]
  s_waitcnt lgkmcnt(8)
  v_mfma_f32_16x16x32_bf16 v[98:101], v[6:9], a[20:23], v[98:101]
  ds_read_b64_tr_b16 a[0:1], v90 offset:24576
  ds_read_b64_tr_b16 a[2:3], v90 offset:27648
  ds_read_b64_tr_b16 a[16:17], v92 offset:24576
  ds_read_b64_tr_b16 a[18:19], v92 offset:27648
  s_waitcnt lgkmcnt(10)
  v_mfma_f32_16x16x32_bf16 v[94:97], a[8:11], v[6:9], v[94:97]
  s_waitcnt lgkmcnt(8)
  v_mfma_f32_16x16x32_bf16 v[98:101], v[6:9], a[24:27], v[98:101]
  ds_read_b64_tr_b16 a[4:5], v90 offset:30720
  ds_read_b64_tr_b16 a[6:7], v90 offset:33792
  ds_read_b64_tr_b16 a[20:21], v92 offset:30720
  ds_read_b64_tr_b16 a[22:23], v92 offset:33792
  s_waitcnt lgkmcnt(10)
  v_mfma_f32_16x16x32_bf16 v[94:97], a[12:15], v[6:9], v[94:97]
  s_waitcnt lgkmcnt(8)
  v_mfma_f32_16x16x32_bf16 v[98:101], v[6:9], a[28:31], v[98:101]
  ds_read_b64_tr_b16 a[8:9], v90 offset:36864
  ds_read_b64_tr_b16 a[10:11], v90 offset:39936
  ds_read_b64_tr_b16 a[24:25], v92 offset:36864
  ds_read_b64_tr_b16 a[26:27], v92 offset:39936
  s_waitcnt lgkmcnt(10)
  v_mfma_f32_16x16x32_bf16 v[94:97], a[0:3], v[6:9], v[94:97]
  s_waitcnt lgkmcnt(8)
  v_mfma_f32_16x16x32_bf16 v[98:101], v[6:9], a[16:19], v[98:101]
  ds_read_b64_tr_b16 a[12:13], v90 offset:43008
  ds_read_b64_tr_b16 a[14:15], v90 offset:46080
  ds_read_b64_tr_b16 a[28:29], v92 offset:43008
  ds_read_b64_tr_b16 a[30:31], v92 offset:46080
  s_waitcnt lgkmcnt(10)
  v_mfma_f32_16x16x32_bf16 v[94:97], a[4:7], v[6:9], v[94:97]
  s_waitcnt lgkmcnt(8)
  v_mfma_f32_16x16x32_bf16 v[98:101], v[6:9], a[20:23], v[98:101]
  ds_read_b64_tr_b16 a[0:1], v91 offset:0
  ds_read_b64_tr_b16 a[2:3], v91 offset:3072
  ds_read_b64_tr_b16 a[16:17], v93 offset:0
  ds_read_b64_tr_b16 a[18:19], v93 offset:3072
  s_waitcnt lgkmcnt(10)
  v_mfma_f32_16x16x32_bf16 v[94:97], a[8:11], v[6:9], v[94:97]
  s_waitcnt lgkmcnt(8)
  v_mfma_f32_16x16x32_bf16 v[98:101], v[6:9], a[24:27], v[98:101]
  ds_read_b64_tr_b16 a[4:5], v91 offset:6144
  ds_read_b64_tr_b16 a[6:7], v91 offset:9216
  ds_read_b64_tr_b16 a[20:21], v93 offset:6144
  ds_read_b64_tr_b16 a[22:23], v93 offset:9216
  s_waitcnt lgkmcnt(10)
  v_mfma_f32_16x16x32_bf16 v[94:97], a[12:15], v[6:9], v[94:97]
  s_waitcnt lgkmcnt(8)
  v_mfma_f32_16x16x32_bf16 v[98:101], v[6:9], a[28:31], v[98:101]
  ds_read_b64_tr_b16 a[8:9], v91 offset:12288
  ds_read_b64_tr_b16 a[10:11], v91 offset:15360
  ds_read_b64_tr_b16 a[24:25], v93 offset:12288
  ds_read_b64_tr_b16 a[26:27], v93 offset:15360
  s_waitcnt lgkmcnt(10)
  v_mfma_f32_16x16x32_bf16 v[94:97], a[0:3], v[6:9], v[94:97]
  s_waitcnt lgkmcnt(8)
  v_mfma_f32_16x16x32_bf16 v[98:101], v[6:9], a[16:19], v[98:101]
  ds_read_b64_tr_b16 a[12:13], v91 offset:18432
  ds_read_b64_tr_b16 a[14:15], v91 offset:21504
  ds_read_b64_tr_b16 a[28:29], v93 offset:18432
  ds_read_b64_tr_b16 a[30:31], v93 offset:21504
  s_waitcnt lgkmcnt(10)
  v_mfma_f32_16x16x32_bf16 v[94:97], a[4:7], v[6:9], v[94:97]
  s_waitcnt lgkmcnt(8)
  v_mfma_f32_16x16x32_bf16 v[98:101], v[6:9], a[20:23], v[98:101]
  ds_read_b64_tr_b16 a[0:1], v91 offset:24576
  ds_read_b64_tr_b16 a[2:3], v91 offset:27648
  ds_read_b64_tr_b16 a[16:17], v93 offset:24576
  ds_read_b64_tr_b16 a[18:19], v93 offset:27648
  s_waitcnt lgkmcnt(10)
  v_mfma_f32_16x16x32_bf16 v[94:97], a[8:11], v[6:9], v[94:97]
  s_waitcnt lgkmcnt(8)
  v_mfma_f32_16x16x32_bf16 v[98:101], v[6:9], a[24:27], v[98:101]
  ds_read_b64_tr_b16 a[4:5], v91 offset:30720
  ds_read_b64_tr_b16 a[6:7], v91 offset:33792
  ds_read_b64_tr_b16 a[20:21], v93 offset:30720
  ds_read_b64_tr_b16 a[22:23], v93 offset:33792
  s_waitcnt lgkmcnt(10)
  v_mfma_f32_16x16x32_bf16 v[94:97], a[12:15], v[6:9], v[94:97]
  s_waitcnt lgkmcnt(8)
  v_mfma_f32_16x16x32_bf16 v[98:101], v[6:9], a[28:31], v[98:101]
  ds_read_b64_tr_b16 a[8:9], v91 offset:36864
  ds_read_b64_tr_b16 a[10:11], v91 offset:39936
  ds_read_b64_tr_b16 a[24:25], v93 offset:36864
  ds_read_b64_tr_b16 a[26:27], v93 offset:39936
  s_waitcnt lgkmcnt(10)
  v_mfma_f32_16x16x32_bf16 v[94:97], a[0:3], v[6:9], v[94:97]
  s_waitcnt lgkmcnt(8)
  v_mfma_f32_16x16x32_bf16 v[98:101], v[6:9], a[16:19], v[98:101]
  ds_read_b64_tr_b16 a[12:13], v91 offset:43008
  ds_read_b64_tr_b16 a[14:15], v91 offset:46080
  ds_read_b64_tr_b16 a[28:29], v93 offset:43008
  ds_read_b64_tr_b16 a[30:31], v93 offset:46080
  s_waitcnt lgkmcnt(10)
  v_mfma_f32_16x16x32_bf16 v[94:97], a[4:7], v[6:9], v[94:97]
  s_waitcnt lgkmcnt(8)
  v_mfma_f32_16x16x32_bf16 v[98:101], v[6:9], a[20:23], v[98:101]
  s_waitcnt lgkmcnt(6)
  v_mfma_f32_16x16x32_bf16 v[94:97], a[8:11], v[6:9], v[94:97]
  s_waitcnt lgkmcnt(4)
  v_mfma_f32_16x16x32_bf16 v[98:101], v[6:9], a[24:27], v[98:101]
  s_waitcnt lgkmcnt(2)
  v_mfma_f32_16x16x32_bf16 v[94:97], a[12:15], v[6:9], v[94:97]
  s_waitcnt lgkmcnt(0)
  v_mfma_f32_16x16x32_bf16 v[98:101], v[6:9], a[28:31], v[98:101]
  s_lshl_b32 s4, s66, 6
  s_add_u32 s4, s4, 159744
  v_lshlrev_b32 v138, 4, v4
  v_add_u32 v138, s4, v138
  s_mov_b32 exec_lo, 65537
  s_mov_b32 exec_hi, 65537
  ds_write_b128 v138, v[94:97]
  s_and_b32 s4, s66, 1
  s_lshl_b32 s4, s4, 6
  s_add_u32 s4, s4, 160000
  s_mov_b64 exec, -1
  v_lshlrev_b32 v138, 2, v3
  v_add_u32 v138, s4, v138
  s_mov_b64 exec, 65535
  ds_write_b32 v138, v98
  s_mov_b64 exec, -1
  s_waitcnt lgkmcnt(0)
Li_51:
  s_waitcnt vmcnt(13)
  s_barrier
  s_cmp_lg_u32 s70, 0
  s_cbranch_scc1 Li_52
  s_cmp_lg_u32 s66, 1
  s_cbranch_scc1 Lw_53
  s_lshl_b32 s85, s65, 8
  s_lshl_b32 s5, s64, 2
  s_add_u32 s85, s85, s5
  s_add_u32 s85, s85, 8192
  v_mov_b32 v90, s85
  s_add_u32 s4, s68, 16
  s_add_u32 s4, s4, s67
  v_mov_b32 v91, s4
  s_mov_b64 exec, 1
  buffer_store_dword v91, v90, s[36:39], 0 offen sc0 sc1
  s_mov_b64 exec, -1
Lw_53:
Li_52:
  s_add_u32 s4, s66, 2
  v_and_b32 v238, 1, v4
  v_xor_b32 v238, s4, v238
  v_lshlrev_b32 v238, 5, v238
  v_add_u32 v232, v15, v238
  v_add_u32 v233, 49152, v232
  v_add_u32 v157, 98304, v5
  s_cmp_ge_u32 s66, 2
  s_cbranch_scc1 LmN_54
  ds_read_b64_tr_b16 a[0:1], v232 offset:0
  ds_read_b128 a[24:27], v157 offset:0
  ds_read_b64_tr_b16 a[2:3], v232 offset:3072
  ds_read_b64_tr_b16 a[4:5], v232 offset:6144
  ds_read_b128 a[28:31], v157 offset:1024
  ds_read_b64_tr_b16 a[6:7], v232 offset:9216
  ds_read_b64_tr_b16 a[8:9], v232 offset:12288
  ds_read_b128 a[32:35], v157 offset:2048
  ds_read_b64_tr_b16 a[10:11], v232 offset:15360
  ds_read_b64_tr_b16 a[12:13], v232 offset:18432
  ds_read_b128 a[36:39], v157 offset:3072
  ds_read_b64_tr_b16 a[14:15], v232 offset:21504
  ds_read_b64_tr_b16 a[16:17], v232 offset:24576
  ds_read_b128 a[40:43], v157 offset:4096
  ds_read_b64_tr_b16 a[18:19], v232 offset:27648
  s_waitcnt vmcnt(7)
  buffer_load_dword v23, v22, s[36:39], s84 offen sc1
  s_waitcnt lgkmcnt(12)
  v_mfma_f32_16x16x32_bf16 v[234:237], a[0:3], a[24:27], 0
  ds_read_b64_tr_b16 a[20:21], v232 offset:30720
  v_lshlrev_b32 v184, 4, v4
  ds_read_b128 a[44:47], v157 offset:5120
  ds_read_b64_tr_b16 a[22:23], v232 offset:33792
  v_add_u32 v184, 159744, v184
  s_waitcnt lgkmcnt(12)
  v_mfma_f32_16x16x32_bf16 v[234:237], a[4:7], a[28:31], v[234:237]
  ds_read_b64_tr_b16 a[0:1], v232 offset:36864
  v_lshlrev_b32 v185, 2, v3
  ds_read_b128 a[24:27], v157 offset:6144
  ds_read_b64_tr_b16 a[2:3], v232 offset:39936
  v_add_u32 v185, 159744, v185
  s_waitcnt lgkmcnt(12)
  v_mfma_f32_16x16x32_bf16 v[234:237], a[8:11], a[32:35], v[234:237]
  ds_read_b64_tr_b16 a[4:5], v232 offset:43008
  v_add_f32 v134, v134, v135
  ds_read_b128 a[28:31], v157 offset:7168
  ds_read_b64_tr_b16 a[6:7], v232 offset:46080
  v_add_f32 v136, v136, v137
  s_waitcnt lgkmcnt(12)
  v_mfma_f32_16x16x32_bf16 v[234:237], a[12:15], a[36:39], v[234:237]
  ds_read_b64_tr_b16 a[8:9], v233 offset:0
  v_add_f32 v134, v134, v136
  ds_read_b128 a[32:35], v157 offset:8192
  ds_read_b64_tr_b16 a[10:11], v233 offset:3072
  v_mov_b32 v156, v134
  s_waitcnt lgkmcnt(12)
  v_mfma_f32_16x16x32_bf16 v[234:237], a[16:19], a[40:43], v[234:237]
  ds_read_b64_tr_b16 a[12:13], v233 offset:6144
  v_permlane16_swap_b32 v134, v156
  ds_read_b128 a[36:39], v157 offset:9216
  ds_read_b64_tr_b16 a[14:15], v233 offset:9216
  v_add_f32 v134, v134, v156
  s_waitcnt lgkmcnt(12)
  v_mfma_f32_16x16x32_bf16 v[234:237], a[20:23], a[44:47], v[234:237]
  ds_read_b64_tr_b16 a[16:17], v233 offset:12288
  v_mov_b32 v156, v134
  ds_read_b128 a[40:43], v157 offset:10240
  ds_read_b64_tr_b16 a[18:19], v233 offset:15360
  v_permlane32_swap_b32 v134, v156
  s_waitcnt lgkmcnt(12)
  v_mfma_f32_16x16x32_bf16 v[234:237], a[0:3], a[24:27], v[234:237]
  ds_read_b64_tr_b16 a[20:21], v233 offset:18432
  v_mul_f32 v158, 989855744, v134
  ds_read_b128 a[44:47], v157 offset:11264
  ds_read_b64_tr_b16 a[22:23], v233 offset:21504
  v_mul_f32 v156, 989855744, v156
  s_waitcnt lgkmcnt(12)
  v_mfma_f32_16x16x32_bf16 v[234:237], a[4:7], a[28:31], v[234:237]
  ds_read_b64_tr_b16 a[0:1], v233 offset:24576
  v_fma_f32 v156, -v158, v158, v156
  ds_read_b128 a[24:27], v157 offset:12288
  ds_read_b64_tr_b16 a[2:3], v233 offset:27648
  v_max_f32 v156, 0, v156
  s_waitcnt lgkmcnt(12)
  v_mfma_f32_16x16x32_bf16 v[234:237], a[8:11], a[32:35], v[234:237]
  ds_read_b64_tr_b16 a[4:5], v233 offset:30720
  v_add_f32 v156, 925353388, v156
  ds_read_b128 a[28:31], v157 offset:13312
  ds_read_b64_tr_b16 a[6:7], v233 offset:33792
  v_rsq_f32 v159, v156
  s_waitcnt lgkmcnt(12)
  v_mfma_f32_16x16x32_bf16 v[234:237], a[12:15], a[36:39], v[234:237]
  ds_read_b64_tr_b16 a[8:9], v233 offset:36864
  s_lshl_b32 s4, s66, 7
  ds_read_b128 a[32:35], v157 offset:14336
  ds_read_b64_tr_b16 a[10:11], v233 offset:39936
  s_add_u32 s4, s4, 64
  s_waitcnt lgkmcnt(12)
  v_mfma_f32_16x16x32_bf16 v[234:237], a[16:19], a[40:43], v[234:237]
  ds_read_b64_tr_b16 a[12:13], v233 offset:43008
  v_add_u32 v182, s4, v185
  ds_read_b128 a[36:39], v157 offset:15360
  ds_read_b64_tr_b16 a[14:15], v233 offset:46080
  v_add_u32 v183, s4, v184
  s_waitcnt lgkmcnt(12)
  v_mfma_f32_16x16x32_bf16 v[234:237], a[20:23], a[44:47], v[234:237]
  s_waitcnt lgkmcnt(9)
  v_mfma_f32_16x16x32_bf16 v[234:237], a[0:3], a[24:27], v[234:237]
  s_waitcnt lgkmcnt(6)
  v_mfma_f32_16x16x32_bf16 v[234:237], a[4:7], a[28:31], v[234:237]
  s_waitcnt lgkmcnt(3)
  v_mfma_f32_16x16x32_bf16 v[234:237], a[8:11], a[32:35], v[234:237]
  s_waitcnt lgkmcnt(0)
  v_mfma_f32_16x16x32_bf16 v[234:237], a[12:15], a[36:39], v[234:237]
  s_branch LmE_55
LmN_54:
  ds_read_b64_tr_b16 a[0:1], v232 offset:0
  ds_read_b128 a[24:27], v157 offset:0
  ds_read_b64_tr_b16 a[2:3], v232 offset:3072
  ds_read_b64_tr_b16 a[4:5], v232 offset:6144
  ds_read_b128 a[28:31], v157 offset:1024
  ds_read_b64_tr_b16 a[6:7], v232 offset:9216
  ds_read_b64_tr_b16 a[8:9], v232 offset:12288
  ds_read_b128 a[32:35], v157 offset:2048
  ds_read_b64_tr_b16 a[10:11], v232 offset:15360
  ds_read_b64_tr_b16 a[12:13], v232 offset:18432
  ds_read_b128 a[36:39], v157 offset:3072
  ds_read_b64_tr_b16 a[14:15], v232 offset:21504
  ds_read_b64_tr_b16 a[16:17], v232 offset:24576
  ds_read_b128 a[40:43], v157 offset:4096
  ds_read_b64_tr_b16 a[18:19], v232 offset:27648
  s_waitcnt vmcnt(7)
  buffer_load_dword v23, v22, s[36:39], s84 offen sc1
  s_waitcnt lgkmcnt(12)
  v_mfma_f32_16x16x32_bf16 v[234:237], a[24:27], a[0:3], 0
  ds_read_b64_tr_b16 a[20:21], v232 offset:30720
  v_lshlrev_b32 v184, 4, v4
  ds_read_b128 a[44:47], v157 offset:5120
  ds_read_b64_tr_b16 a[22:23], v232 offset:33792
  v_add_u32 v184, 159744, v184
  s_waitcnt lgkmcnt(12)
  v_mfma_f32_16x16x32_bf16 v[234:237], a[28:31], a[4:7], v[234:237]
  ds_read_b64_tr_b16 a[0:1], v232 offset:36864
  v_lshlrev_b32 v185, 2, v3
  ds_read_b128 a[24:27], v157 offset:6144
  ds_read_b64_tr_b16 a[2:3], v232 offset:39936
  v_add_u32 v185, 159744, v185
  s_waitcnt lgkmcnt(12)
  v_mfma_f32_16x16x32_bf16 v[234:237], a[32:35], a[8:11], v[234:237]
  ds_read_b64_tr_b16 a[4:5], v232 offset:43008
  v_add_f32 v134, v134, v135
  ds_read_b128 a[28:31], v157 offset:7168
  ds_read_b64_tr_b16 a[6:7], v232 offset:46080
  v_add_f32 v136, v136, v137
  s_waitcnt lgkmcnt(12)
  v_mfma_f32_16x16x32_bf16 v[234:237], a[36:39], a[12:15], v[234:237]
  ds_read_b64_tr_b16 a[8:9], v233 offset:0
  v_add_f32 v134, v134, v136
  ds_read_b128 a[32:35], v157 offset:8192
  ds_read_b64_tr_b16 a[10:11], v233 offset:3072
  v_mov_b32 v156, v134
  s_waitcnt lgkmcnt(12)
  v_mfma_f32_16x16x32_bf16 v[234:237], a[40:43], a[16:19], v[234:237]
  ds_read_b64_tr_b16 a[12:13], v233 offset:6144
  v_permlane16_swap_b32 v134, v156
  ds_read_b128 a[36:39], v157 offset:9216
  ds_read_b64_tr_b16 a[14:15], v233 offset:9216
  v_add_f32 v134, v134, v156
  s_waitcnt lgkmcnt(12)
  v_mfma_f32_16x16x32_bf16 v[234:237], a[44:47], a[20:23], v[234:237]
  ds_read_b64_tr_b16 a[16:17], v233 offset:12288
  v_mov_b32 v156, v134
  ds_read_b128 a[40:43], v157 offset:10240
  ds_read_b64_tr_b16 a[18:19], v233 offset:15360
  v_permlane32_swap_b32 v134, v156
  s_waitcnt lgkmcnt(12)
  v_mfma_f32_16x16x32_bf16 v[234:237], a[24:27], a[0:3], v[234:237]
  ds_read_b64_tr_b16 a[20:21], v233 offset:18432
  v_mul_f32 v158, 989855744, v134
  ds_read_b128 a[44:47], v157 offset:11264
  ds_read_b64_tr_b16 a[22:23], v233 offset:21504
  v_mul_f32 v156, 989855744, v156
  s_waitcnt lgkmcnt(12)
  v_mfma_f32_16x16x32_bf16 v[234:237], a[28:31], a[4:7], v[234:237]
  ds_read_b64_tr_b16 a[0:1], v233 offset:24576
  v_fma_f32 v156, -v158, v158, v156
  ds_read_b128 a[24:27], v157 offset:12288
  ds_read_b64_tr_b16 a[2:3], v233 offset:27648
  v_max_f32 v156, 0, v156
  s_waitcnt lgkmcnt(12)
  v_mfma_f32_16x16x32_bf16 v[234:237], a[32:35], a[8:11], v[234:237]
  ds_read_b64_tr_b16 a[4:5], v233 offset:30720
  v_add_f32 v156, 925353388, v156
  ds_read_b128 a[28:31], v157 offset:13312
  ds_read_b64_tr_b16 a[6:7], v233 offset:33792
  v_rsq_f32 v159, v156
  s_waitcnt lgkmcnt(12)
  v_mfma_f32_16x16x32_bf16 v[234:237], a[36:39], a[12:15], v[234:237]
  ds_read_b64_tr_b16 a[8:9], v233 offset:36864
  s_lshl_b32 s4, s66, 7
  ds_read_b128 a[32:35], v157 offset:14336
  ds_read_b64_tr_b16 a[10:11], v233 offset:39936
  s_add_u32 s4, s4, 64
  s_waitcnt lgkmcnt(12)
  v_mfma_f32_16x16x32_bf16 v[234:237], a[40:43], a[16:19], v[234:237]
  ds_read_b64_tr_b16 a[12:13], v233 offset:43008
  v_add_u32 v182, s4, v185
  ds_read_b128 a[36:39], v157 offset:15360
  ds_read_b64_tr_b16 a[14:15], v233 offset:46080
  v_add_u32 v183, s4, v184
  s_waitcnt lgkmcnt(12)
  v_mfma_f32_16x16x32_bf16 v[234:237], a[44:47], a[20:23], v[234:237]
  s_waitcnt lgkmcnt(9)
  v_mfma_f32_16x16x32_bf16 v[234:237], a[24:27], a[0:3], v[234:237]
  s_waitcnt lgkmcnt(6)
  v_mfma_f32_16x16x32_bf16 v[234:237], a[28:31], a[4:7], v[234:237]
  s_waitcnt lgkmcnt(3)
  v_mfma_f32_16x16x32_bf16 v[234:237], a[32:35], a[8:11], v[234:237]
  s_waitcnt lgkmcnt(0)
  v_mfma_f32_16x16x32_bf16 v[234:237], a[36:39], a[12:15], v[234:237]
LmE_55:
  s_mov_b64 exec, 65535
  ds_write_b32 v182, v148 offset:1088
  ds_write_b32 v182, v149 offset:1664
  ds_write_b32 v182, v152 offset:1152
  ds_write_b32 v182, v153 offset:1728
  ds_write_b32 v185, v158 offset:1088
  ds_write_b32 v185, v159 offset:1664
  s_mov_b64 exec, -1
  ds_read_b128 v[218:221], v184 offset:128
  ds_read_b128 v[222:225], v184 offset:192
  ds_read_b32 v146, v185 offset:256
  ds_read_b32 v226, v185 offset:320
  ds_read_b128 v[186:189], v183 offset:1088
  ds_read_b128 v[198:201], v183 offset:1664
  ds_read_b128 v[190:193], v183 offset:1152
  ds_read_b128 v[202:205], v183 offset:1728
  ds_read_b128 v[194:197], v184 offset:1088
  ds_read_b128 v[206:209], v184 offset:1664
  ds_read_b128 v[210:213], v184 offset:0
  ds_read_b128 v[214:217], v184 offset:64
  s_and_b32 s4, s66, 1
  s_lshl_b32 s4, s4, 6
  s_add_u32 s5, s4, 128
  v_add_u32 v182, s5, v184
  ds_read_b128 v[228:231], v182 offset:0
  s_waitcnt lgkmcnt(0)
  s_barrier
  v_pk_fma_f32 v[74:75], v[218:219], v[148:149], v[74:75] op_sel_hi:[1,0,1] neg_lo:[0,1,0] neg_hi:[0,1,0]
  s_add_u32 m0, s54, 0
  s_add_u32 s79, s55, 131072
  buffer_load_dwordx4 v24, s[16:19], s79 offen lds
  v_pk_fma_f32 v[76:77], v[220:221], v[148:149], v[76:77] op_sel_hi:[1,0,1] neg_lo:[0,1,0] neg_hi:[0,1,0]
  v_pk_fma_f32 v[78:79], v[222:223], v[148:149], v[78:79] op_sel_hi:[1,0,1] neg_lo:[0,1,0] neg_hi:[0,1,0]
  v_pk_fma_f32 v[80:81], v[224:225], v[148:149], v[80:81] op_sel_hi:[1,0,1] neg_lo:[0,1,0] neg_hi:[0,1,0]
  v_pk_fma_f32 v[110:111], v[218:219], v[152:153], v[110:111] op_sel_hi:[1,0,1] neg_lo:[0,1,0] neg_hi:[0,1,0]
  v_pk_fma_f32 v[112:113], v[220:221], v[152:153], v[112:113] op_sel_hi:[1,0,1] neg_lo:[0,1,0] neg_hi:[0,1,0]
  v_pk_fma_f32 v[114:115], v[222:223], v[152:153], v[114:115] op_sel_hi:[1,0,1] neg_lo:[0,1,0] neg_hi:[0,1,0]
  v_pk_fma_f32 v[116:117], v[224:225], v[152:153], v[116:117] op_sel_hi:[1,0,1] neg_lo:[0,1,0] neg_hi:[0,1,0]
  v_pk_fma_f32 v[82:83], v[186:187], v[146:147], v[82:83] op_sel_hi:[1,0,1] neg_lo:[0,1,0] neg_hi:[0,1,0]
  v_pk_fma_f32 v[84:85], v[188:189], v[146:147], v[84:85] op_sel_hi:[1,0,1] neg_lo:[0,1,0] neg_hi:[0,1,0]
  v_pk_fma_f32 v[86:87], v[186:187], v[226:227], v[86:87] op_sel_hi:[1,0,1] neg_lo:[0,1,0] neg_hi:[0,1,0]
  v_pk_fma_f32 v[88:89], v[188:189], v[226:227], v[88:89] op_sel_hi:[1,0,1] neg_lo:[0,1,0] neg_hi:[0,1,0]
  v_pk_fma_f32 v[118:119], v[190:191], v[146:147], v[118:119] op_sel_hi:[1,0,1] neg_lo:[0,1,0] neg_hi:[0,1,0]
  buffer_load_dwordx4 v25, s[16:19], s79 offen offset:1024 lds
  v_pk_fma_f32 v[120:121], v[192:193], v[146:147], v[120:121] op_sel_hi:[1,0,1] neg_lo:[0,1,0] neg_hi:[0,1,0]
  v_pk_fma_f32 v[122:123], v[190:191], v[226:227], v[122:123] op_sel_hi:[1,0,1] neg_lo:[0,1,0] neg_hi:[0,1,0]
  v_pk_fma_f32 v[124:125], v[192:193], v[226:227], v[124:125] op_sel_hi:[1,0,1] neg_lo:[0,1,0] neg_hi:[0,1,0]
  v_pk_mul_f32 v[74:75], v[74:75], v[148:149] op_sel:[0,1] op_sel_hi:[1,1]
  v_pk_mul_f32 v[76:77], v[76:77], v[148:149] op_sel:[0,1] op_sel_hi:[1,1]
  v_pk_mul_f32 v[78:79], v[78:79], v[148:149] op_sel:[0,1] op_sel_hi:[1,1]
  v_pk_mul_f32 v[80:81], v[80:81], v[148:149] op_sel:[0,1] op_sel_hi:[1,1]
  v_pk_mul_f32 v[110:111], v[110:111], v[152:153] op_sel:[0,1] op_sel_hi:[1,1]
  v_pk_mul_f32 v[112:113], v[112:113], v[152:153] op_sel:[0,1] op_sel_hi:[1,1]
  v_pk_mul_f32 v[114:115], v[114:115], v[152:153] op_sel:[0,1] op_sel_hi:[1,1]
  v_pk_mul_f32 v[116:117], v[116:117], v[152:153] op_sel:[0,1] op_sel_hi:[1,1]
  v_pk_mul_f32 v[82:83], v[82:83], v[198:199]
  buffer_load_dwordx4 v26, s[16:19], s79 offen offset:2048 lds
  v_pk_mul_f32 v[84:85], v[84:85], v[200:201]
  v_pk_mul_f32 v[86:87], v[86:87], v[198:199]
  v_pk_mul_f32 v[88:89], v[88:89], v[200:201]
  v_pk_mul_f32 v[118:119], v[118:119], v[202:203]
  v_pk_mul_f32 v[120:121], v[120:121], v[204:205]
  v_pk_mul_f32 v[122:123], v[122:123], v[202:203]
  v_pk_mul_f32 v[124:125], v[124:125], v[204:205]
  v_cvt_pk_bf16_f32 v98, v74, v75
  v_cvt_pk_bf16_f32 v99, v76, v77
  v_cvt_pk_bf16_f32 v100, v78, v79
  v_cvt_pk_bf16_f32 v101, v80, v81
  v_cvt_pk_bf16_f32 v138, v110, v111
  buffer_load_dwordx4 v27, s[16:19], s79 offen offset:3072 lds
  v_cvt_pk_bf16_f32 v139, v112, v113
  v_cvt_pk_bf16_f32 v140, v114, v115
  v_cvt_pk_bf16_f32 v141, v116, v117
  v_cvt_pk_bf16_f32 v166, v82, v83
  v_cvt_pk_bf16_f32 v167, v84, v85
  v_cvt_pk_bf16_f32 v174, v86, v87
  v_cvt_pk_bf16_f32 v175, v88, v89
  v_cvt_pk_bf16_f32 v168, v118, v119
  v_cvt_pk_bf16_f32 v169, v120, v121
  v_cvt_pk_bf16_f32 v176, v122, v123
  v_cvt_pk_bf16_f32 v177, v124, v125
  s_lshl_b32 s4, s66, 11
  s_add_u32 s4, s4, 116736
  v_add_u32 v182, s4, v5
  ds_write_b64 v182, v[138:139] offset:0
  ds_write_b64 v182, v[168:169] offset:8
  ds_write_b64 v182, v[140:141] offset:1024
  ds_write_b64 v182, v[176:177] offset:1032
  s_cmp_ge_u32 s66, 2
  s_cbranch_scc1 LhN_62
  v_pk_fma_f32 v[234:235], v[228:229], v[158:159], v[234:235] op_sel_hi:[1,0,1] neg_lo:[0,1,0] neg_hi:[0,1,0]
  v_pk_fma_f32 v[236:237], v[230:231], v[158:159], v[236:237] op_sel_hi:[1,0,1] neg_lo:[0,1,0] neg_hi:[0,1,0]
  v_pk_mul_f32 v[234:235], v[234:235], v[158:159] op_sel:[0,1] op_sel_hi:[1,1]
  v_pk_mul_f32 v[236:237], v[236:237], v[158:159] op_sel:[0,1] op_sel_hi:[1,1]
  v_cvt_pk_bf16_f32 v126, v234, v235
  v_cvt_pk_bf16_f32 v127, v236, v237
  s_branch LhE_63
LhN_62:
  s_cmp_eq_u32 s66, 2
  s_cselect_b64 vcc, -1, 0
  v_cndmask_b32 v128, v226, v146, vcc
  v_pk_fma_f32 v[234:235], v[194:195], v[128:129], v[234:235] op_sel_hi:[1,0,1] neg_lo:[0,1,0] neg_hi:[0,1,0]
  v_pk_fma_f32 v[236:237], v[196:197], v[128:129], v[236:237] op_sel_hi:[1,0,1] neg_lo:[0,1,0] neg_hi:[0,1,0]
  v_pk_mul_f32 v[234:235], v[234:235], v[206:207]
  v_pk_mul_f32 v[236:237], v[236:237], v[208:209]
  v_cvt_pk_bf16_f32 v126, v234, v235
  v_cvt_pk_bf16_f32 v127, v236, v237
LhE_63:
  s_and_b32 s4, s66, 1
  s_lshl_b32 s4, s4, 10
  s_lshr_b32 s5, s66, 1
  s_lshl_b32 s5, s5, 3
  s_add_u32 s4, s4, s5
  s_add_u32 s4, s4, 114688
  v_add_u32 v157, s4, v5
  ds_write_b64 v157, v[126:127]
  v_pk_fma_f32 v[66:67], v[210:211], v[148:149], v[66:67] op_sel_hi:[1,0,1] neg_lo:[0,1,0] neg_hi:[0,1,0]
  v_pk_fma_f32 v[68:69], v[212:213], v[148:149], v[68:69] op_sel_hi:[1,0,1] neg_lo:[0,1,0] neg_hi:[0,1,0]
  v_pk_fma_f32 v[70:71], v[214:215], v[148:149], v[70:71] op_sel_hi:[1,0,1] neg_lo:[0,1,0] neg_hi:[0,1,0]
  v_pk_fma_f32 v[72:73], v[216:217], v[148:149], v[72:73] op_sel_hi:[1,0,1] neg_lo:[0,1,0] neg_hi:[0,1,0]
  v_pk_fma_f32 v[102:103], v[210:211], v[152:153], v[102:103] op_sel_hi:[1,0,1] neg_lo:[0,1,0] neg_hi:[0,1,0]
  v_pk_fma_f32 v[104:105], v[212:213], v[152:153], v[104:105] op_sel_hi:[1,0,1] neg_lo:[0,1,0] neg_hi:[0,1,0]
  v_pk_fma_f32 v[106:107], v[214:215], v[152:153], v[106:107] op_sel_hi:[1,0,1] neg_lo:[0,1,0] neg_hi:[0,1,0]
  v_pk_fma_f32 v[108:109], v[216:217], v[152:153], v[108:109] op_sel_hi:[1,0,1] neg_lo:[0,1,0] neg_hi:[0,1,0]
  v_pk_mul_f32 v[66:67], v[66:67], v[150:151] op_sel_hi:[1,0]
  v_pk_mul_f32 v[68:69], v[68:69], v[150:151] op_sel_hi:[1,0]
  v_pk_mul_f32 v[70:71], v[70:71], v[150:151] op_sel_hi:[1,0]
  v_pk_mul_f32 v[72:73], v[72:73], v[150:151] op_sel_hi:[1,0]
  v_pk_mul_f32 v[102:103], v[102:103], v[154:155] op_sel_hi:[1,0]
  v_pk_mul_f32 v[104:105], v[104:105], v[154:155] op_sel_hi:[1,0]
  v_pk_mul_f32 v[106:107], v[106:107], v[154:155] op_sel_hi:[1,0]
  v_pk_mul_f32 v[108:109], v[108:109], v[154:155] op_sel_hi:[1,0]
  v_cvt_pk_bf16_f32 v90, v66, v67
  v_cvt_pk_bf16_f32 v91, v68, v69
  v_cvt_pk_bf16_f32 v92, v70, v71
  v_cvt_pk_bf16_f32 v93, v72, v73
  v_cvt_pk_bf16_f32 v94, v102, v103
  v_cvt_pk_bf16_f32 v95, v104, v105
  v_cvt_pk_bf16_f32 v96, v106, v107
  v_cvt_pk_bf16_f32 v97, v108, v109
  s_waitcnt lgkmcnt(0)
  s_barrier
  s_lshl_b32 s4, s66, 11
  s_add_u32 s4, s4, 114688
  v_add_u32 v157, s4, v5
  ds_read_b128 v[162:165], v157 offset:0
  ds_read_b128 v[170:173], v157 offset:1024
  v_mfma_f32_16x16x16_bf16 v[66:69], v[98:99], v[94:95], v[36:39]
  v_mfma_f32_16x16x16_bf16 v[102:105], v[100:101], v[96:97], v[36:39]
  s_add_u32 m0, s54, 16384
  s_add_u32 s79, s55, 196608
  buffer_load_dwordx4 v24, s[16:19], s79 offen lds
  s_waitcnt lgkmcnt(1)
  v_mfma_f32_16x16x16_bf16 v[124:127], v[162:163], v[90:91], v[44:47]
  s_waitcnt lgkmcnt(0)
  v_mfma_f32_16x16x16_bf16 v[186:189], v[170:171], v[92:93], v[44:47]
  v_mfma_f32_16x16x16_bf16 v[70:73], v[138:139], v[94:95], v[40:43]
  v_mfma_f32_16x16x16_bf16 v[106:109], v[140:141], v[96:97], v[40:43]
  v_mfma_f32_16x16x16_bf16 v[128:131], v[98:99], v[90:91], v[40:43]
  v_mfma_f32_16x16x16_bf16 v[190:193], v[100:101], v[92:93], v[40:43]
  v_max3_f32 v74, v66, v67, v68
  v_max3_f32 v110, v102, v103, v104
  v_max3_f32 v132, v124, v125, v126
  buffer_load_dwordx4 v25, s[16:19], s79 offen offset:1024 lds
  v_max3_f32 v136, v186, v187, v188
  v_max3_f32 v74, v74, v69, v70
  v_max3_f32 v110, v110, v105, v106
  v_max3_f32 v132, v132, v127, v128
  v_max3_f32 v136, v136, v189, v190
  v_max3_f32 v74, v74, v71, v72
  v_max3_f32 v110, v110, v107, v108
  v_max3_f32 v132, v132, v129, v130
  v_max3_f32 v136, v136, v191, v192
  buffer_load_dwordx4 v26, s[16:19], s79 offen offset:2048 lds
  v_max_f32 v74, v74, v73
  v_max_f32 v110, v110, v109
  v_max_f32 v132, v132, v131
  v_max_f32 v136, v136, v193
  v_mov_b32 v76, v74
  v_mov_b32 v77, v110
  v_mov_b32 v134, v132
  v_mov_b32 v135, v136
  v_permlane16_swap_b32 v74, v76
  buffer_load_dwordx4 v27, s[16:19], s79 offen offset:3072 lds
  v_permlane16_swap_b32 v110, v77
  v_permlane16_swap_b32 v132, v134
  v_permlane16_swap_b32 v136, v135
  v_max_f32 v74, v74, v76
  v_max_f32 v110, v110, v77
  v_max_f32 v132, v132, v134
  v_max_f32 v136, v136, v135
  v_mov_b32 v76, v74
  v_mov_b32 v77, v110
  s_cmp_lg_u32 s70, 1
  s_cbranch_scc1 Li_56
  s_add_u32 m0, s52, 33792
  s_add_u32 s79, s53, 0
  buffer_load_dwordx4 v5, s[36:39], s79 offen sc1 lds
Li_56:
  v_mov_b32 v134, v132
  v_mov_b32 v135, v136
  v_permlane32_swap_b32 v74, v76
  v_permlane32_swap_b32 v110, v77
  v_permlane32_swap_b32 v132, v134
  v_permlane32_swap_b32 v136, v135
  v_max_f32 v74, v74, v76
  v_max_f32 v110, v110, v77
  v_max_f32 v132, v132, v134
  s_cmp_lg_u32 s70, 1
  s_cbranch_scc1 Li_57
  buffer_load_dwordx4 v5, s[36:39], s79 offen offset:1024 sc1 lds
Li_57:
  v_max_f32 v136, v136, v135
  v_mul_f32 v74, s59, v74
  v_mul_f32 v110, s59, v110
  v_mul_f32 v132, s59, v132
  v_mul_f32 v136, s59, v136
  v_fma_f32 v66, v66, s58, v74
  v_fma_f32 v102, v102, s58, v110
  v_fma_f32 v124, v124, s58, v132
  v_fma_f32 v186, v186, s58, v136
  s_cmp_lg_u32 s70, 1
  s_cbranch_scc1 Li_58
  buffer_load_dwordx4 v5, s[36:39], s79 offen offset:2048 sc1 lds
Li_58:
  v_fma_f32 v67, v67, s58, v74
  v_fma_f32 v103, v103, s58, v110
  v_fma_f32 v125, v125, s58, v132
  v_fma_f32 v187, v187, s58, v136
  v_fma_f32 v68, v68, s58, v74
  v_fma_f32 v104, v104, s58, v110
  v_fma_f32 v126, v126, s58, v132
  v_fma_f32 v188, v188, s58, v136
  v_fma_f32 v69, v69, s58, v74
  s_cmp_lg_u32 s70, 1
  s_cbranch_scc1 Li_59
  s_add_u32 m0, s52, 45056
  s_add_u32 s79, s53, 11264
  buffer_load_dwordx4 v5, s[36:39], s79 offen sc1 lds
Li_59:
  v_fma_f32 v105, v105, s58, v110
  v_fma_f32 v127, v127, s58, v132
  v_fma_f32 v189, v189, s58, v136
  v_fma_f32 v70, v70, s58, v74
  v_fma_f32 v106, v106, s58, v110
  v_fma_f32 v128, v128, s58, v132
  v_fma_f32 v190, v190, s58, v136
  v_fma_f32 v71, v71, s58, v74
  v_fma_f32 v107, v107, s58, v110
  s_cmp_lg_u32 s70, 1
  s_cbranch_scc1 Li_60
  buffer_load_dwordx4 v5, s[36:39], s79 offen offset:1024 sc1 lds
Li_60:
  v_fma_f32 v129, v129, s58, v132
  v_fma_f32 v191, v191, s58, v136
  v_fma_f32 v72, v72, s58, v74
  v_fma_f32 v108, v108, s58, v110
  v_fma_f32 v130, v130, s58, v132
  v_fma_f32 v192, v192, s58, v136
  v_fma_f32 v73, v73, s58, v74
  v_fma_f32 v109, v109, s58, v110
  v_fma_f32 v131, v131, s58, v132
  s_cmp_lg_u32 s70, 1
  s_cbranch_scc1 Li_61
  buffer_load_dwordx4 v5, s[36:39], s79 offen offset:2048 sc1 lds
Li_61:
  v_fma_f32 v193, v193, s58, v136
  v_exp_f32 v66, v66
  v_exp_f32 v102, v102
  v_exp_f32 v124, v124
  v_exp_f32 v186, v186
  v_exp_f32 v67, v67
  v_exp_f32 v103, v103
  v_exp_f32 v125, v125
  v_exp_f32 v187, v187
  v_exp_f32 v68, v68
  v_exp_f32 v104, v104
  v_exp_f32 v126, v126
  v_exp_f32 v188, v188
  v_exp_f32 v69, v69
  v_exp_f32 v105, v105
  v_exp_f32 v127, v127
  v_exp_f32 v189, v189
  v_exp_f32 v70, v70
  v_exp_f32 v106, v106
  v_exp_f32 v128, v128
  v_exp_f32 v190, v190
  v_exp_f32 v71, v71
  v_exp_f32 v107, v107
  v_exp_f32 v129, v129
  v_exp_f32 v191, v191
  v_exp_f32 v72, v72
  v_exp_f32 v108, v108
  v_exp_f32 v130, v130
  v_exp_f32 v192, v192
  v_exp_f32 v73, v73
  v_exp_f32 v109, v109
  v_exp_f32 v131, v131
  v_exp_f32 v193, v193
  v_cvt_pk_bf16_f32 v78, v66, v67
  v_cvt_pk_bf16_f32 v112, v102, v103
  v_cvt_pk_bf16_f32 v146, v124, v125
  v_cvt_pk_bf16_f32 v194, v186, v187
  v_cvt_pk_bf16_f32 v79, v68, v69
  v_cvt_pk_bf16_f32 v113, v104, v105
  v_cvt_pk_bf16_f32 v147, v126, v127
  v_cvt_pk_bf16_f32 v195, v188, v189
  v_cvt_pk_bf16_f32 v80, v70, v71
  v_cvt_pk_bf16_f32 v114, v106, v107
  v_cvt_pk_bf16_f32 v148, v128, v129
  v_cvt_pk_bf16_f32 v196, v190, v191
  v_cvt_pk_bf16_f32 v81, v72, v73
  v_cvt_pk_bf16_f32 v115, v108, v109
  v_cvt_pk_bf16_f32 v149, v130, v131
  v_cvt_pk_bf16_f32 v197, v192, v193
  v_mfma_f32_16x16x32_bf16 v[86:89], v[6:9], v[78:81], 0
  v_mfma_f32_16x16x32_bf16 v[120:123], v[6:9], v[112:115], 0
  v_mfma_f32_16x16x32_bf16 v[158:161], v[6:9], v[146:149], 0
  v_mfma_f32_16x16x32_bf16 v[202:205], v[6:9], v[194:197], 0
  v_mfma_f32_16x16x32_bf16 v[82:85], v[166:169], v[78:81], 0
  v_mfma_f32_16x16x32_bf16 v[116:119], v[174:177], v[112:115], 0
  v_mfma_f32_16x16x32_bf16 v[150:153], v[164:167], v[146:149], 0
  v_mfma_f32_16x16x32_bf16 v[198:201], v[172:175], v[194:197], 0
  s_nop 0
  v_rcp_f32 v74, v86
  v_rcp_f32 v110, v120
  v_rcp_f32 v132, v158
  v_rcp_f32 v136, v202
  v_mul_f32 v82, v82, v74
  v_mul_f32 v116, v116, v110
  v_mul_f32 v150, v150, v132
  v_mul_f32 v198, v198, v136
  v_mul_f32 v83, v83, v74
  v_mul_f32 v117, v117, v110
  v_mul_f32 v151, v151, v132
  v_mul_f32 v199, v199, v136
  v_mul_f32 v84, v84, v74
  v_mul_f32 v118, v118, v110
  v_mul_f32 v152, v152, v132
  v_mul_f32 v200, v200, v136
  v_mul_f32 v85, v85, v74
  v_mul_f32 v119, v119, v110
  v_mul_f32 v153, v153, v132
  v_mul_f32 v201, v201, v136
  v_cvt_pk_bf16_f32 v178, v82, v83
  v_cvt_pk_bf16_f32 v180, v116, v117
  v_cvt_pk_bf16_f32 v142, v150, v151
  v_cvt_pk_bf16_f32 v144, v198, v199
  v_cvt_pk_bf16_f32 v179, v84, v85
  v_cvt_pk_bf16_f32 v181, v118, v119
  v_cvt_pk_bf16_f32 v143, v152, v153
  v_cvt_pk_bf16_f32 v145, v200, v201
  s_lshl_b32 s4, s66, 15
  s_add_u32 s4, s4, s63
  s_lshl_b32 s5, s65, 10
  s_add_u32 s4, s4, s5
  s_add_u32 s85, s4, 0
  s_add_u32 s86, s85, 16384
  s_cmp_eq_u32 s69, 0
  s_cbranch_scc1 Lsl_64
  buffer_store_dwordx4 v[142:145], v5, s[36:39], s85 offen
  buffer_store_dwordx4 v[178:181], v5, s[36:39], s86 offen
Lsb_65:
  s_cmp_lg_u32 s70, 0
  s_cbranch_scc1 Li_66
  s_cmp_lg_u32 s66, 0
  s_cbranch_scc1 Lw_67
  s_lshl_b32 s85, s65, 8
  s_add_u32 s85, s85, 8192
  v_and_b32 v66, 15, v1
  v_lshlrev_b32 v66, 2, v66
  v_add_u32 v66, s85, v66
  s_add_u32 s85, s68, 16
  s_mov_b32 s86, 240
  s_mov_b32 s78, 0
Lpoll_68:
  s_add_u32 s78, s78, 1
  s_cmp_gt_u32 s78, 400000
  s_cbranch_scc1 L_exit
  buffer_load_dword v67, v66, s[36:39], 0 offen sc1
  s_waitcnt vmcnt(0)
  v_subrev_u32 v68, s85, v67
  v_cmp_gt_u32 vcc, s86, v68
  s_nop 3
  s_cmp_eq_u64 vcc, exec
  s_cbranch_scc0 Lpoll_68
Lok_69:
Lw_67:
Li_66:
  s_add_u32 s4, s83, 2
  s_lshl_b32 s4, s4, 4
  s_sub_u32 s86, 256, s4
  s_add_u32 s85, s4, s68
  s_add_u32 s4, s85, s67
  v_mov_b32 v66, s4
  s_waitcnt vmcnt(0)
  s_barrier
  s_cmp_lg_u32 s66, 0
  s_cbranch_scc1 Lh_70
  s_mov_b64 exec, 1
  s_cmp_eq_u32 s69, 0
  s_cbranch_scc1 Lsl_72
  buffer_store_dword v66, v64, s[36:39], 0 offen
Lsb_73:
  s_mov_b64 exec, -1
  buffer_load_dword v67, v65, s[36:39], 0 offen sc1
  s_waitcnt vmcnt(0)
  v_subrev_u32 v68, s85, v67
  v_cmp_gt_u32 vcc, s86, v68
  s_nop 3
  s_cmp_eq_u64 vcc, exec
  s_cbranch_scc1 Lok_75
  s_mov_b32 s78, 0
Lpoll_74:
  s_add_u32 s78, s78, 1
  s_cmp_gt_u32 s78, 400000
  s_cbranch_scc1 L_exit
  buffer_load_dword v67, v65, s[36:39], 0 offen sc1
  s_waitcnt vmcnt(0)
  v_subrev_u32 v68, s85, v67
  v_cmp_gt_u32 vcc, s86, v68
  s_nop 3
  s_cmp_eq_u64 vcc, exec
  s_cbranch_scc0 Lpoll_74
Lok_75:
  s_branch Lhe_71
Lh_70:
  s_cmp_lg_u32 s70, 0
  s_cbranch_scc1 Li_76
  s_cmp_lg_u32 s66, 1
  s_cbranch_scc1 Lw_78
  s_mov_b32 m0, 33792
  s_add_u32 s79, s50, 0
  buffer_load_dwordx4 v5, s[36:39], s79 offen sc1 lds
  buffer_load_dwordx4 v5, s[36:39], s79 offen offset:1024 sc1 lds
  buffer_load_dwordx4 v5, s[36:39], s79 offen offset:2048 sc1 lds
  buffer_load_dwordx4 v5, s[36:39], s79 offen offset:3072 sc1 lds
  s_mov_b32 m0, 45056
  s_add_u32 s79, s50, 11264
  buffer_load_dwordx4 v5, s[36:39], s79 offen sc1 lds
  buffer_load_dwordx4 v5, s[36:39], s79 offen offset:1024 sc1 lds
  buffer_load_dwordx4 v5, s[36:39], s79 offen offset:2048 sc1 lds
  buffer_load_dwordx4 v5, s[36:39], s79 offen offset:3072 sc1 lds
  s_branch Lwe_77
Lw_78:
  s_cmp_lg_u32 s66, 2
  s_cbranch_scc1 Lw_79
  s_mov_b32 m0, 37888
  s_add_u32 s79, s50, 4096
  buffer_load_dwordx4 v5, s[36:39], s79 offen sc1 lds
  buffer_load_dwordx4 v5, s[36:39], s79 offen offset:1024 sc1 lds
  buffer_load_dwordx4 v5, s[36:39], s79 offen offset:2048 sc1 lds
  buffer_load_dwordx4 v5, s[36:39], s79 offen offset:3072 sc1 lds
  s_mov_b32 m0, 49152
  s_add_u32 s79, s50, 15360
  buffer_load_dwordx4 v5, s[36:39], s79 offen sc1 lds
  buffer_load_dwordx4 v5, s[36:39], s79 offen offset:1024 sc1 lds
  buffer_load_dwordx4 v5, s[36:39], s79 offen offset:2048 sc1 lds
  buffer_load_dwordx4 v5, s[36:39], s79 offen offset:3072 sc1 lds
  s_branch Lwe_77
Lw_79:
  s_cmp_lg_u32 s66, 3
  s_cbranch_scc1 Lw_80
  s_mov_b32 m0, 41984
  s_add_u32 s79, s50, 8192
  buffer_load_dwordx4 v5, s[36:39], s79 offen sc1 lds
  buffer_load_dwordx4 v5, s[36:39], s79 offen offset:1024 sc1 lds
  buffer_load_dwordx4 v5, s[36:39], s79 offen offset:2048 sc1 lds
  s_mov_b32 m0, 53248
  s_add_u32 s79, s50, 19456
  buffer_load_dwordx4 v5, s[36:39], s79 offen sc1 lds
  buffer_load_dwordx4 v5, s[36:39], s79 offen offset:1024 sc1 lds
  buffer_load_dwordx4 v5, s[36:39], s79 offen offset:2048 sc1 lds
Lw_80:
Lwe_77:
Li_76:
  s_cmp_lg_u32 s66, 1
  s_cbranch_scc1 Lw_82
  s_mov_b32 m0, 56320
  s_add_u32 s79, s50, 22528
  buffer_load_dwordx4 v5, s[36:39], s79 offen sc1 lds
  buffer_load_dwordx4 v5, s[36:39], s79 offen offset:1024 sc1 lds
  buffer_load_dwordx4 v5, s[36:39], s79 offen offset:2048 sc1 lds
  buffer_load_dwordx4 v5, s[36:39], s79 offen offset:3072 sc1 lds
  s_mov_b32 m0, 67584
  s_add_u32 s79, s50, 33792
  buffer_load_dwordx4 v5, s[36:39], s79 offen sc1 lds
  buffer_load_dwordx4 v5, s[36:39], s79 offen offset:1024 sc1 lds
  buffer_load_dwordx4 v5, s[36:39], s79 offen offset:2048 sc1 lds
  buffer_load_dwordx4 v5, s[36:39], s79 offen offset:3072 sc1 lds
  s_branch Lwe_81
Lw_82:
  s_cmp_lg_u32 s66, 2
  s_cbranch_scc1 Lw_83
  s_mov_b32 m0, 60416
  s_add_u32 s79, s50, 26624
  buffer_load_dwordx4 v5, s[36:39], s79 offen sc1 lds
  buffer_load_dwordx4 v5, s[36:39], s79 offen offset:1024 sc1 lds
  buffer_load_dwordx4 v5, s[36:39], s79 offen offset:2048 sc1 lds
  buffer_load_dwordx4 v5, s[36:39], s79 offen offset:3072 sc1 lds
  s_mov_b32 m0, 71680
  s_add_u32 s79, s50, 37888
  buffer_load_dwordx4 v5, s[36:39], s79 offen sc1 lds
  buffer_load_dwordx4 v5, s[36:39], s79 offen offset:1024 sc1 lds
  buffer_load_dwordx4 v5, s[36:39], s79 offen offset:2048 sc1 lds
  buffer_load_dwordx4 v5, s[36:39], s79 offen offset:3072 sc1 lds
  s_branch Lwe_81
Lw_83:
  s_cmp_lg_u32 s66, 3
  s_cbranch_scc1 Lw_84
  s_mov_b32 m0, 64512
  s_add_u32 s79, s50, 30720
  buffer_load_dwordx4 v5, s[36:39], s79 offen sc1 lds
  buffer_load_dwordx4 v5, s[36:39], s79 offen offset:1024 sc1 lds
  buffer_load_dwordx4 v5, s[36:39], s79 offen offset:2048 sc1 lds
  s_mov_b32 m0, 75776
  s_add_u32 s79, s50, 41984
  buffer_load_dwordx4 v5, s[36:39], s79 offen sc1 lds
  buffer_load_dwordx4 v5, s[36:39], s79 offen offset:1024 sc1 lds
  buffer_load_dwordx4 v5, s[36:39], s79 offen offset:2048 sc1 lds
Lw_84:
Lwe_81:
  s_cmp_lg_u32 s70, 0
  s_cbranch_scc1 Li_85
  v_lshlrev_b32 v68, 10, v3
  v_lshlrev_b32 v69, 4, v4
  v_add_u32 v68, v68, v69
  s_lshl_b32 s3, s65, 14
  s_add_u32 s3, s3, 131072
  s_sub_u32 s4, s66, 1
  s_lshl_b32 s4, s4, 6
  s_add_u32 s3, s3, s4
  buffer_load_dwordx4 v[70:73], v68, s[36:39], s3 offen offset:0 sc1
  buffer_load_dwordx4 v[74:77], v68, s[36:39], s3 offen offset:192 sc1
  buffer_load_dwordx4 v[78:81], v68, s[36:39], s3 offen offset:384 sc1
  buffer_load_dwordx4 v[82:85], v68, s[36:39], s3 offen offset:576 sc1
Li_85:
Lhe_71:
  s_barrier
  s_lshl_b32 s4, s71, 16
  s_add_u32 s85, s4, s63
  s_lshl_b32 s4, s74, 13
  s_add_u32 s85, s85, s4
  s_add_u32 s85, s85, 0
  s_lshl_b32 s4, s73, 1
  s_add_u32 s5, s4, s74
  s_mul_i32 s5, s5, 16384
  s_add_u32 s86, s85, s5
  s_add_u32 s4, s4, 1
  s_sub_u32 s4, s4, s74
  s_mul_i32 s5, s4, 16384
  s_add_u32 s87, s85, s5
  buffer_load_dwordx4 a[0:3], v5, s[36:39], s86 offen offset:0 sc1
  buffer_load_dwordx4 a[32:35], v5, s[36:39], s87 offen offset:0 sc1
  buffer_load_dwordx4 a[4:7], v5, s[36:39], s86 offen offset:1024 sc1
  buffer_load_dwordx4 a[36:39], v5, s[36:39], s87 offen offset:1024 sc1
  buffer_load_dwordx4 a[8:11], v5, s[36:39], s86 offen offset:2048 sc1
  buffer_load_dwordx4 a[40:43], v5, s[36:39], s87 offen offset:2048 sc1
  buffer_load_dwordx4 a[12:15], v5, s[36:39], s86 offen offset:3072 sc1
  buffer_load_dwordx4 a[44:47], v5, s[36:39], s87 offen offset:3072 sc1
  v_add_u32 v114, 65536, v32
  v_add_u32 v115, 65536, v33
  v_add_u32 v116, 65536, v34
  v_add_u32 v117, 65536, v35
  v_add_u32 v118, 131072, v32
  v_add_u32 v119, 131072, v33
  v_add_u32 v120, 131072, v34
  v_add_u32 v121, 131072, v35
  ds_read_b64_tr_b16 a[64:65], v114 offset:61440
  ds_read_b64_tr_b16 a[66:67], v114 offset:63488
  ds_read_b64_tr_b16 a[68:69], v115 offset:61440
  ds_read_b64_tr_b16 a[70:71], v115 offset:63488
  ds_read_b64_tr_b16 a[72:73], v116 offset:61440
  ds_read_b64_tr_b16 a[74:75], v116 offset:63488
  s_waitcnt vmcnt(6)
  s_waitcnt lgkmcnt(4)
  v_mfma_f32_16x16x32_bf16 v[66:69], a[64:67], a[0:3], 0
  ds_read_b64_tr_b16 a[76:77], v117 offset:61440
  s_add_u32 s86, s86, 4096
  buffer_load_dwordx4 a[16:19], v5, s[36:39], s86 offen offset:0 sc1
  v_mfma_f32_16x16x32_bf16 v[98:101], a[64:67], a[32:35], 0
  ds_read_b64_tr_b16 a[78:79], v117 offset:63488
  s_waitcnt lgkmcnt(4)
  v_mfma_f32_16x16x32_bf16 v[86:89], a[68:71], a[0:3], 0
  ds_read_b64_tr_b16 a[64:65], v118 offset:4096
  v_mfma_f32_16x16x32_bf16 v[102:105], a[68:71], a[32:35], 0
  ds_read_b64_tr_b16 a[66:67], v118 offset:6144
  s_waitcnt lgkmcnt(4)
  v_mfma_f32_16x16x32_bf16 v[90:93], a[72:75], a[0:3], 0
  ds_read_b64_tr_b16 a[68:69], v119 offset:4096
  s_add_u32 s87, s87, 4096
  buffer_load_dwordx4 a[48:51], v5, s[36:39], s87 offen offset:0 sc1
  v_mfma_f32_16x16x32_bf16 v[106:109], a[72:75], a[32:35], 0
  ds_read_b64_tr_b16 a[70:71], v119 offset:6144
  s_waitcnt lgkmcnt(4)
  v_mfma_f32_16x16x32_bf16 v[94:97], a[76:79], a[0:3], 0
  ds_read_b64_tr_b16 a[72:73], v120 offset:4096
  v_mfma_f32_16x16x32_bf16 v[110:113], a[76:79], a[32:35], 0
  ds_read_b64_tr_b16 a[74:75], v120 offset:6144
  s_waitcnt vmcnt(6) lgkmcnt(4)
  v_mfma_f32_16x16x32_bf16 v[66:69], a[64:67], a[4:7], v[66:69]
  ds_read_b64_tr_b16 a[76:77], v121 offset:4096
  buffer_load_dwordx4 a[20:23], v5, s[36:39], s86 offen offset:1024 sc1
  v_mfma_f32_16x16x32_bf16 v[98:101], a[64:67], a[36:39], v[98:101]
  ds_read_b64_tr_b16 a[78:79], v121 offset:6144
  s_waitcnt lgkmcnt(4)
  v_mfma_f32_16x16x32_bf16 v[86:89], a[68:71], a[4:7], v[86:89]
  ds_read_b64_tr_b16 a[64:65], v118 offset:12288
  v_mfma_f32_16x16x32_bf16 v[102:105], a[68:71], a[36:39], v[102:105]
  ds_read_b64_tr_b16 a[66:67], v118 offset:14336
  s_waitcnt lgkmcnt(4)
  v_mfma_f32_16x16x32_bf16 v[90:93], a[72:75], a[4:7], v[90:93]
  ds_read_b64_tr_b16 a[68:69], v119 offset:12288
  buffer_load_dwordx4 a[52:55], v5, s[36:39], s87 offen offset:1024 sc1
  v_mfma_f32_16x16x32_bf16 v[106:109], a[72:75], a[36:39], v[106:109]
  ds_read_b64_tr_b16 a[70:71], v119 offset:14336
  s_waitcnt lgkmcnt(4)
  v_mfma_f32_16x16x32_bf16 v[94:97], a[76:79], a[4:7], v[94:97]
  ds_read_b64_tr_b16 a[72:73], v120 offset:12288
  v_mfma_f32_16x16x32_bf16 v[110:113], a[76:79], a[36:39], v[110:113]
  ds_read_b64_tr_b16 a[74:75], v120 offset:14336
  s_waitcnt vmcnt(6) lgkmcnt(4)
  v_mfma_f32_16x16x32_bf16 v[66:69], a[64:67], a[8:11], v[66:69]
  ds_read_b64_tr_b16 a[76:77], v121 offset:12288
  buffer_load_dwordx4 a[24:27], v5, s[36:39], s86 offen offset:2048 sc1
  v_mfma_f32_16x16x32_bf16 v[98:101], a[64:67], a[40:43], v[98:101]
  ds_read_b64_tr_b16 a[78:79], v121 offset:14336
  s_waitcnt lgkmcnt(4)
  v_mfma_f32_16x16x32_bf16 v[86:89], a[68:71], a[8:11], v[86:89]
  ds_read_b64_tr_b16 a[64:65], v118 offset:20480
  v_mfma_f32_16x16x32_bf16 v[102:105], a[68:71], a[40:43], v[102:105]
  ds_read_b64_tr_b16 a[66:67], v118 offset:22528
  s_waitcnt lgkmcnt(4)
  v_mfma_f32_16x16x32_bf16 v[90:93], a[72:75], a[8:11], v[90:93]
  ds_read_b64_tr_b16 a[68:69], v119 offset:20480
  buffer_load_dwordx4 a[56:59], v5, s[36:39], s87 offen offset:2048 sc1
  v_mfma_f32_16x16x32_bf16 v[106:109], a[72:75], a[40:43], v[106:109]
  ds_read_b64_tr_b16 a[70:71], v119 offset:22528
  s_waitcnt lgkmcnt(4)
  v_mfma_f32_16x16x32_bf16 v[94:97], a[76:79], a[8:11], v[94:97]
  ds_read_b64_tr_b16 a[72:73], v120 offset:20480
  v_mfma_f32_16x16x32_bf16 v[110:113], a[76:79], a[40:43], v[110:113]
  ds_read_b64_tr_b16 a[74:75], v120 offset:22528
  s_waitcnt lgkmcnt(4)
  s_barrier
  s_waitcnt vmcnt(6)
  v_mfma_f32_16x16x32_bf16 v[66:69], a[64:67], a[12:15], v[66:69]
  ds_read_b64_tr_b16 a[76:77], v121 offset:20480
  buffer_load_dwordx4 a[28:31], v5, s[36:39], s86 offen offset:3072 sc1
  v_mfma_f32_16x16x32_bf16 v[98:101], a[64:67], a[44:47], v[98:101]
  ds_read_b64_tr_b16 a[78:79], v121 offset:22528
  s_waitcnt lgkmcnt(4)
  v_mfma_f32_16x16x32_bf16 v[86:89], a[68:71], a[12:15], v[86:89]
  ds_read_b64_tr_b16 a[64:65], v32 offset:0
  v_mfma_f32_16x16x32_bf16 v[102:105], a[68:71], a[44:47], v[102:105]
  ds_read_b64_tr_b16 a[66:67], v32 offset:2048
  s_waitcnt lgkmcnt(4)
  v_mfma_f32_16x16x32_bf16 v[90:93], a[72:75], a[12:15], v[90:93]
  ds_read_b64_tr_b16 a[68:69], v33 offset:0
  buffer_load_dwordx4 a[60:63], v5, s[36:39], s87 offen offset:3072 sc1
  v_mfma_f32_16x16x32_bf16 v[106:109], a[72:75], a[44:47], v[106:109]
  ds_read_b64_tr_b16 a[70:71], v33 offset:2048
  s_waitcnt lgkmcnt(4)
  v_mfma_f32_16x16x32_bf16 v[94:97], a[76:79], a[12:15], v[94:97]
  ds_read_b64_tr_b16 a[72:73], v34 offset:0
  v_mfma_f32_16x16x32_bf16 v[110:113], a[76:79], a[44:47], v[110:113]
  ds_read_b64_tr_b16 a[74:75], v34 offset:2048
  s_waitcnt vmcnt(6) lgkmcnt(4)
  v_mfma_f32_16x16x32_bf16 v[66:69], a[64:67], a[16:19], v[66:69]
  ds_read_b64_tr_b16 a[76:77], v35 offset:0
  v_mfma_f32_16x16x32_bf16 v[98:101], a[64:67], a[48:51], v[98:101]
  ds_read_b64_tr_b16 a[78:79], v35 offset:2048
  s_waitcnt lgkmcnt(4)
  v_mfma_f32_16x16x32_bf16 v[86:89], a[68:71], a[16:19], v[86:89]
  ds_read_b64_tr_b16 a[64:65], v32 offset:8192
  v_mfma_f32_16x16x32_bf16 v[102:105], a[68:71], a[48:51], v[102:105]
  ds_read_b64_tr_b16 a[66:67], v32 offset:10240
  s_waitcnt lgkmcnt(4)
  v_mfma_f32_16x16x32_bf16 v[90:93], a[72:75], a[16:19], v[90:93]
  ds_read_b64_tr_b16 a[68:69], v33 offset:8192
  v_mfma_f32_16x16x32_bf16 v[106:109], a[72:75], a[48:51], v[106:109]
  ds_read_b64_tr_b16 a[70:71], v33 offset:10240
  s_waitcnt lgkmcnt(4)
  v_mfma_f32_16x16x32_bf16 v[94:97], a[76:79], a[16:19], v[94:97]
  ds_read_b64_tr_b16 a[72:73], v34 offset:8192
  v_mfma_f32_16x16x32_bf16 v[110:113], a[76:79], a[48:51], v[110:113]
  ds_read_b64_tr_b16 a[74:75], v34 offset:10240
  s_waitcnt vmcnt(4) lgkmcnt(4)
  v_mfma_f32_16x16x32_bf16 v[66:69], a[64:67], a[20:23], v[66:69]
  ds_read_b64_tr_b16 a[76:77], v35 offset:8192
  v_mfma_f32_16x16x32_bf16 v[98:101], a[64:67], a[52:55], v[98:101]
  ds_read_b64_tr_b16 a[78:79], v35 offset:10240
  s_waitcnt lgkmcnt(4)
  v_mfma_f32_16x16x32_bf16 v[86:89], a[68:71], a[20:23], v[86:89]
  ds_read_b64_tr_b16 a[64:65], v32 offset:16384
  v_mfma_f32_16x16x32_bf16 v[102:105], a[68:71], a[52:55], v[102:105]
  ds_read_b64_tr_b16 a[66:67], v32 offset:18432
  s_waitcnt lgkmcnt(4)
  v_mfma_f32_16x16x32_bf16 v[90:93], a[72:75], a[20:23], v[90:93]
  ds_read_b64_tr_b16 a[68:69], v33 offset:16384
  v_mfma_f32_16x16x32_bf16 v[106:109], a[72:75], a[52:55], v[106:109]
  ds_read_b64_tr_b16 a[70:71], v33 offset:18432
  s_waitcnt lgkmcnt(4)
  v_mfma_f32_16x16x32_bf16 v[94:97], a[76:79], a[20:23], v[94:97]
  ds_read_b64_tr_b16 a[72:73], v34 offset:16384
  v_mfma_f32_16x16x32_bf16 v[110:113], a[76:79], a[52:55], v[110:113]
  ds_read_b64_tr_b16 a[74:75], v34 offset:18432
  s_waitcnt vmcnt(2) lgkmcnt(4)
  v_mfma_f32_16x16x32_bf16 v[66:69], a[64:67], a[24:27], v[66:69]
  ds_read_b64_tr_b16 a[76:77], v35 offset:16384
  v_mfma_f32_16x16x32_bf16 v[98:101], a[64:67], a[56:59], v[98:101]
  ds_read_b64_tr_b16 a[78:79], v35 offset:18432
  s_waitcnt lgkmcnt(4)
  v_mfma_f32_16x16x32_bf16 v[86:89], a[68:71], a[24:27], v[86:89]
  ds_read_b64_tr_b16 a[64:65], v32 offset:24576
  v_mfma_f32_16x16x32_bf16 v[102:105], a[68:71], a[56:59], v[102:105]
  ds_read_b64_tr_b16 a[66:67], v32 offset:26624
  s_waitcnt lgkmcnt(4)
  v_mfma_f32_16x16x32_bf16 v[90:93], a[72:75], a[24:27], v[90:93]
  ds_read_b64_tr_b16 a[68:69], v33 offset:24576
  v_mfma_f32_16x16x32_bf16 v[106:109], a[72:75], a[56:59], v[106:109]
  ds_read_b64_tr_b16 a[70:71], v33 offset:26624
  s_waitcnt lgkmcnt(4)
  v_mfma_f32_16x16x32_bf16 v[94:97], a[76:79], a[24:27], v[94:97]
  ds_read_b64_tr_b16 a[72:73], v34 offset:24576
  v_mfma_f32_16x16x32_bf16 v[110:113], a[76:79], a[56:59], v[110:113]
  ds_read_b64_tr_b16 a[74:75], v34 offset:26624
  s_waitcnt vmcnt(0) lgkmcnt(4)
  v_mfma_f32_16x16x32_bf16 v[66:69], a[64:67], a[28:31], v[66:69]
  ds_read_b64_tr_b16 a[76:77], v35 offset:24576
  v_mfma_f32_16x16x32_bf16 v[98:101], a[64:67], a[60:63], v[98:101]
  ds_read_b64_tr_b16 a[78:79], v35 offset:26624
  s_waitcnt lgkmcnt(4)
  v_mfma_f32_16x16x32_bf16 v[86:89], a[68:71], a[28:31], v[86:89]
  v_mfma_f32_16x16x32_bf16 v[102:105], a[68:71], a[60:63], v[102:105]
  s_waitcnt lgkmcnt(2)
  v_mfma_f32_16x16x32_bf16 v[90:93], a[72:75], a[28:31], v[90:93]
  v_mfma_f32_16x16x32_bf16 v[106:109], a[72:75], a[60:63], v[106:109]
  s_waitcnt lgkmcnt(0)
  v_mfma_f32_16x16x32_bf16 v[94:97], a[76:79], a[28:31], v[94:97]
  v_mfma_f32_16x16x32_bf16 v[110:113], a[76:79], a[60:63], v[110:113]
  s_add_u32 s4, s82, 126976
  v_add_u32 v114, s4, v5
  s_add_u32 m0, s52, 78848
  s_add_u32 s79, s53, 45056
  buffer_load_dwordx4 v5, s[36:39], s79 offen sc1 lds
  ds_write_b128 v114, v[98:101] offset:0
  ds_write_b128 v114, v[102:105] offset:1024
  buffer_load_dwordx4 v5, s[36:39], s79 offen offset:1024 sc1 lds
  ds_write_b128 v114, v[106:109] offset:2048
  ds_write_b128 v114, v[110:113] offset:3072
  buffer_load_dwordx4 v5, s[36:39], s79 offen offset:2048 sc1 lds
  s_xor_b32 s4, s82, 4096
  s_add_u32 s4, s4, 126976
  s_add_u32 m0, s52, 90112
  s_add_u32 s79, s53, 56320
  buffer_load_dwordx4 v5, s[36:39], s79 offen sc1 lds
  v_add_u32 v115, s4, v5
  v_pk_add_f32 v[66:67], v[66:67], v[48:49]
  buffer_load_dwordx4 v5, s[36:39], s79 offen offset:1024 sc1 lds
  v_pk_add_f32 v[68:69], v[68:69], v[50:51]
  v_pk_add_f32 v[86:87], v[86:87], v[52:53]
  buffer_load_dwordx4 v5, s[36:39], s79 offen offset:2048 sc1 lds
  v_pk_add_f32 v[88:89], v[88:89], v[54:55]
  v_pk_add_f32 v[90:91], v[90:91], v[56:57]
  s_add_u32 m0, s52, 101376
  s_add_u32 s79, s53, 67584
  buffer_load_dwordx4 v5, s[36:39], s79 offen sc1 lds
  v_pk_add_f32 v[92:93], v[92:93], v[58:59]
  v_pk_add_f32 v[94:95], v[94:95], v[60:61]
  buffer_load_dwordx4 v5, s[36:39], s79 offen offset:1024 sc1 lds
  v_pk_add_f32 v[96:97], v[96:97], v[62:63]
  buffer_load_dwordx4 v5, s[36:39], s79 offen offset:2048 sc1 lds
  s_waitcnt lgkmcnt(0)
  s_barrier
  ds_read_b128 v[98:101], v115 offset:0
  ds_read_b128 v[102:105], v115 offset:1024
  ds_read_b128 v[106:109], v115 offset:2048
  ds_read_b128 v[110:113], v115 offset:3072
  s_waitcnt lgkmcnt(3)
  v_pk_add_f32 v[66:67], v[66:67], v[98:99]
  v_pk_add_f32 v[68:69], v[68:69], v[100:101]
  v_cvt_pk_bf16_f32 v116, v66, v67
  v_cvt_pk_bf16_f32 v117, v68, v69
  s_waitcnt lgkmcnt(2)
  v_pk_add_f32 v[86:87], v[86:87], v[102:103]
  v_pk_add_f32 v[88:89], v[88:89], v[104:105]
  v_cvt_pk_bf16_f32 v118, v86, v87
  v_cvt_pk_bf16_f32 v119, v88, v89
  s_waitcnt lgkmcnt(1)
  v_pk_add_f32 v[90:91], v[90:91], v[106:107]
  v_pk_add_f32 v[92:93], v[92:93], v[108:109]
  v_cvt_pk_bf16_f32 v120, v90, v91
  v_cvt_pk_bf16_f32 v121, v92, v93
  s_waitcnt lgkmcnt(0)
  v_pk_add_f32 v[94:95], v[94:95], v[110:111]
  v_pk_add_f32 v[96:97], v[96:97], v[112:113]
  v_cvt_pk_bf16_f32 v122, v94, v95
  v_cvt_pk_bf16_f32 v123, v96, v97
  s_cmp_eq_u32 s69, 0
  s_cbranch_scc1 Lsl_86
  buffer_store_dwordx4 v[116:119], v5, s[36:39], s61 offen
  buffer_store_dwordx4 v[120:123], v5, s[36:39], s61 offen offset:1024
Lsb_87:
  v_dot2_f32_bf16 v66, v116, v6, v10
  v_dot2_f32_bf16 v67, v116, v116, v10
  v_dot2_f32_bf16 v68, v120, v6, v10
  v_dot2_f32_bf16 v69, v120, v120, v10
  v_dot2_f32_bf16 v66, v117, v6, v66
  v_dot2_f32_bf16 v67, v117, v117, v67
  v_dot2_f32_bf16 v68, v121, v6, v68
  v_dot2_f32_bf16 v69, v121, v121, v69
  v_dot2_f32_bf16 v66, v118, v6, v66
  v_dot2_f32_bf16 v67, v118, v118, v67
  v_dot2_f32_bf16 v68, v122, v6, v68
  v_dot2_f32_bf16 v69, v122, v122, v69
  v_dot2_f32_bf16 v66, v119, v6, v66
  v_dot2_f32_bf16 v67, v119, v119, v67
  v_dot2_f32_bf16 v68, v123, v6, v68
  v_dot2_f32_bf16 v69, v123, v123, v69
  s_nop 1
  v_add_f32 v66, v66, v68
  v_add_f32 v67, v67, v69
  s_nop 1
  v_permlane32_swap_b32 v66, v67
  v_add_f32 v66, v66, v67
  v_mov_b32 v67, v66
  s_nop 1
  v_permlane16_swap_b32 v66, v67
  v_add_f32 v86, v66, v67
  s_cmp_eq_u32 s69, 0
  s_cbranch_scc1 Lsl_88
  buffer_store_dword v86, v14, s[36:39], s62 offen
Lsb_89:
  s_add_u32 s4, s83, 3
  s_lshl_b32 s4, s4, 4
  s_sub_u32 s86, 256, s4
  s_add_u32 s85, s4, s68
  s_add_u32 s4, s85, s67
  v_mov_b32 v66, s4
  s_waitcnt vmcnt(0)
  s_barrier
  s_cmp_lg_u32 s66, 0
  s_cbranch_scc1 Lh_90
  s_mov_b64 exec, 1
  s_cmp_eq_u32 s69, 0
  s_cbranch_scc1 Lsl_92
  buffer_store_dword v66, v64, s[36:39], 0 offen
Lsb_93:
  s_mov_b64 exec, -1
  buffer_load_dword v67, v65, s[36:39], 0 offen sc1
  v_lshlrev_b32 v48, 16, v116
  v_and_b32 v49, 4294901760, v116
  v_lshlrev_b32 v50, 16, v117
  v_and_b32 v51, 4294901760, v117
  v_lshlrev_b32 v52, 16, v118
  v_and_b32 v53, 4294901760, v118
  v_lshlrev_b32 v54, 16, v119
  v_and_b32 v55, 4294901760, v119
  v_lshlrev_b32 v56, 16, v120
  v_and_b32 v57, 4294901760, v120
  v_lshlrev_b32 v58, 16, v121
  v_and_b32 v59, 4294901760, v121
  v_lshlrev_b32 v60, 16, v122
  v_and_b32 v61, 4294901760, v122
  v_lshlrev_b32 v62, 16, v123
  v_and_b32 v63, 4294901760, v123
  s_waitcnt vmcnt(0)
  v_subrev_u32 v68, s85, v67
  v_cmp_gt_u32 vcc, s86, v68
  s_nop 3
  s_cmp_eq_u64 vcc, exec
  s_cbranch_scc1 Lok_95
  s_mov_b32 s78, 0
Lpoll_94:
  s_add_u32 s78, s78, 1
  s_cmp_gt_u32 s78, 400000
  s_cbranch_scc1 L_exit
  buffer_load_dword v67, v65, s[36:39], 0 offen sc1
  s_waitcnt vmcnt(0)
  v_subrev_u32 v68, s85, v67
  v_cmp_gt_u32 vcc, s86, v68
  s_nop 3
  s_cmp_eq_u64 vcc, exec
  s_cbranch_scc0 Lpoll_94
Lok_95:
  s_branch Lhe_91
Lh_90:
  s_cmp_lg_u32 s66, 1
  s_cbranch_scc1 Lw_97
  s_mov_b32 m0, 112640
  s_add_u32 s79, s50, 78848
  buffer_load_dwordx4 v5, s[36:39], s79 offen sc1 lds
  buffer_load_dwordx4 v5, s[36:39], s79 offen offset:1024 sc1 lds
  buffer_load_dwordx4 v5, s[36:39], s79 offen offset:2048 sc1 lds
  buffer_load_dwordx4 v5, s[36:39], s79 offen offset:3072 sc1 lds
  s_branch Lwe_96
Lw_97:
  s_cmp_lg_u32 s66, 2
  s_cbranch_scc1 Lw_98
  s_mov_b32 m0, 116736
  s_add_u32 s79, s50, 82944
  buffer_load_dwordx4 v5, s[36:39], s79 offen sc1 lds
  buffer_load_dwordx4 v5, s[36:39], s79 offen offset:1024 sc1 lds
  buffer_load_dwordx4 v5, s[36:39], s79 offen offset:2048 sc1 lds
  buffer_load_dwordx4 v5, s[36:39], s79 offen offset:3072 sc1 lds
  s_branch Lwe_96
Lw_98:
  s_cmp_lg_u32 s66, 3
  s_cbranch_scc1 Lw_99
  s_mov_b32 m0, 120832
  s_add_u32 s79, s50, 87040
  buffer_load_dwordx4 v5, s[36:39], s79 offen sc1 lds
  buffer_load_dwordx4 v5, s[36:39], s79 offen offset:1024 sc1 lds
  buffer_load_dwordx4 v5, s[36:39], s79 offen offset:2048 sc1 lds
Lw_99:
Lwe_96:
  v_lshlrev_b32 v48, 16, v116
  v_and_b32 v49, 4294901760, v116
  v_lshlrev_b32 v50, 16, v117
  v_and_b32 v51, 4294901760, v117
  v_lshlrev_b32 v52, 16, v118
  v_and_b32 v53, 4294901760, v118
  v_lshlrev_b32 v54, 16, v119
  v_and_b32 v55, 4294901760, v119
  v_lshlrev_b32 v56, 16, v120
  v_and_b32 v57, 4294901760, v120
  v_lshlrev_b32 v58, 16, v121
  v_and_b32 v59, 4294901760, v121
  v_lshlrev_b32 v60, 16, v122
  v_and_b32 v61, 4294901760, v122
  v_lshlrev_b32 v62, 16, v123
  v_and_b32 v63, 4294901760, v123
  s_cmp_lg_u32 s70, 0
  s_cbranch_scc1 Li_100
  v_add_f32_dpp v70, v70, v70 row_ror:8 row_mask:0xf bank_mask:0xf
  v_add_f32_dpp v71, v71, v71 row_ror:8 row_mask:0xf bank_mask:0xf
  v_add_f32_dpp v72, v72, v72 row_ror:8 row_mask:0xf bank_mask:0xf
  v_add_f32_dpp v73, v73, v73 row_ror:8 row_mask:0xf bank_mask:0xf
  v_add_f32_dpp v74, v74, v74 row_ror:8 row_mask:0xf bank_mask:0xf
  v_add_f32_dpp v75, v75, v75 row_ror:8 row_mask:0xf bank_mask:0xf
  v_add_f32_dpp v76, v76, v76 row_ror:8 row_mask:0xf bank_mask:0xf
  v_add_f32_dpp v77, v77, v77 row_ror:8 row_mask:0xf bank_mask:0xf
  v_add_f32_dpp v78, v78, v78 row_ror:8 row_mask:0xf bank_mask:0xf
  v_add_f32_dpp v79, v79, v79 row_ror:8 row_mask:0xf bank_mask:0xf
  v_add_f32_dpp v80, v80, v80 row_ror:8 row_mask:0xf bank_mask:0xf
  v_add_f32_dpp v81, v81, v81 row_ror:8 row_mask:0xf bank_mask:0xf
  v_add_f32_dpp v82, v82, v82 row_ror:8 row_mask:0xf bank_mask:0xf
  v_add_f32_dpp v83, v83, v83 row_ror:8 row_mask:0xf bank_mask:0xf
  v_add_f32_dpp v84, v84, v84 row_ror:8 row_mask:0xf bank_mask:0xf
  v_add_f32_dpp v85, v85, v85 row_ror:8 row_mask:0xf bank_mask:0xf
  v_add_f32_dpp v70, v70, v70 row_ror:4 row_mask:0xf bank_mask:0xf
  v_add_f32_dpp v71, v71, v71 row_ror:4 row_mask:0xf bank_mask:0xf
  v_add_f32_dpp v72, v72, v72 row_ror:4 row_mask:0xf bank_mask:0xf
  v_add_f32_dpp v73, v73, v73 row_ror:4 row_mask:0xf bank_mask:0xf
  v_add_f32_dpp v74, v74, v74 row_ror:4 row_mask:0xf bank_mask:0xf
  v_add_f32_dpp v75, v75, v75 row_ror:4 row_mask:0xf bank_mask:0xf
  v_add_f32_dpp v76, v76, v76 row_ror:4 row_mask:0xf bank_mask:0xf
  v_add_f32_dpp v77, v77, v77 row_ror:4 row_mask:0xf bank_mask:0xf
  v_add_f32_dpp v78, v78, v78 row_ror:4 row_mask:0xf bank_mask:0xf
  v_add_f32_dpp v79, v79, v79 row_ror:4 row_mask:0xf bank_mask:0xf
  v_add_f32_dpp v80, v80, v80 row_ror:4 row_mask:0xf bank_mask:0xf
  v_add_f32_dpp v81, v81, v81 row_ror:4 row_mask:0xf bank_mask:0xf
  v_add_f32_dpp v82, v82, v82 row_ror:4 row_mask:0xf bank_mask:0xf
  v_add_f32_dpp v83, v83, v83 row_ror:4 row_mask:0xf bank_mask:0xf
  v_add_f32_dpp v84, v84, v84 row_ror:4 row_mask:0xf bank_mask:0xf
  v_add_f32_dpp v85, v85, v85 row_ror:4 row_mask:0xf bank_mask:0xf
  v_add_f32_dpp v70, v70, v70 row_ror:2 row_mask:0xf bank_mask:0xf
  v_add_f32_dpp v71, v71, v71 row_ror:2 row_mask:0xf bank_mask:0xf
  v_add_f32_dpp v72, v72, v72 row_ror:2 row_mask:0xf bank_mask:0xf
  v_add_f32_dpp v73, v73, v73 row_ror:2 row_mask:0xf bank_mask:0xf
  v_add_f32_dpp v74, v74, v74 row_ror:2 row_mask:0xf bank_mask:0xf
  v_add_f32_dpp v75, v75, v75 row_ror:2 row_mask:0xf bank_mask:0xf
  v_add_f32_dpp v76, v76, v76 row_ror:2 row_mask:0xf bank_mask:0xf
  v_add_f32_dpp v77, v77, v77 row_ror:2 row_mask:0xf bank_mask:0xf
  v_add_f32_dpp v78, v78, v78 row_ror:2 row_mask:0xf bank_mask:0xf
  v_add_f32_dpp v79, v79, v79 row_ror:2 row_mask:0xf bank_mask:0xf
  v_add_f32_dpp v80, v80, v80 row_ror:2 row_mask:0xf bank_mask:0xf
  v_add_f32_dpp v81, v81, v81 row_ror:2 row_mask:0xf bank_mask:0xf
  v_add_f32_dpp v82, v82, v82 row_ror:2 row_mask:0xf bank_mask:0xf
  v_add_f32_dpp v83, v83, v83 row_ror:2 row_mask:0xf bank_mask:0xf
  v_add_f32_dpp v84, v84, v84 row_ror:2 row_mask:0xf bank_mask:0xf
  v_add_f32_dpp v85, v85, v85 row_ror:2 row_mask:0xf bank_mask:0xf
  v_add_f32_dpp v70, v70, v70 row_ror:1 row_mask:0xf bank_mask:0xf
  v_add_f32_dpp v71, v71, v71 row_ror:1 row_mask:0xf bank_mask:0xf
  v_add_f32_dpp v72, v72, v72 row_ror:1 row_mask:0xf bank_mask:0xf
  v_add_f32_dpp v73, v73, v73 row_ror:1 row_mask:0xf bank_mask:0xf
  v_add_f32_dpp v74, v74, v74 row_ror:1 row_mask:0xf bank_mask:0xf
  v_add_f32_dpp v75, v75, v75 row_ror:1 row_mask:0xf bank_mask:0xf
  v_add_f32_dpp v76, v76, v76 row_ror:1 row_mask:0xf bank_mask:0xf
  v_add_f32_dpp v77, v77, v77 row_ror:1 row_mask:0xf bank_mask:0xf
  v_add_f32_dpp v78, v78, v78 row_ror:1 row_mask:0xf bank_mask:0xf
  v_add_f32_dpp v79, v79, v79 row_ror:1 row_mask:0xf bank_mask:0xf
  v_add_f32_dpp v80, v80, v80 row_ror:1 row_mask:0xf bank_mask:0xf
  v_add_f32_dpp v81, v81, v81 row_ror:1 row_mask:0xf bank_mask:0xf
  v_add_f32_dpp v82, v82, v82 row_ror:1 row_mask:0xf bank_mask:0xf
  v_add_f32_dpp v83, v83, v83 row_ror:1 row_mask:0xf bank_mask:0xf
  v_add_f32_dpp v84, v84, v84 row_ror:1 row_mask:0xf bank_mask:0xf
  v_add_f32_dpp v85, v85, v85 row_ror:1 row_mask:0xf bank_mask:0xf
  v_lshlrev_b32 v68, 4, v4
  s_sub_u32 s4, s66, 1
  s_lshl_b32 s4, s4, 6
  s_add_u32 s4, s4, 159744
  v_add_u32 v68, s4, v68
  s_mov_b32 exec_lo, 65537
  s_mov_b32 exec_hi, 65537
  ds_write_b128 v68, v[70:73] offset:384
  ds_write_b128 v68, v[74:77] offset:576
  ds_write_b128 v68, v[78:81] offset:768
  s_cmp_eq_u32 s66, 3
  s_cbranch_scc1 Lw_101
  ds_write_b128 v68, v[82:85] offset:960
Lw_101:
  s_mov_b64 exec, -1
  s_waitcnt lgkmcnt(0)
Li_100:
Lhe_91:
  s_barrier
  s_lshl_b32 s4, s66, 15
  s_add_u32 s85, s4, s57
  s_add_u32 s85, s85, 16384
  s_add_u32 s86, s85, 16384
  buffer_load_dwordx4 a[0:3], v5, s[36:39], s85 offen offset:0 sc1
  buffer_load_dwordx4 a[64:67], v5, s[36:39], s86 offen offset:0 sc1
  buffer_load_dwordx4 a[4:7], v5, s[36:39], s85 offen offset:1024 sc1
  buffer_load_dwordx4 a[68:71], v5, s[36:39], s86 offen offset:1024 sc1
  buffer_load_dwordx4 a[8:11], v5, s[36:39], s85 offen offset:2048 sc1
  buffer_load_dwordx4 a[72:75], v5, s[36:39], s86 offen offset:2048 sc1
  s_lshl_b32 s4, s66, 11
  s_add_u32 s87, s4, s60
  s_add_u32 s87, s87, 1024
  v_add_u32 v162, 65536, v5
  v_add_u32 v163, 131072, v5
  ds_read_b128 a[128:131], v5 offset:33792
  ds_read_b128 a[132:135], v5 offset:34816
  ds_read_b128 a[136:139], v5 offset:35840
  ds_read_b128 a[140:143], v5 offset:36864
  ds_read_b128 a[144:147], v5 offset:37888
  ds_read_b128 a[148:151], v5 offset:38912
  ds_read_b128 a[152:155], v5 offset:39936
  ds_read_b128 a[156:159], v5 offset:40960
  ds_read_b128 a[160:163], v5 offset:41984
  ds_read_b128 a[164:167], v5 offset:43008
  s_waitcnt vmcnt(4)
  s_waitcnt lgkmcnt(9)
  v_mfma_f32_16x16x32_bf16 v[66:69], a[128:131], a[0:3], 0
  ds_read_b128 a[168:171], v5 offset:44032
  buffer_load_dwordx4 a[12:15], v5, s[36:39], s85 offen offset:3072 sc1
  v_mfma_f32_16x16x32_bf16 v[110:113], a[128:131], a[64:67], 0
  s_waitcnt lgkmcnt(9)
  v_mfma_f32_16x16x32_bf16 v[70:73], a[132:135], a[0:3], 0
  ds_read_b128 a[128:131], v5 offset:45056
  v_mfma_f32_16x16x32_bf16 v[114:117], a[132:135], a[64:67], 0
  s_waitcnt lgkmcnt(9)
  v_mfma_f32_16x16x32_bf16 v[74:77], a[136:139], a[0:3], 0
  ds_read_b128 a[132:135], v5 offset:46080
  buffer_load_dwordx4 a[76:79], v5, s[36:39], s86 offen offset:3072 sc1
  v_mfma_f32_16x16x32_bf16 v[118:121], a[136:139], a[64:67], 0
  s_waitcnt lgkmcnt(9)
  v_mfma_f32_16x16x32_bf16 v[78:81], a[140:143], a[0:3], 0
  ds_read_b128 a[136:139], v5 offset:47104
  v_mfma_f32_16x16x32_bf16 v[122:125], a[140:143], a[64:67], 0
  s_waitcnt lgkmcnt(9)
  v_mfma_f32_16x16x32_bf16 v[82:85], a[144:147], a[0:3], 0
  ds_read_b128 a[140:143], v5 offset:48128
  s_add_u32 m0, s52, 0
  s_add_u32 s79, s53, 90112
  buffer_load_dwordx4 v5, s[36:39], s79 offen sc1 lds
  v_mfma_f32_16x16x32_bf16 v[126:129], a[144:147], a[64:67], 0
  s_waitcnt lgkmcnt(9)
  v_mfma_f32_16x16x32_bf16 v[86:89], a[148:151], a[0:3], 0
  ds_read_b128 a[144:147], v5 offset:49152
  v_mfma_f32_16x16x32_bf16 v[130:133], a[148:151], a[64:67], 0
  s_waitcnt lgkmcnt(9)
  v_mfma_f32_16x16x32_bf16 v[90:93], a[152:155], a[0:3], 0
  ds_read_b128 a[148:151], v5 offset:50176
  buffer_load_dwordx4 v5, s[36:39], s79 offen offset:1024 sc1 lds
  v_mfma_f32_16x16x32_bf16 v[134:137], a[152:155], a[64:67], 0
  s_waitcnt lgkmcnt(9)
  v_mfma_f32_16x16x32_bf16 v[94:97], a[156:159], a[0:3], 0
  ds_read_b128 a[152:155], v5 offset:51200
  v_mfma_f32_16x16x32_bf16 v[138:141], a[156:159], a[64:67], 0
  s_waitcnt lgkmcnt(9)
  v_mfma_f32_16x16x32_bf16 v[98:101], a[160:163], a[0:3], 0
  ds_read_b128 a[156:159], v5 offset:52224
  buffer_load_dwordx4 v5, s[36:39], s79 offen offset:2048 sc1 lds
  v_mfma_f32_16x16x32_bf16 v[142:145], a[160:163], a[64:67], 0
  s_waitcnt lgkmcnt(9)
  v_mfma_f32_16x16x32_bf16 v[102:105], a[164:167], a[0:3], 0
  ds_read_b128 a[160:163], v5 offset:53248
  v_mfma_f32_16x16x32_bf16 v[146:149], a[164:167], a[64:67], 0
  s_waitcnt lgkmcnt(9)
  v_mfma_f32_16x16x32_bf16 v[106:109], a[168:171], a[0:3], 0
  ds_read_b128 a[164:167], v5 offset:54272
  v_mfma_f32_16x16x32_bf16 v[150:153], a[168:171], a[64:67], 0
  s_waitcnt vmcnt(7) lgkmcnt(9)
  v_mfma_f32_16x16x32_bf16 v[66:69], a[128:131], a[4:7], v[66:69]
  ds_read_b128 a[168:171], v5 offset:55296
  s_add_u32 s85, s85, 4096
  buffer_load_dwordx4 a[16:19], v5, s[36:39], s85 offen offset:0 sc1
  v_mfma_f32_16x16x32_bf16 v[110:113], a[128:131], a[68:71], v[110:113]
  s_waitcnt lgkmcnt(9)
  v_mfma_f32_16x16x32_bf16 v[70:73], a[132:135], a[4:7], v[70:73]
  ds_read_b128 a[128:131], v5 offset:56320
  v_mfma_f32_16x16x32_bf16 v[114:117], a[132:135], a[68:71], v[114:117]
  s_waitcnt lgkmcnt(9)
  v_mfma_f32_16x16x32_bf16 v[74:77], a[136:139], a[4:7], v[74:77]
  ds_read_b128 a[132:135], v5 offset:57344
  s_add_u32 s86, s86, 4096
  buffer_load_dwordx4 a[80:83], v5, s[36:39], s86 offen offset:0 sc1
  v_mfma_f32_16x16x32_bf16 v[118:121], a[136:139], a[68:71], v[118:121]
  s_waitcnt lgkmcnt(9)
  v_mfma_f32_16x16x32_bf16 v[78:81], a[140:143], a[4:7], v[78:81]
  ds_read_b128 a[136:139], v5 offset:58368
  v_mfma_f32_16x16x32_bf16 v[122:125], a[140:143], a[68:71], v[122:125]
  s_waitcnt lgkmcnt(9)
  v_mfma_f32_16x16x32_bf16 v[82:85], a[144:147], a[4:7], v[82:85]
  ds_read_b128 a[140:143], v5 offset:59392
  s_add_u32 m0, s52, 11264
  s_add_u32 s79, s53, 101376
  buffer_load_dwordx4 v5, s[36:39], s79 offen sc1 lds
  v_mfma_f32_16x16x32_bf16 v[126:129], a[144:147], a[68:71], v[126:129]
  s_waitcnt lgkmcnt(9)
  v_mfma_f32_16x16x32_bf16 v[86:89], a[148:151], a[4:7], v[86:89]
  ds_read_b128 a[144:147], v5 offset:60416
  v_mfma_f32_16x16x32_bf16 v[130:133], a[148:151], a[68:71], v[130:133]
  s_waitcnt lgkmcnt(9)
  v_mfma_f32_16x16x32_bf16 v[90:93], a[152:155], a[4:7], v[90:93]
  ds_read_b128 a[148:151], v5 offset:61440
  buffer_load_dwordx4 v5, s[36:39], s79 offen offset:1024 sc1 lds
  v_mfma_f32_16x16x32_bf16 v[134:137], a[152:155], a[68:71], v[134:137]
  s_waitcnt lgkmcnt(9)
  v_mfma_f32_16x16x32_bf16 v[94:97], a[156:159], a[4:7], v[94:97]
  ds_read_b128 a[152:155], v5 offset:62464
  v_mfma_f32_16x16x32_bf16 v[138:141], a[156:159], a[68:71], v[138:141]
  s_waitcnt lgkmcnt(9)
  v_mfma_f32_16x16x32_bf16 v[98:101], a[160:163], a[4:7], v[98:101]
  ds_read_b128 a[156:159], v5 offset:63488
  buffer_load_dwordx4 v5, s[36:39], s79 offen offset:2048 sc1 lds
  v_mfma_f32_16x16x32_bf16 v[142:145], a[160:163], a[68:71], v[142:145]
  s_waitcnt lgkmcnt(9)
  v_mfma_f32_16x16x32_bf16 v[102:105], a[164:167], a[4:7], v[102:105]
  ds_read_b128 a[160:163], v5 offset:64512
  v_mfma_f32_16x16x32_bf16 v[146:149], a[164:167], a[68:71], v[146:149]
  s_waitcnt lgkmcnt(9)
  v_mfma_f32_16x16x32_bf16 v[106:109], a[168:171], a[4:7], v[106:109]
  ds_read_b128 a[164:167], v162 offset:0
  v_mfma_f32_16x16x32_bf16 v[150:153], a[168:171], a[68:71], v[150:153]
  s_waitcnt vmcnt(10) lgkmcnt(9)
  v_mfma_f32_16x16x32_bf16 v[66:69], a[128:131], a[8:11], v[66:69]
  ds_read_b128 a[168:171], v162 offset:1024
  buffer_load_dwordx4 a[20:23], v5, s[36:39], s85 offen offset:1024 sc1
  v_mfma_f32_16x16x32_bf16 v[110:113], a[128:131], a[72:75], v[110:113]
  s_waitcnt lgkmcnt(9)
  v_mfma_f32_16x16x32_bf16 v[70:73], a[132:135], a[8:11], v[70:73]
  ds_read_b128 a[128:131], v162 offset:2048
  v_mfma_f32_16x16x32_bf16 v[114:117], a[132:135], a[72:75], v[114:117]
  s_waitcnt lgkmcnt(9)
  v_mfma_f32_16x16x32_bf16 v[74:77], a[136:139], a[8:11], v[74:77]
  ds_read_b128 a[132:135], v162 offset:3072
  buffer_load_dwordx4 a[84:87], v5, s[36:39], s86 offen offset:1024 sc1
  v_mfma_f32_16x16x32_bf16 v[118:121], a[136:139], a[72:75], v[118:121]
  s_waitcnt lgkmcnt(9)
  v_mfma_f32_16x16x32_bf16 v[78:81], a[140:143], a[8:11], v[78:81]
  ds_read_b128 a[136:139], v162 offset:4096
  v_mfma_f32_16x16x32_bf16 v[122:125], a[140:143], a[72:75], v[122:125]
  s_waitcnt lgkmcnt(9)
  v_mfma_f32_16x16x32_bf16 v[82:85], a[144:147], a[8:11], v[82:85]
  ds_read_b128 a[140:143], v162 offset:5120
  s_add_u32 m0, s52, 22528
  s_add_u32 s79, s53, 112640
  buffer_load_dwordx4 v5, s[36:39], s79 offen sc1 lds
  v_mfma_f32_16x16x32_bf16 v[126:129], a[144:147], a[72:75], v[126:129]
  s_waitcnt lgkmcnt(9)
  v_mfma_f32_16x16x32_bf16 v[86:89], a[148:151], a[8:11], v[86:89]
  ds_read_b128 a[144:147], v162 offset:6144
  v_mfma_f32_16x16x32_bf16 v[130:133], a[148:151], a[72:75], v[130:133]
  s_waitcnt lgkmcnt(9)
  v_mfma_f32_16x16x32_bf16 v[90:93], a[152:155], a[8:11], v[90:93]
  ds_read_b128 a[148:151], v162 offset:7168
  buffer_load_dwordx4 v5, s[36:39], s79 offen offset:1024 sc1 lds
  v_mfma_f32_16x16x32_bf16 v[134:137], a[152:155], a[72:75], v[134:137]
  s_waitcnt lgkmcnt(9)
  v_mfma_f32_16x16x32_bf16 v[94:97], a[156:159], a[8:11], v[94:97]
  ds_read_b128 a[152:155], v162 offset:8192
  v_mfma_f32_16x16x32_bf16 v[138:141], a[156:159], a[72:75], v[138:141]
  s_waitcnt lgkmcnt(9)
  v_mfma_f32_16x16x32_bf16 v[98:101], a[160:163], a[8:11], v[98:101]
  ds_read_b128 a[156:159], v162 offset:9216
  buffer_load_dwordx4 v5, s[36:39], s79 offen offset:2048 sc1 lds
  v_mfma_f32_16x16x32_bf16 v[142:145], a[160:163], a[72:75], v[142:145]
  s_waitcnt lgkmcnt(9)
  v_mfma_f32_16x16x32_bf16 v[102:105], a[164:167], a[8:11], v[102:105]
  ds_read_b128 a[160:163], v162 offset:10240
  v_mfma_f32_16x16x32_bf16 v[146:149], a[164:167], a[72:75], v[146:149]
  s_waitcnt lgkmcnt(9)
  v_mfma_f32_16x16x32_bf16 v[106:109], a[168:171], a[8:11], v[106:109]
  ds_read_b128 a[164:167], v162 offset:11264
  v_mfma_f32_16x16x32_bf16 v[150:153], a[168:171], a[72:75], v[150:153]
  s_waitcnt vmcnt(13) lgkmcnt(9)
  v_mfma_f32_16x16x32_bf16 v[66:69], a[128:131], a[12:15], v[66:69]
  ds_read_b128 a[168:171], v162 offset:12288
  buffer_load_dwordx4 a[24:27], v5, s[36:39], s85 offen offset:2048 sc1
  v_mfma_f32_16x16x32_bf16 v[110:113], a[128:131], a[76:79], v[110:113]
  s_waitcnt lgkmcnt(9)
  v_mfma_f32_16x16x32_bf16 v[70:73], a[132:135], a[12:15], v[70:73]
  ds_read_b128 a[128:131], v162 offset:13312
  v_mfma_f32_16x16x32_bf16 v[114:117], a[132:135], a[76:79], v[114:117]
  s_waitcnt lgkmcnt(9)
  v_mfma_f32_16x16x32_bf16 v[74:77], a[136:139], a[12:15], v[74:77]
  ds_read_b128 a[132:135], v162 offset:14336
  buffer_load_dwordx4 a[88:91], v5, s[36:39], s86 offen offset:2048 sc1
  v_mfma_f32_16x16x32_bf16 v[118:121], a[136:139], a[76:79], v[118:121]
  s_waitcnt lgkmcnt(9)
  v_mfma_f32_16x16x32_bf16 v[78:81], a[140:143], a[12:15], v[78:81]
  ds_read_b128 a[136:139], v162 offset:15360
  v_mfma_f32_16x16x32_bf16 v[122:125], a[140:143], a[76:79], v[122:125]
  s_waitcnt lgkmcnt(9)
  v_mfma_f32_16x16x32_bf16 v[82:85], a[144:147], a[12:15], v[82:85]
  ds_read_b128 a[140:143], v162 offset:16384
  s_add_u32 m0, s52, 123904
  s_add_u32 s79, s53, 123904
  buffer_load_dwordx4 v5, s[36:39], s79 offen sc1 lds
  v_mfma_f32_16x16x32_bf16 v[126:129], a[144:147], a[76:79], v[126:129]
  s_waitcnt lgkmcnt(9)
  v_mfma_f32_16x16x32_bf16 v[86:89], a[148:151], a[12:15], v[86:89]
  ds_read_b128 a[144:147], v162 offset:17408
  v_mfma_f32_16x16x32_bf16 v[130:133], a[148:151], a[76:79], v[130:133]
  s_waitcnt lgkmcnt(9)
  v_mfma_f32_16x16x32_bf16 v[90:93], a[152:155], a[12:15], v[90:93]
  ds_read_b128 a[148:151], v162 offset:18432
  buffer_load_dwordx4 v5, s[36:39], s79 offen offset:1024 sc1 lds
  v_mfma_f32_16x16x32_bf16 v[134:137], a[152:155], a[76:79], v[134:137]
  s_waitcnt lgkmcnt(9)
  v_mfma_f32_16x16x32_bf16 v[94:97], a[156:159], a[12:15], v[94:97]
  ds_read_b128 a[152:155], v162 offset:19456
  v_mfma_f32_16x16x32_bf16 v[138:141], a[156:159], a[76:79], v[138:141]
  s_waitcnt lgkmcnt(9)
  v_mfma_f32_16x16x32_bf16 v[98:101], a[160:163], a[12:15], v[98:101]
  ds_read_b128 a[156:159], v162 offset:20480
  buffer_load_dwordx4 v5, s[36:39], s79 offen offset:2048 sc1 lds
  v_mfma_f32_16x16x32_bf16 v[142:145], a[160:163], a[76:79], v[142:145]
  s_waitcnt lgkmcnt(9)
  v_mfma_f32_16x16x32_bf16 v[102:105], a[164:167], a[12:15], v[102:105]
  ds_read_b128 a[160:163], v162 offset:21504
  v_mfma_f32_16x16x32_bf16 v[146:149], a[164:167], a[76:79], v[146:149]
  s_waitcnt lgkmcnt(9)
  v_mfma_f32_16x16x32_bf16 v[106:109], a[168:171], a[12:15], v[106:109]
  ds_read_b128 a[164:167], v162 offset:22528
  v_mfma_f32_16x16x32_bf16 v[150:153], a[168:171], a[76:79], v[150:153]
  s_waitcnt vmcnt(13) lgkmcnt(9)
  v_mfma_f32_16x16x32_bf16 v[66:69], a[128:131], a[16:19], v[66:69]
  ds_read_b128 a[168:171], v162 offset:23552
  buffer_load_dwordx4 a[28:31], v5, s[36:39], s85 offen offset:3072 sc1
  v_mfma_f32_16x16x32_bf16 v[110:113], a[128:131], a[80:83], v[110:113]
  s_waitcnt lgkmcnt(9)
  v_mfma_f32_16x16x32_bf16 v[70:73], a[132:135], a[16:19], v[70:73]
  ds_read_b128 a[128:131], v162 offset:24576
  v_mfma_f32_16x16x32_bf16 v[114:117], a[132:135], a[80:83], v[114:117]
  s_waitcnt lgkmcnt(9)
  v_mfma_f32_16x16x32_bf16 v[74:77], a[136:139], a[16:19], v[74:77]
  ds_read_b128 a[132:135], v162 offset:25600
  buffer_load_dwordx4 a[92:95], v5, s[36:39], s86 offen offset:3072 sc1
  v_mfma_f32_16x16x32_bf16 v[118:121], a[136:139], a[80:83], v[118:121]
  s_waitcnt lgkmcnt(9)
  v_mfma_f32_16x16x32_bf16 v[78:81], a[140:143], a[16:19], v[78:81]
  ds_read_b128 a[136:139], v162 offset:26624
  v_mfma_f32_16x16x32_bf16 v[122:125], a[140:143], a[80:83], v[122:125]
  s_waitcnt lgkmcnt(9)
  v_mfma_f32_16x16x32_bf16 v[82:85], a[144:147], a[16:19], v[82:85]
  ds_read_b128 a[140:143], v162 offset:27648
  s_add_u32 m0, s52, 135168
  s_add_u32 s79, s53, 135168
  buffer_load_dwordx4 v5, s[36:39], s79 offen sc1 lds
  v_mfma_f32_16x16x32_bf16 v[126:129], a[144:147], a[80:83], v[126:129]
  s_waitcnt lgkmcnt(9)
  v_mfma_f32_16x16x32_bf16 v[86:89], a[148:151], a[16:19], v[86:89]
  ds_read_b128 a[144:147], v162 offset:28672
  v_mfma_f32_16x16x32_bf16 v[130:133], a[148:151], a[80:83], v[130:133]
  s_waitcnt lgkmcnt(9)
  v_mfma_f32_16x16x32_bf16 v[90:93], a[152:155], a[16:19], v[90:93]
  ds_read_b128 a[148:151], v162 offset:29696
  buffer_load_dwordx4 v5, s[36:39], s79 offen offset:1024 sc1 lds
  v_mfma_f32_16x16x32_bf16 v[134:137], a[152:155], a[80:83], v[134:137]
  s_waitcnt lgkmcnt(9)
  v_mfma_f32_16x16x32_bf16 v[94:97], a[156:159], a[16:19], v[94:97]
  ds_read_b128 a[152:155], v162 offset:30720
  v_mfma_f32_16x16x32_bf16 v[138:141], a[156:159], a[80:83], v[138:141]
  s_waitcnt lgkmcnt(9)
  v_mfma_f32_16x16x32_bf16 v[98:101], a[160:163], a[16:19], v[98:101]
  ds_read_b128 a[156:159], v162 offset:31744
  buffer_load_dwordx4 v5, s[36:39], s79 offen offset:2048 sc1 lds
  v_mfma_f32_16x16x32_bf16 v[142:145], a[160:163], a[80:83], v[142:145]
  s_waitcnt lgkmcnt(9)
  v_mfma_f32_16x16x32_bf16 v[102:105], a[164:167], a[16:19], v[102:105]
  ds_read_b128 a[160:163], v162 offset:32768
  v_mfma_f32_16x16x32_bf16 v[146:149], a[164:167], a[80:83], v[146:149]
  s_waitcnt lgkmcnt(9)
  v_mfma_f32_16x16x32_bf16 v[106:109], a[168:171], a[16:19], v[106:109]
  ds_read_b128 a[164:167], v162 offset:33792
  v_mfma_f32_16x16x32_bf16 v[150:153], a[168:171], a[80:83], v[150:153]
  s_waitcnt vmcnt(13) lgkmcnt(9)
  v_mfma_f32_16x16x32_bf16 v[66:69], a[128:131], a[20:23], v[66:69]
  ds_read_b128 a[168:171], v162 offset:34816
  s_add_u32 s85, s85, 4096
  buffer_load_dwordx4 a[32:35], v5, s[36:39], s85 offen offset:0 sc1
  v_mfma_f32_16x16x32_bf16 v[110:113], a[128:131], a[84:87], v[110:113]
  s_waitcnt lgkmcnt(9)
  v_mfma_f32_16x16x32_bf16 v[70:73], a[132:135], a[20:23], v[70:73]
  ds_read_b128 a[128:131], v162 offset:35840
  v_mfma_f32_16x16x32_bf16 v[114:117], a[132:135], a[84:87], v[114:117]
  s_waitcnt lgkmcnt(9)
  v_mfma_f32_16x16x32_bf16 v[74:77], a[136:139], a[20:23], v[74:77]
  ds_read_b128 a[132:135], v162 offset:36864
  s_add_u32 s86, s86, 4096
  buffer_load_dwordx4 a[96:99], v5, s[36:39], s86 offen offset:0 sc1
  v_mfma_f32_16x16x32_bf16 v[118:121], a[136:139], a[84:87], v[118:121]
  s_waitcnt lgkmcnt(9)
  v_mfma_f32_16x16x32_bf16 v[78:81], a[140:143], a[20:23], v[78:81]
  ds_read_b128 a[136:139], v162 offset:37888
  v_mfma_f32_16x16x32_bf16 v[122:125], a[140:143], a[84:87], v[122:125]
  s_waitcnt lgkmcnt(9)
  v_mfma_f32_16x16x32_bf16 v[82:85], a[144:147], a[20:23], v[82:85]
  ds_read_b128 a[140:143], v162 offset:38912
  s_add_u32 m0, s52, 146432
  s_add_u32 s79, s53, 146432
  buffer_load_dwordx4 v5, s[36:39], s79 offen sc1 lds
  v_mfma_f32_16x16x32_bf16 v[126:129], a[144:147], a[84:87], v[126:129]
  s_waitcnt lgkmcnt(9)
  v_mfma_f32_16x16x32_bf16 v[86:89], a[148:151], a[20:23], v[86:89]
  ds_read_b128 a[144:147], v162 offset:39936
  v_mfma_f32_16x16x32_bf16 v[130:133], a[148:151], a[84:87], v[130:133]
  s_waitcnt lgkmcnt(9)
  v_mfma_f32_16x16x32_bf16 v[90:93], a[152:155], a[20:23], v[90:93]
  ds_read_b128 a[148:151], v162 offset:40960
  buffer_load_dwordx4 v5, s[36:39], s79 offen offset:1024 sc1 lds
  v_mfma_f32_16x16x32_bf16 v[134:137], a[152:155], a[84:87], v[134:137]
  s_waitcnt lgkmcnt(9)
  v_mfma_f32_16x16x32_bf16 v[94:97], a[156:159], a[20:23], v[94:97]
  ds_read_b128 a[152:155], v162 offset:41984
  v_mfma_f32_16x16x32_bf16 v[138:141], a[156:159], a[84:87], v[138:141]
  s_waitcnt lgkmcnt(9)
  v_mfma_f32_16x16x32_bf16 v[98:101], a[160:163], a[20:23], v[98:101]
  ds_read_b128 a[156:159], v162 offset:43008
  buffer_load_dwordx4 v5, s[36:39], s79 offen offset:2048 sc1 lds
  v_mfma_f32_16x16x32_bf16 v[142:145], a[160:163], a[84:87], v[142:145]
  s_waitcnt lgkmcnt(9)
  v_mfma_f32_16x16x32_bf16 v[102:105], a[164:167], a[20:23], v[102:105]
  ds_read_b128 a[160:163], v162 offset:44032
  v_mfma_f32_16x16x32_bf16 v[146:149], a[164:167], a[84:87], v[146:149]
  s_waitcnt lgkmcnt(9)
  v_mfma_f32_16x16x32_bf16 v[106:109], a[168:171], a[20:23], v[106:109]
  ds_read_b128 a[164:167], v162 offset:45056
  v_mfma_f32_16x16x32_bf16 v[150:153], a[168:171], a[84:87], v[150:153]
  s_waitcnt lgkmcnt(9)
  s_barrier
  s_waitcnt vmcnt(13)
  v_mfma_f32_16x16x32_bf16 v[66:69], a[128:131], a[24:27], v[66:69]
  ds_read_b128 a[168:171], v162 offset:46080
  buffer_load_dwordx4 a[36:39], v5, s[36:39], s85 offen offset:1024 sc1
  v_mfma_f32_16x16x32_bf16 v[110:113], a[128:131], a[88:91], v[110:113]
  s_waitcnt lgkmcnt(9)
  v_mfma_f32_16x16x32_bf16 v[70:73], a[132:135], a[24:27], v[70:73]
  ds_read_b128 a[128:131], v162 offset:47104
  v_mfma_f32_16x16x32_bf16 v[114:117], a[132:135], a[88:91], v[114:117]
  s_waitcnt lgkmcnt(9)
  v_mfma_f32_16x16x32_bf16 v[74:77], a[136:139], a[24:27], v[74:77]
  ds_read_b128 a[132:135], v162 offset:48128
  buffer_load_dwordx4 a[100:103], v5, s[36:39], s86 offen offset:1024 sc1
  v_mfma_f32_16x16x32_bf16 v[118:121], a[136:139], a[88:91], v[118:121]
  s_waitcnt lgkmcnt(9)
  v_mfma_f32_16x16x32_bf16 v[78:81], a[140:143], a[24:27], v[78:81]
  ds_read_b128 a[136:139], v162 offset:49152
  v_mfma_f32_16x16x32_bf16 v[122:125], a[140:143], a[88:91], v[122:125]
  s_waitcnt lgkmcnt(9)
  v_mfma_f32_16x16x32_bf16 v[82:85], a[144:147], a[24:27], v[82:85]
  ds_read_b128 a[140:143], v162 offset:50176
  s_add_u32 m0, s52, 33792
  s_add_u32 s79, s53, 157696
  buffer_load_dwordx4 v5, s[36:39], s79 offen sc1 lds
  v_mfma_f32_16x16x32_bf16 v[126:129], a[144:147], a[88:91], v[126:129]
  s_waitcnt lgkmcnt(9)
  v_mfma_f32_16x16x32_bf16 v[86:89], a[148:151], a[24:27], v[86:89]
  ds_read_b128 a[144:147], v162 offset:51200
  v_mfma_f32_16x16x32_bf16 v[130:133], a[148:151], a[88:91], v[130:133]
  s_waitcnt lgkmcnt(9)
  v_mfma_f32_16x16x32_bf16 v[90:93], a[152:155], a[24:27], v[90:93]
  ds_read_b128 a[148:151], v162 offset:52224
  buffer_load_dwordx4 v5, s[36:39], s79 offen offset:1024 sc1 lds
  v_mfma_f32_16x16x32_bf16 v[134:137], a[152:155], a[88:91], v[134:137]
  s_waitcnt lgkmcnt(9)
  v_mfma_f32_16x16x32_bf16 v[94:97], a[156:159], a[24:27], v[94:97]
  ds_read_b128 a[152:155], v162 offset:53248
  v_mfma_f32_16x16x32_bf16 v[138:141], a[156:159], a[88:91], v[138:141]
  s_waitcnt lgkmcnt(9)
  v_mfma_f32_16x16x32_bf16 v[98:101], a[160:163], a[24:27], v[98:101]
  ds_read_b128 a[156:159], v162 offset:54272
  buffer_load_dwordx4 v5, s[36:39], s79 offen offset:2048 sc1 lds
  v_mfma_f32_16x16x32_bf16 v[142:145], a[160:163], a[88:91], v[142:145]
  s_waitcnt lgkmcnt(9)
  v_mfma_f32_16x16x32_bf16 v[102:105], a[164:167], a[24:27], v[102:105]
  ds_read_b128 a[160:163], v162 offset:55296
  v_mfma_f32_16x16x32_bf16 v[146:149], a[164:167], a[88:91], v[146:149]
  s_waitcnt lgkmcnt(9)
  v_mfma_f32_16x16x32_bf16 v[106:109], a[168:171], a[24:27], v[106:109]
  ds_read_b128 a[164:167], v162 offset:56320
  v_mfma_f32_16x16x32_bf16 v[150:153], a[168:171], a[88:91], v[150:153]
  s_waitcnt vmcnt(13) lgkmcnt(9)
  v_mfma_f32_16x16x32_bf16 v[66:69], a[128:131], a[28:31], v[66:69]
  ds_read_b128 a[168:171], v162 offset:57344
  buffer_load_dwordx4 a[40:43], v5, s[36:39], s85 offen offset:2048 sc1
  v_mfma_f32_16x16x32_bf16 v[110:113], a[128:131], a[92:95], v[110:113]
  s_waitcnt lgkmcnt(9)
  v_mfma_f32_16x16x32_bf16 v[70:73], a[132:135], a[28:31], v[70:73]
  ds_read_b128 a[128:131], v5 offset:0
  v_mfma_f32_16x16x32_bf16 v[114:117], a[132:135], a[92:95], v[114:117]
  s_waitcnt lgkmcnt(9)
  v_mfma_f32_16x16x32_bf16 v[74:77], a[136:139], a[28:31], v[74:77]
  ds_read_b128 a[132:135], v5 offset:1024
  buffer_load_dwordx4 a[104:107], v5, s[36:39], s86 offen offset:2048 sc1
  v_mfma_f32_16x16x32_bf16 v[118:121], a[136:139], a[92:95], v[118:121]
  s_waitcnt lgkmcnt(9)
  v_mfma_f32_16x16x32_bf16 v[78:81], a[140:143], a[28:31], v[78:81]
  ds_read_b128 a[136:139], v5 offset:2048
  v_mfma_f32_16x16x32_bf16 v[122:125], a[140:143], a[92:95], v[122:125]
  s_waitcnt lgkmcnt(9)
  v_mfma_f32_16x16x32_bf16 v[82:85], a[144:147], a[28:31], v[82:85]
  ds_read_b128 a[140:143], v5 offset:3072
  s_add_u32 m0, s52, 45056
  s_add_u32 s79, s53, 168960
  buffer_load_dwordx4 v5, s[36:39], s79 offen sc1 lds
  v_mfma_f32_16x16x32_bf16 v[126:129], a[144:147], a[92:95], v[126:129]
  s_waitcnt lgkmcnt(9)
  v_mfma_f32_16x16x32_bf16 v[86:89], a[148:151], a[28:31], v[86:89]
  ds_read_b128 a[144:147], v5 offset:4096
  v_mfma_f32_16x16x32_bf16 v[130:133], a[148:151], a[92:95], v[130:133]
  s_waitcnt lgkmcnt(9)
  v_mfma_f32_16x16x32_bf16 v[90:93], a[152:155], a[28:31], v[90:93]
  ds_read_b128 a[148:151], v5 offset:5120
  buffer_load_dwordx4 v5, s[36:39], s79 offen offset:1024 sc1 lds
  v_mfma_f32_16x16x32_bf16 v[134:137], a[152:155], a[92:95], v[134:137]
  s_waitcnt lgkmcnt(9)
  v_mfma_f32_16x16x32_bf16 v[94:97], a[156:159], a[28:31], v[94:97]
  ds_read_b128 a[152:155], v5 offset:6144
  v_mfma_f32_16x16x32_bf16 v[138:141], a[156:159], a[92:95], v[138:141]
  s_waitcnt lgkmcnt(9)
  v_mfma_f32_16x16x32_bf16 v[98:101], a[160:163], a[28:31], v[98:101]
  ds_read_b128 a[156:159], v5 offset:7168
  buffer_load_dwordx4 v5, s[36:39], s79 offen offset:2048 sc1 lds
  v_mfma_f32_16x16x32_bf16 v[142:145], a[160:163], a[92:95], v[142:145]
  s_waitcnt lgkmcnt(9)
  v_mfma_f32_16x16x32_bf16 v[102:105], a[164:167], a[28:31], v[102:105]
  ds_read_b128 a[160:163], v5 offset:8192
  v_mfma_f32_16x16x32_bf16 v[146:149], a[164:167], a[92:95], v[146:149]
  s_waitcnt lgkmcnt(9)
  v_mfma_f32_16x16x32_bf16 v[106:109], a[168:171], a[28:31], v[106:109]
  ds_read_b128 a[164:167], v5 offset:9216
  v_mfma_f32_16x16x32_bf16 v[150:153], a[168:171], a[92:95], v[150:153]
  s_waitcnt vmcnt(13) lgkmcnt(9)
  v_mfma_f32_16x16x32_bf16 v[66:69], a[128:131], a[32:35], v[66:69]
  ds_read_b128 a[168:171], v5 offset:10240
  buffer_load_dwordx4 a[44:47], v5, s[36:39], s85 offen offset:3072 sc1
  v_mfma_f32_16x16x32_bf16 v[110:113], a[128:131], a[96:99], v[110:113]
  s_waitcnt lgkmcnt(9)
  v_mfma_f32_16x16x32_bf16 v[70:73], a[132:135], a[32:35], v[70:73]
  ds_read_b128 a[128:131], v5 offset:11264
  v_mfma_f32_16x16x32_bf16 v[114:117], a[132:135], a[96:99], v[114:117]
  s_waitcnt lgkmcnt(9)
  v_mfma_f32_16x16x32_bf16 v[74:77], a[136:139], a[32:35], v[74:77]
  ds_read_b128 a[132:135], v5 offset:12288
  v_mfma_f32_16x16x32_bf16 v[118:121], a[136:139], a[96:99], v[118:121]
  s_waitcnt lgkmcnt(9)
  v_mfma_f32_16x16x32_bf16 v[78:81], a[140:143], a[32:35], v[78:81]
  ds_read_b128 a[136:139], v5 offset:13312
  v_mfma_f32_16x16x32_bf16 v[122:125], a[140:143], a[96:99], v[122:125]
  s_waitcnt lgkmcnt(9)
  v_mfma_f32_16x16x32_bf16 v[82:85], a[144:147], a[32:35], v[82:85]
  ds_read_b128 a[140:143], v5 offset:14336
  v_mfma_f32_16x16x32_bf16 v[126:129], a[144:147], a[96:99], v[126:129]
  s_waitcnt lgkmcnt(9)
  v_mfma_f32_16x16x32_bf16 v[86:89], a[148:151], a[32:35], v[86:89]
  ds_read_b128 a[144:147], v5 offset:15360
  buffer_load_dwordx4 a[108:111], v5, s[36:39], s86 offen offset:3072 sc1
  v_mfma_f32_16x16x32_bf16 v[130:133], a[148:151], a[96:99], v[130:133]
  s_waitcnt lgkmcnt(9)
  v_mfma_f32_16x16x32_bf16 v[90:93], a[152:155], a[32:35], v[90:93]
  ds_read_b128 a[148:151], v5 offset:16384
  v_mfma_f32_16x16x32_bf16 v[134:137], a[152:155], a[96:99], v[134:137]
  s_waitcnt lgkmcnt(9)
  v_mfma_f32_16x16x32_bf16 v[94:97], a[156:159], a[32:35], v[94:97]
  ds_read_b128 a[152:155], v5 offset:17408
  v_mfma_f32_16x16x32_bf16 v[138:141], a[156:159], a[96:99], v[138:141]
  s_waitcnt lgkmcnt(9)
  v_mfma_f32_16x16x32_bf16 v[98:101], a[160:163], a[32:35], v[98:101]
  ds_read_b128 a[156:159], v5 offset:18432
  v_mfma_f32_16x16x32_bf16 v[142:145], a[160:163], a[96:99], v[142:145]
  s_waitcnt lgkmcnt(9)
  v_mfma_f32_16x16x32_bf16 v[102:105], a[164:167], a[32:35], v[102:105]
  ds_read_b128 a[160:163], v5 offset:19456
  v_mfma_f32_16x16x32_bf16 v[146:149], a[164:167], a[96:99], v[146:149]
  s_waitcnt lgkmcnt(9)
  v_mfma_f32_16x16x32_bf16 v[106:109], a[168:171], a[32:35], v[106:109]
  ds_read_b128 a[164:167], v5 offset:20480
  v_mfma_f32_16x16x32_bf16 v[150:153], a[168:171], a[96:99], v[150:153]
  s_waitcnt lgkmcnt(9)
  s_barrier
  s_waitcnt vmcnt(10)
  v_mfma_f32_16x16x32_bf16 v[66:69], a[128:131], a[36:39], v[66:69]
  ds_read_b128 a[168:171], v5 offset:21504
  s_add_u32 s85, s85, 4096
  buffer_load_dwordx4 a[48:51], v5, s[36:39], s85 offen offset:0 sc1
  v_mfma_f32_16x16x32_bf16 v[110:113], a[128:131], a[100:103], v[110:113]
  s_waitcnt lgkmcnt(9)
  v_mfma_f32_16x16x32_bf16 v[70:73], a[132:135], a[36:39], v[70:73]
  ds_read_b128 a[128:131], v5 offset:22528
  v_mfma_f32_16x16x32_bf16 v[114:117], a[132:135], a[100:103], v[114:117]
  s_waitcnt lgkmcnt(9)
  v_mfma_f32_16x16x32_bf16 v[74:77], a[136:139], a[36:39], v[74:77]
  ds_read_b128 a[132:135], v5 offset:23552
  v_mfma_f32_16x16x32_bf16 v[118:121], a[136:139], a[100:103], v[118:121]
  s_waitcnt lgkmcnt(9)
  v_mfma_f32_16x16x32_bf16 v[78:81], a[140:143], a[36:39], v[78:81]
  ds_read_b128 a[136:139], v5 offset:24576
  v_mfma_f32_16x16x32_bf16 v[122:125], a[140:143], a[100:103], v[122:125]
  s_waitcnt lgkmcnt(9)
  v_mfma_f32_16x16x32_bf16 v[82:85], a[144:147], a[36:39], v[82:85]
  ds_read_b128 a[140:143], v5 offset:25600
  v_mfma_f32_16x16x32_bf16 v[126:129], a[144:147], a[100:103], v[126:129]
  s_waitcnt lgkmcnt(9)
  v_mfma_f32_16x16x32_bf16 v[86:89], a[148:151], a[36:39], v[86:89]
  ds_read_b128 a[144:147], v5 offset:26624
  s_add_u32 s86, s86, 4096
  buffer_load_dwordx4 a[112:115], v5, s[36:39], s86 offen offset:0 sc1
  v_mfma_f32_16x16x32_bf16 v[130:133], a[148:151], a[100:103], v[130:133]
  s_waitcnt lgkmcnt(9)
  v_mfma_f32_16x16x32_bf16 v[90:93], a[152:155], a[36:39], v[90:93]
  ds_read_b128 a[148:151], v5 offset:27648
  v_mfma_f32_16x16x32_bf16 v[134:137], a[152:155], a[100:103], v[134:137]
  s_waitcnt lgkmcnt(9)
  v_mfma_f32_16x16x32_bf16 v[94:97], a[156:159], a[36:39], v[94:97]
  ds_read_b128 a[152:155], v5 offset:28672
  v_mfma_f32_16x16x32_bf16 v[138:141], a[156:159], a[100:103], v[138:141]
  s_waitcnt lgkmcnt(9)
  v_mfma_f32_16x16x32_bf16 v[98:101], a[160:163], a[36:39], v[98:101]
  ds_read_b128 a[156:159], v5 offset:29696
  v_mfma_f32_16x16x32_bf16 v[142:145], a[160:163], a[100:103], v[142:145]
  s_waitcnt lgkmcnt(9)
  v_mfma_f32_16x16x32_bf16 v[102:105], a[164:167], a[36:39], v[102:105]
  ds_read_b128 a[160:163], v5 offset:30720
  v_mfma_f32_16x16x32_bf16 v[146:149], a[164:167], a[100:103], v[146:149]
  s_waitcnt lgkmcnt(9)
  v_mfma_f32_16x16x32_bf16 v[106:109], a[168:171], a[36:39], v[106:109]
  ds_read_b128 a[164:167], v5 offset:31744
  v_mfma_f32_16x16x32_bf16 v[150:153], a[168:171], a[100:103], v[150:153]
  s_waitcnt vmcnt(7) lgkmcnt(9)
  v_mfma_f32_16x16x32_bf16 v[66:69], a[128:131], a[40:43], v[66:69]
  ds_read_b128 a[168:171], v5 offset:32768
  buffer_load_dwordx4 a[52:55], v5, s[36:39], s85 offen offset:1024 sc1
  v_mfma_f32_16x16x32_bf16 v[110:113], a[128:131], a[104:107], v[110:113]
  s_waitcnt lgkmcnt(9)
  v_mfma_f32_16x16x32_bf16 v[70:73], a[132:135], a[40:43], v[70:73]
  ds_read_b128 a[128:131], v162 offset:58368
  buffer_load_dwordx4 a[116:119], v5, s[36:39], s86 offen offset:1024 sc1
  v_mfma_f32_16x16x32_bf16 v[114:117], a[132:135], a[104:107], v[114:117]
  s_waitcnt lgkmcnt(9)
  v_mfma_f32_16x16x32_bf16 v[74:77], a[136:139], a[40:43], v[74:77]
  ds_read_b128 a[132:135], v162 offset:59392
  v_mfma_f32_16x16x32_bf16 v[118:121], a[136:139], a[104:107], v[118:121]
  s_waitcnt lgkmcnt(9)
  v_mfma_f32_16x16x32_bf16 v[78:81], a[140:143], a[40:43], v[78:81]
  ds_read_b128 a[136:139], v162 offset:60416
  buffer_load_dword v154, v13, s[36:39], s87 offen offset:0 sc1
  v_mfma_f32_16x16x32_bf16 v[122:125], a[140:143], a[104:107], v[122:125]
  s_waitcnt lgkmcnt(9)
  v_mfma_f32_16x16x32_bf16 v[82:85], a[144:147], a[40:43], v[82:85]
  ds_read_b128 a[140:143], v162 offset:61440
  buffer_load_dword v155, v13, s[36:39], s87 offen offset:256 sc1
  v_mfma_f32_16x16x32_bf16 v[126:129], a[144:147], a[104:107], v[126:129]
  s_waitcnt lgkmcnt(9)
  v_mfma_f32_16x16x32_bf16 v[86:89], a[148:151], a[40:43], v[86:89]
  ds_read_b128 a[144:147], v162 offset:62464
  v_mfma_f32_16x16x32_bf16 v[130:133], a[148:151], a[104:107], v[130:133]
  s_waitcnt lgkmcnt(9)
  v_mfma_f32_16x16x32_bf16 v[90:93], a[152:155], a[40:43], v[90:93]
  ds_read_b128 a[148:151], v162 offset:63488
  buffer_load_dword v156, v13, s[36:39], s87 offen offset:512 sc1
  v_mfma_f32_16x16x32_bf16 v[134:137], a[152:155], a[104:107], v[134:137]
  s_waitcnt lgkmcnt(9)
  v_mfma_f32_16x16x32_bf16 v[94:97], a[156:159], a[40:43], v[94:97]
  ds_read_b128 a[152:155], v162 offset:64512
  buffer_load_dword v157, v13, s[36:39], s87 offen offset:768 sc1
  v_mfma_f32_16x16x32_bf16 v[138:141], a[156:159], a[104:107], v[138:141]
  s_waitcnt lgkmcnt(9)
  v_mfma_f32_16x16x32_bf16 v[98:101], a[160:163], a[40:43], v[98:101]
  ds_read_b128 a[156:159], v163 offset:0
  v_mfma_f32_16x16x32_bf16 v[142:145], a[160:163], a[104:107], v[142:145]
  s_waitcnt lgkmcnt(9)
  v_mfma_f32_16x16x32_bf16 v[102:105], a[164:167], a[40:43], v[102:105]
  ds_read_b128 a[160:163], v163 offset:1024
  s_add_u32 m0, s54, 73728
  s_add_u32 s79, s56, 0
  buffer_load_dwordx4 v24, s[28:31], s79 offen lds
  v_mfma_f32_16x16x32_bf16 v[146:149], a[164:167], a[104:107], v[146:149]
  s_waitcnt lgkmcnt(9)
  v_mfma_f32_16x16x32_bf16 v[106:109], a[168:171], a[40:43], v[106:109]
  ds_read_b128 a[164:167], v163 offset:2048
  v_mfma_f32_16x16x32_bf16 v[150:153], a[168:171], a[104:107], v[150:153]
  s_waitcnt vmcnt(9) lgkmcnt(9)
  v_mfma_f32_16x16x32_bf16 v[66:69], a[128:131], a[44:47], v[66:69]
  ds_read_b128 a[168:171], v163 offset:3072
  buffer_load_dwordx4 a[56:59], v5, s[36:39], s85 offen offset:2048 sc1
  v_mfma_f32_16x16x32_bf16 v[110:113], a[128:131], a[108:111], v[110:113]
  s_waitcnt lgkmcnt(9)
  v_mfma_f32_16x16x32_bf16 v[70:73], a[132:135], a[44:47], v[70:73]
  ds_read_b128 a[128:131], v163 offset:4096
  buffer_load_dwordx4 a[120:123], v5, s[36:39], s86 offen offset:2048 sc1
  v_mfma_f32_16x16x32_bf16 v[114:117], a[132:135], a[108:111], v[114:117]
  s_waitcnt lgkmcnt(9)
  v_mfma_f32_16x16x32_bf16 v[74:77], a[136:139], a[44:47], v[74:77]
  ds_read_b128 a[132:135], v163 offset:5120
  buffer_load_dword v158, v13, s[36:39], s87 offen offset:1024 sc1
  v_mfma_f32_16x16x32_bf16 v[118:121], a[136:139], a[108:111], v[118:121]
  s_waitcnt lgkmcnt(9)
  v_mfma_f32_16x16x32_bf16 v[78:81], a[140:143], a[44:47], v[78:81]
  ds_read_b128 a[136:139], v163 offset:6144
  v_mfma_f32_16x16x32_bf16 v[122:125], a[140:143], a[108:111], v[122:125]
  s_waitcnt lgkmcnt(9)
  v_mfma_f32_16x16x32_bf16 v[82:85], a[144:147], a[44:47], v[82:85]
  ds_read_b128 a[140:143], v163 offset:7168
  buffer_load_dword v159, v13, s[36:39], s87 offen offset:1280 sc1
  v_mfma_f32_16x16x32_bf16 v[126:129], a[144:147], a[108:111], v[126:129]
  s_waitcnt lgkmcnt(9)
  v_mfma_f32_16x16x32_bf16 v[86:89], a[148:151], a[44:47], v[86:89]
  ds_read_b128 a[144:147], v163 offset:8192
  buffer_load_dword v160, v13, s[36:39], s87 offen offset:1536 sc1
  v_mfma_f32_16x16x32_bf16 v[130:133], a[148:151], a[108:111], v[130:133]
  s_waitcnt lgkmcnt(9)
  v_mfma_f32_16x16x32_bf16 v[90:93], a[152:155], a[44:47], v[90:93]
  ds_read_b128 a[148:151], v163 offset:9216
  buffer_load_dword v161, v13, s[36:39], s87 offen offset:1792 sc1
  v_mfma_f32_16x16x32_bf16 v[134:137], a[152:155], a[108:111], v[134:137]
  s_waitcnt lgkmcnt(9)
  v_mfma_f32_16x16x32_bf16 v[94:97], a[156:159], a[44:47], v[94:97]
  ds_read_b128 a[152:155], v163 offset:10240
  v_mfma_f32_16x16x32_bf16 v[138:141], a[156:159], a[108:111], v[138:141]
  s_waitcnt lgkmcnt(9)
  v_mfma_f32_16x16x32_bf16 v[98:101], a[160:163], a[44:47], v[98:101]
  ds_read_b128 a[156:159], v163 offset:11264
  buffer_load_dwordx4 v25, s[28:31], s79 offen offset:1024 lds
  v_mfma_f32_16x16x32_bf16 v[142:145], a[160:163], a[108:111], v[142:145]
  s_waitcnt lgkmcnt(9)
  v_mfma_f32_16x16x32_bf16 v[102:105], a[164:167], a[44:47], v[102:105]
  ds_read_b128 a[160:163], v163 offset:12288
  buffer_load_dwordx4 v26, s[28:31], s79 offen offset:2048 lds
  v_mfma_f32_16x16x32_bf16 v[146:149], a[164:167], a[108:111], v[146:149]
  s_waitcnt lgkmcnt(9)
  v_mfma_f32_16x16x32_bf16 v[106:109], a[168:171], a[44:47], v[106:109]
  ds_read_b128 a[164:167], v163 offset:13312
  v_mfma_f32_16x16x32_bf16 v[150:153], a[168:171], a[108:111], v[150:153]
  s_waitcnt lgkmcnt(9)
  s_barrier
  s_waitcnt vmcnt(15)
  v_mfma_f32_16x16x32_bf16 v[66:69], a[128:131], a[48:51], v[66:69]
  ds_read_b128 a[168:171], v163 offset:14336
  buffer_load_dwordx4 a[60:63], v5, s[36:39], s85 offen offset:3072 sc1
  v_mfma_f32_16x16x32_bf16 v[110:113], a[128:131], a[112:115], v[110:113]
  s_waitcnt lgkmcnt(9)
  v_mfma_f32_16x16x32_bf16 v[70:73], a[132:135], a[48:51], v[70:73]
  ds_read_b128 a[128:131], v163 offset:15360
  v_mfma_f32_16x16x32_bf16 v[114:117], a[132:135], a[112:115], v[114:117]
  s_waitcnt lgkmcnt(9)
  v_mfma_f32_16x16x32_bf16 v[74:77], a[136:139], a[48:51], v[74:77]
  ds_read_b128 a[132:135], v163 offset:16384
  buffer_load_dwordx4 a[124:127], v5, s[36:39], s86 offen offset:3072 sc1
  v_mfma_f32_16x16x32_bf16 v[118:121], a[136:139], a[112:115], v[118:121]
  s_waitcnt lgkmcnt(9)
  v_mfma_f32_16x16x32_bf16 v[78:81], a[140:143], a[48:51], v[78:81]
  ds_read_b128 a[136:139], v163 offset:17408
  v_mfma_f32_16x16x32_bf16 v[122:125], a[140:143], a[112:115], v[122:125]
  s_waitcnt lgkmcnt(9)
  v_mfma_f32_16x16x32_bf16 v[82:85], a[144:147], a[48:51], v[82:85]
  ds_read_b128 a[140:143], v163 offset:18432
  v_mfma_f32_16x16x32_bf16 v[126:129], a[144:147], a[112:115], v[126:129]
  s_waitcnt lgkmcnt(9)
  v_mfma_f32_16x16x32_bf16 v[86:89], a[148:151], a[48:51], v[86:89]
  ds_read_b128 a[144:147], v163 offset:19456
  buffer_load_dwordx4 v27, s[28:31], s79 offen offset:3072 lds
  v_mfma_f32_16x16x32_bf16 v[130:133], a[148:151], a[112:115], v[130:133]
  s_waitcnt lgkmcnt(9)
  v_mfma_f32_16x16x32_bf16 v[90:93], a[152:155], a[48:51], v[90:93]
  ds_read_b128 a[148:151], v163 offset:20480
  v_mfma_f32_16x16x32_bf16 v[134:137], a[152:155], a[112:115], v[134:137]
  s_waitcnt lgkmcnt(9)
  v_mfma_f32_16x16x32_bf16 v[94:97], a[156:159], a[48:51], v[94:97]
  ds_read_b128 a[152:155], v163 offset:21504
  v_mfma_f32_16x16x32_bf16 v[138:141], a[156:159], a[112:115], v[138:141]
  s_waitcnt lgkmcnt(9)
  v_mfma_f32_16x16x32_bf16 v[98:101], a[160:163], a[48:51], v[98:101]
  ds_read_b128 a[156:159], v163 offset:22528
  s_add_u32 m0, s54, 90112
  s_add_u32 s79, s56, 90112
  buffer_load_dwordx4 v24, s[28:31], s79 offen lds
  v_mfma_f32_16x16x32_bf16 v[142:145], a[160:163], a[112:115], v[142:145]
  s_waitcnt lgkmcnt(9)
  v_mfma_f32_16x16x32_bf16 v[102:105], a[164:167], a[48:51], v[102:105]
  ds_read_b128 a[160:163], v163 offset:23552
  v_mfma_f32_16x16x32_bf16 v[146:149], a[164:167], a[112:115], v[146:149]
  s_waitcnt lgkmcnt(9)
  v_mfma_f32_16x16x32_bf16 v[106:109], a[168:171], a[48:51], v[106:109]
  ds_read_b128 a[164:167], v163 offset:24576
  v_mfma_f32_16x16x32_bf16 v[150:153], a[168:171], a[112:115], v[150:153]
  s_waitcnt vmcnt(17) lgkmcnt(9)
  v_mfma_f32_16x16x32_bf16 v[66:69], a[128:131], a[52:55], v[66:69]
  ds_read_b128 a[168:171], v163 offset:25600
  buffer_load_dwordx4 v25, s[28:31], s79 offen offset:1024 lds
  v_mfma_f32_16x16x32_bf16 v[110:113], a[128:131], a[116:119], v[110:113]
  s_waitcnt vmcnt(16)
  v_add_f32 v154, v154, v155
  s_waitcnt lgkmcnt(9)
  v_mfma_f32_16x16x32_bf16 v[70:73], a[132:135], a[52:55], v[70:73]
  ds_read_b128 a[128:131], v5 offset:33792
  s_waitcnt vmcnt(14)
  v_add_f32 v156, v156, v157
  v_mfma_f32_16x16x32_bf16 v[114:117], a[132:135], a[116:119], v[114:117]
  v_add_f32 v154, v154, v156
  s_waitcnt lgkmcnt(9)
  v_mfma_f32_16x16x32_bf16 v[74:77], a[136:139], a[52:55], v[74:77]
  ds_read_b128 a[132:135], v5 offset:34816
  v_mov_b32 v164, v154
  v_mfma_f32_16x16x32_bf16 v[118:121], a[136:139], a[116:119], v[118:121]
  s_nop 0
  v_permlane16_swap_b32 v154, v164
  s_waitcnt lgkmcnt(9)
  v_mfma_f32_16x16x32_bf16 v[78:81], a[140:143], a[52:55], v[78:81]
  ds_read_b128 a[136:139], v5 offset:35840
  buffer_load_dwordx4 v26, s[28:31], s79 offen offset:2048 lds
  v_mfma_f32_16x16x32_bf16 v[122:125], a[140:143], a[116:119], v[122:125]
  v_add_f32 v154, v154, v164
  s_waitcnt lgkmcnt(9)
  v_mfma_f32_16x16x32_bf16 v[82:85], a[144:147], a[52:55], v[82:85]
  ds_read_b128 a[140:143], v5 offset:36864
  v_mov_b32 v164, v154
  v_mfma_f32_16x16x32_bf16 v[126:129], a[144:147], a[116:119], v[126:129]
  s_nop 0
  v_permlane32_swap_b32 v154, v164
  s_waitcnt lgkmcnt(9)
  v_mfma_f32_16x16x32_bf16 v[86:89], a[148:151], a[52:55], v[86:89]
  ds_read_b128 a[144:147], v5 offset:37888
  v_mul_f32 v166, 989855744, v154
  v_mfma_f32_16x16x32_bf16 v[130:133], a[148:151], a[116:119], v[130:133]
  v_mul_f32 v164, 989855744, v164
  s_waitcnt lgkmcnt(9)
  v_mfma_f32_16x16x32_bf16 v[90:93], a[152:155], a[52:55], v[90:93]
  ds_read_b128 a[148:151], v5 offset:38912
  v_fma_f32 v164, -v166, v166, v164
  v_mfma_f32_16x16x32_bf16 v[134:137], a[152:155], a[116:119], v[134:137]
  v_max_f32 v164, 0, v164
  s_waitcnt lgkmcnt(9)
  v_mfma_f32_16x16x32_bf16 v[94:97], a[156:159], a[52:55], v[94:97]
  ds_read_b128 a[152:155], v5 offset:39936
  buffer_load_dwordx4 v27, s[28:31], s79 offen offset:3072 lds
  v_mfma_f32_16x16x32_bf16 v[138:141], a[156:159], a[116:119], v[138:141]
  v_add_f32 v164, 925353388, v164
  s_waitcnt lgkmcnt(9)
  v_mfma_f32_16x16x32_bf16 v[98:101], a[160:163], a[52:55], v[98:101]
  ds_read_b128 a[156:159], v5 offset:40960
  v_rsq_f32 v167, v164
  v_mfma_f32_16x16x32_bf16 v[142:145], a[160:163], a[116:119], v[142:145]
  v_mul_f32 v169, v164, v167
  s_waitcnt lgkmcnt(9)
  v_mfma_f32_16x16x32_bf16 v[102:105], a[164:167], a[52:55], v[102:105]
  ds_read_b128 a[160:163], v5 offset:41984
  v_mul_f32 v168, s59, v167
  v_mfma_f32_16x16x32_bf16 v[146:149], a[164:167], a[116:119], v[146:149]
  s_waitcnt vmcnt(11)
  v_add_f32 v158, v158, v159
  s_waitcnt lgkmcnt(9)
  v_mfma_f32_16x16x32_bf16 v[106:109], a[168:171], a[52:55], v[106:109]
  ds_read_b128 a[164:167], v5 offset:43008
  s_waitcnt vmcnt(9)
  v_add_f32 v160, v160, v161
  v_mfma_f32_16x16x32_bf16 v[150:153], a[168:171], a[116:119], v[150:153]
  v_add_f32 v158, v158, v160
  s_waitcnt lgkmcnt(9)
  v_mfma_f32_16x16x32_bf16 v[66:69], a[128:131], a[56:59], v[66:69]
  ds_read_b128 a[168:171], v5 offset:44032
  s_add_u32 m0, s54, 57344
  s_add_u32 s79, s56, 180224
  buffer_load_dwordx4 v24, s[28:31], s79 offen lds
  v_mfma_f32_16x16x32_bf16 v[110:113], a[128:131], a[120:123], v[110:113]
  v_mov_b32 v164, v158
  s_waitcnt lgkmcnt(9)
  v_mfma_f32_16x16x32_bf16 v[70:73], a[132:135], a[56:59], v[70:73]
  ds_read_b128 a[128:131], v5 offset:45056
  v_permlane16_swap_b32 v158, v164
  v_mfma_f32_16x16x32_bf16 v[114:117], a[132:135], a[120:123], v[114:117]
  v_add_f32 v158, v158, v164
  s_waitcnt lgkmcnt(9)
  v_mfma_f32_16x16x32_bf16 v[74:77], a[136:139], a[56:59], v[74:77]
  ds_read_b128 a[132:135], v5 offset:46080
  buffer_load_dwordx4 v25, s[28:31], s79 offen offset:1024 lds
  v_mfma_f32_16x16x32_bf16 v[118:121], a[136:139], a[120:123], v[118:121]
  v_mov_b32 v164, v158
  s_waitcnt lgkmcnt(9)
  v_mfma_f32_16x16x32_bf16 v[78:81], a[140:143], a[56:59], v[78:81]
  ds_read_b128 a[136:139], v5 offset:47104
  v_permlane32_swap_b32 v158, v164
  v_mfma_f32_16x16x32_bf16 v[122:125], a[140:143], a[120:123], v[122:125]
  v_mul_f32 v170, 989855744, v158
  s_waitcnt lgkmcnt(9)
  v_mfma_f32_16x16x32_bf16 v[82:85], a[144:147], a[56:59], v[82:85]
  ds_read_b128 a[140:143], v5 offset:48128
  v_mul_f32 v164, 989855744, v164
  v_mfma_f32_16x16x32_bf16 v[126:129], a[144:147], a[120:123], v[126:129]
  v_fma_f32 v164, -v170, v170, v164
  s_waitcnt lgkmcnt(9)
  v_mfma_f32_16x16x32_bf16 v[86:89], a[148:151], a[56:59], v[86:89]
  ds_read_b128 a[144:147], v5 offset:49152
  buffer_load_dwordx4 v26, s[28:31], s79 offen offset:2048 lds
  v_mfma_f32_16x16x32_bf16 v[130:133], a[148:151], a[120:123], v[130:133]
  v_max_f32 v164, 0, v164
  s_waitcnt lgkmcnt(9)
  v_mfma_f32_16x16x32_bf16 v[90:93], a[152:155], a[56:59], v[90:93]
  ds_read_b128 a[148:151], v5 offset:50176
  v_add_f32 v164, 925353388, v164
  v_mfma_f32_16x16x32_bf16 v[134:137], a[152:155], a[120:123], v[134:137]
  v_rsq_f32 v171, v164
  s_waitcnt lgkmcnt(9)
  v_mfma_f32_16x16x32_bf16 v[94:97], a[156:159], a[56:59], v[94:97]
  ds_read_b128 a[152:155], v5 offset:51200
  v_mul_f32 v173, v164, v171
  v_mfma_f32_16x16x32_bf16 v[138:141], a[156:159], a[120:123], v[138:141]
  v_mul_f32 v172, s59, v171
  s_waitcnt lgkmcnt(9)
  v_mfma_f32_16x16x32_bf16 v[98:101], a[160:163], a[56:59], v[98:101]
  ds_read_b128 a[156:159], v5 offset:52224
  buffer_load_dwordx4 v27, s[28:31], s79 offen offset:3072 lds
  v_mfma_f32_16x16x32_bf16 v[142:145], a[160:163], a[120:123], v[142:145]
  s_waitcnt lgkmcnt(9)
  v_mfma_f32_16x16x32_bf16 v[102:105], a[164:167], a[56:59], v[102:105]
  ds_read_b128 a[160:163], v5 offset:53248
  v_mfma_f32_16x16x32_bf16 v[146:149], a[164:167], a[120:123], v[146:149]
  s_waitcnt lgkmcnt(9)
  v_mfma_f32_16x16x32_bf16 v[106:109], a[168:171], a[56:59], v[106:109]
  ds_read_b128 a[164:167], v5 offset:54272
  v_mfma_f32_16x16x32_bf16 v[150:153], a[168:171], a[120:123], v[150:153]
  s_waitcnt vmcnt(9) lgkmcnt(9)
  v_mfma_f32_16x16x32_bf16 v[66:69], a[128:131], a[60:63], v[66:69]
  ds_read_b128 a[168:171], v5 offset:55296
  s_add_u32 m0, s54, 106496
  s_add_u32 s79, s56, 270336
  buffer_load_dwordx4 v24, s[28:31], s79 offen lds
  v_mfma_f32_16x16x32_bf16 v[110:113], a[128:131], a[124:127], v[110:113]
  s_waitcnt lgkmcnt(9)
  v_mfma_f32_16x16x32_bf16 v[70:73], a[132:135], a[60:63], v[70:73]
  v_mfma_f32_16x16x32_bf16 v[114:117], a[132:135], a[124:127], v[114:117]
  s_waitcnt lgkmcnt(8)
  v_mfma_f32_16x16x32_bf16 v[74:77], a[136:139], a[60:63], v[74:77]
  buffer_load_dwordx4 v25, s[28:31], s79 offen offset:1024 lds
  v_mfma_f32_16x16x32_bf16 v[118:121], a[136:139], a[124:127], v[118:121]
  s_waitcnt lgkmcnt(7)
  v_mfma_f32_16x16x32_bf16 v[78:81], a[140:143], a[60:63], v[78:81]
  v_mfma_f32_16x16x32_bf16 v[122:125], a[140:143], a[124:127], v[122:125]
  s_waitcnt lgkmcnt(6)
  v_mfma_f32_16x16x32_bf16 v[82:85], a[144:147], a[60:63], v[82:85]
  v_mfma_f32_16x16x32_bf16 v[126:129], a[144:147], a[124:127], v[126:129]
  s_waitcnt lgkmcnt(5)
  v_mfma_f32_16x16x32_bf16 v[86:89], a[148:151], a[60:63], v[86:89]
  buffer_load_dwordx4 v26, s[28:31], s79 offen offset:2048 lds
  v_mfma_f32_16x16x32_bf16 v[130:133], a[148:151], a[124:127], v[130:133]
  s_waitcnt lgkmcnt(4)
  v_mfma_f32_16x16x32_bf16 v[90:93], a[152:155], a[60:63], v[90:93]
  v_mfma_f32_16x16x32_bf16 v[134:137], a[152:155], a[124:127], v[134:137]
  s_waitcnt lgkmcnt(3)
  v_mfma_f32_16x16x32_bf16 v[94:97], a[156:159], a[60:63], v[94:97]
  v_mfma_f32_16x16x32_bf16 v[138:141], a[156:159], a[124:127], v[138:141]
  s_waitcnt lgkmcnt(2)
  v_mfma_f32_16x16x32_bf16 v[98:101], a[160:163], a[60:63], v[98:101]
  buffer_load_dwordx4 v27, s[28:31], s79 offen offset:3072 lds
  v_mfma_f32_16x16x32_bf16 v[142:145], a[160:163], a[124:127], v[142:145]
  s_waitcnt lgkmcnt(1)
  v_mfma_f32_16x16x32_bf16 v[102:105], a[164:167], a[60:63], v[102:105]
  v_mfma_f32_16x16x32_bf16 v[146:149], a[164:167], a[124:127], v[146:149]
  s_waitcnt lgkmcnt(0)
  v_mfma_f32_16x16x32_bf16 v[106:109], a[168:171], a[60:63], v[106:109]
  v_mfma_f32_16x16x32_bf16 v[150:153], a[168:171], a[124:127], v[150:153]
  s_barrier
  v_lshlrev_b32 v162, 4, v4
  v_add_u32 v162, 159744, v162
  s_add_u32 m0, s54, 0
  s_add_u32 s79, s56, 360448
  buffer_load_dwordx4 v24, s[28:31], s79 offen lds
  ds_read_b128 v[182:185], v162 offset:384
  ds_read_b128 v[190:193], v162 offset:448
  s_lshl_b32 s4, s66, 1
  s_mul_i32 s4, s4, 45056
  s_add_u32 s85, s4, s63
  s_add_u32 s85, s85, 131072
  s_add_u32 s86, s85, 45056
  buffer_load_dwordx4 v25, s[28:31], s79 offen offset:1024 lds
  s_mul_i32 s4, s71, 22
  s_lshl_b32 s5, s72, 1
  s_add_u32 s4, s4, s5
  s_lshl_b32 s4, s4, 10
  s_add_u32 s87, s85, s4
  s_add_u32 s88, s86, s4
  ds_read_b128 v[186:189], v162 offset:512
  buffer_load_dwordx4 v26, s[28:31], s79 offen offset:2048 lds
  ds_read_b128 v[194:197], v162 offset:576
  s_waitcnt lgkmcnt(3)
  v_pk_fma_f32 v[66:67], v[182:183], v[166:167], v[66:67] op_sel_hi:[1,0,1] neg_lo:[0,1,0] neg_hi:[0,1,0]
  v_pk_fma_f32 v[110:111], v[182:183], v[170:171], v[110:111] op_sel_hi:[1,0,1] neg_lo:[0,1,0] neg_hi:[0,1,0]
  v_pk_fma_f32 v[68:69], v[184:185], v[166:167], v[68:69] op_sel_hi:[1,0,1] neg_lo:[0,1,0] neg_hi:[0,1,0]
  v_pk_fma_f32 v[112:113], v[184:185], v[170:171], v[112:113] op_sel_hi:[1,0,1] neg_lo:[0,1,0] neg_hi:[0,1,0]
  v_pk_mul_f32 v[66:67], v[66:67], v[168:169] op_sel_hi:[1,0]
  v_pk_mul_f32 v[110:111], v[110:111], v[172:173] op_sel_hi:[1,0]
  buffer_load_dwordx4 v27, s[28:31], s79 offen offset:3072 lds
  v_pk_mul_f32 v[68:69], v[68:69], v[168:169] op_sel_hi:[1,0]
  v_pk_mul_f32 v[112:113], v[112:113], v[172:173] op_sel_hi:[1,0]
  v_exp_f32 v66, v66
  v_exp_f32 v110, v110
  v_exp_f32 v67, v67
  v_exp_f32 v111, v111
  v_exp_f32 v68, v68
  s_add_u32 m0, s54, 16384
  s_add_u32 s79, s56, 450560
  buffer_load_dwordx4 v24, s[28:31], s79 offen lds
  v_exp_f32 v112, v112
  v_exp_f32 v69, v69
  v_exp_f32 v113, v113
  s_waitcnt lgkmcnt(2)
  v_pk_fma_f32 v[70:71], v[190:191], v[166:167], v[70:71] op_sel_hi:[1,0,1] neg_lo:[0,1,0] neg_hi:[0,1,0]
  v_pk_fma_f32 v[114:115], v[190:191], v[170:171], v[114:115] op_sel_hi:[1,0,1] neg_lo:[0,1,0] neg_hi:[0,1,0]
  v_pk_fma_f32 v[72:73], v[192:193], v[166:167], v[72:73] op_sel_hi:[1,0,1] neg_lo:[0,1,0] neg_hi:[0,1,0]
  v_pk_fma_f32 v[116:117], v[192:193], v[170:171], v[116:117] op_sel_hi:[1,0,1] neg_lo:[0,1,0] neg_hi:[0,1,0]
  buffer_load_dwordx4 v25, s[28:31], s79 offen offset:1024 lds
  v_pk_fma_f32 v[66:67], v[66:67], v[168:169], v[168:169] op_sel:[0,1,1] op_sel_hi:[1,1,1]
  v_pk_fma_f32 v[110:111], v[110:111], v[172:173], v[172:173] op_sel:[0,1,1] op_sel_hi:[1,1,1]
  v_pk_fma_f32 v[68:69], v[68:69], v[168:169], v[168:169] op_sel:[0,1,1] op_sel_hi:[1,1,1]
  v_pk_fma_f32 v[112:113], v[112:113], v[172:173], v[172:173] op_sel:[0,1,1] op_sel_hi:[1,1,1]
  v_rcp_f32 v66, v66
  v_rcp_f32 v110, v110
  v_rcp_f32 v67, v67
  buffer_load_dwordx4 v26, s[28:31], s79 offen offset:2048 lds
  v_rcp_f32 v111, v111
  v_rcp_f32 v68, v68
  v_rcp_f32 v112, v112
  v_rcp_f32 v69, v69
  v_rcp_f32 v113, v113
  v_pk_mul_f32 v[70:71], v[70:71], v[66:67]
  v_pk_mul_f32 v[114:115], v[114:115], v[110:111]
  buffer_load_dwordx4 v27, s[28:31], s79 offen offset:3072 lds
  v_pk_mul_f32 v[72:73], v[72:73], v[68:69]
  v_pk_mul_f32 v[116:117], v[116:117], v[112:113]
  v_cvt_pk_bf16_f32 v174, v70, v71
  v_cvt_pk_bf16_f32 v178, v114, v115
  v_cvt_pk_bf16_f32 v175, v72, v73
  v_cvt_pk_bf16_f32 v179, v116, v117
  ds_read_b128 v[182:185], v162 offset:640
  s_add_u32 m0, s54, 126976
  s_add_u32 s79, s56, 540672
  buffer_load_dwordx4 v24, s[28:31], s79 offen lds
  ds_read_b128 v[190:193], v162 offset:704
  s_waitcnt lgkmcnt(3)
  v_pk_fma_f32 v[74:75], v[186:187], v[166:167], v[74:75] op_sel_hi:[1,0,1] neg_lo:[0,1,0] neg_hi:[0,1,0]
  v_pk_fma_f32 v[118:119], v[186:187], v[170:171], v[118:119] op_sel_hi:[1,0,1] neg_lo:[0,1,0] neg_hi:[0,1,0]
  v_pk_fma_f32 v[76:77], v[188:189], v[166:167], v[76:77] op_sel_hi:[1,0,1] neg_lo:[0,1,0] neg_hi:[0,1,0]
  v_pk_fma_f32 v[120:121], v[188:189], v[170:171], v[120:121] op_sel_hi:[1,0,1] neg_lo:[0,1,0] neg_hi:[0,1,0]
  v_pk_mul_f32 v[74:75], v[74:75], v[168:169] op_sel_hi:[1,0]
  v_pk_mul_f32 v[118:119], v[118:119], v[172:173] op_sel_hi:[1,0]
  buffer_load_dwordx4 v25, s[28:31], s79 offen offset:1024 lds
  v_pk_mul_f32 v[76:77], v[76:77], v[168:169] op_sel_hi:[1,0]
  v_pk_mul_f32 v[120:121], v[120:121], v[172:173] op_sel_hi:[1,0]
  v_exp_f32 v74, v74
  v_exp_f32 v118, v118
  v_exp_f32 v75, v75
  v_exp_f32 v119, v119
  v_exp_f32 v76, v76
  buffer_load_dwordx4 v26, s[28:31], s79 offen offset:2048 lds
  v_exp_f32 v120, v120
  v_exp_f32 v77, v77
  v_exp_f32 v121, v121
  s_waitcnt lgkmcnt(2)
  v_pk_fma_f32 v[78:79], v[194:195], v[166:167], v[78:79] op_sel_hi:[1,0,1] neg_lo:[0,1,0] neg_hi:[0,1,0]
  v_pk_fma_f32 v[122:123], v[194:195], v[170:171], v[122:123] op_sel_hi:[1,0,1] neg_lo:[0,1,0] neg_hi:[0,1,0]
  v_pk_fma_f32 v[80:81], v[196:197], v[166:167], v[80:81] op_sel_hi:[1,0,1] neg_lo:[0,1,0] neg_hi:[0,1,0]
  v_pk_fma_f32 v[124:125], v[196:197], v[170:171], v[124:125] op_sel_hi:[1,0,1] neg_lo:[0,1,0] neg_hi:[0,1,0]
  buffer_load_dwordx4 v27, s[28:31], s79 offen offset:3072 lds
  v_pk_fma_f32 v[74:75], v[74:75], v[168:169], v[168:169] op_sel:[0,1,1] op_sel_hi:[1,1,1]
  v_pk_fma_f32 v[118:119], v[118:119], v[172:173], v[172:173] op_sel:[0,1,1] op_sel_hi:[1,1,1]
  v_pk_fma_f32 v[76:77], v[76:77], v[168:169], v[168:169] op_sel:[0,1,1] op_sel_hi:[1,1,1]
  v_pk_fma_f32 v[120:121], v[120:121], v[172:173], v[172:173] op_sel:[0,1,1] op_sel_hi:[1,1,1]
  v_rcp_f32 v74, v74
  v_rcp_f32 v118, v118
  v_rcp_f32 v75, v75
  s_add_u32 m0, s54, 143360
  s_add_u32 s79, s56, 630784
  buffer_load_dwordx4 v24, s[28:31], s79 offen lds
  v_rcp_f32 v119, v119
  v_rcp_f32 v76, v76
  v_rcp_f32 v120, v120
  v_rcp_f32 v77, v77
  v_rcp_f32 v121, v121
  v_pk_mul_f32 v[78:79], v[78:79], v[74:75]
  v_pk_mul_f32 v[122:123], v[122:123], v[118:119]
  buffer_load_dwordx4 v25, s[28:31], s79 offen offset:1024 lds
  v_pk_mul_f32 v[80:81], v[80:81], v[76:77]
  v_pk_mul_f32 v[124:125], v[124:125], v[120:121]
  v_cvt_pk_bf16_f32 v176, v78, v79
  v_cvt_pk_bf16_f32 v180, v122, v123
  v_cvt_pk_bf16_f32 v177, v80, v81
  v_cvt_pk_bf16_f32 v181, v124, v125
  s_cmp_eq_u32 s69, 0
  s_cbranch_scc1 Lsl_102
  buffer_store_dwordx4 v[174:177], v5, s[36:39], s87 offen offset:0
  buffer_store_dwordx4 v[178:181], v5, s[36:39], s88 offen offset:0
Lsb_103:
  buffer_load_dwordx4 v26, s[28:31], s79 offen offset:2048 lds
  ds_read_b128 v[186:189], v162 offset:768
  ds_read_b128 v[194:197], v162 offset:832
  s_waitcnt lgkmcnt(3)
  v_pk_fma_f32 v[82:83], v[182:183], v[166:167], v[82:83] op_sel_hi:[1,0,1] neg_lo:[0,1,0] neg_hi:[0,1,0]
  v_pk_fma_f32 v[126:127], v[182:183], v[170:171], v[126:127] op_sel_hi:[1,0,1] neg_lo:[0,1,0] neg_hi:[0,1,0]
  v_pk_fma_f32 v[84:85], v[184:185], v[166:167], v[84:85] op_sel_hi:[1,0,1] neg_lo:[0,1,0] neg_hi:[0,1,0]
  v_pk_fma_f32 v[128:129], v[184:185], v[170:171], v[128:129] op_sel_hi:[1,0,1] neg_lo:[0,1,0] neg_hi:[0,1,0]
  v_pk_mul_f32 v[82:83], v[82:83], v[168:169] op_sel_hi:[1,0]
  buffer_load_dwordx4 v27, s[28:31], s79 offen offset:3072 lds
  v_pk_mul_f32 v[126:127], v[126:127], v[172:173] op_sel_hi:[1,0]
  v_pk_mul_f32 v[84:85], v[84:85], v[168:169] op_sel_hi:[1,0]
  v_pk_mul_f32 v[128:129], v[128:129], v[172:173] op_sel_hi:[1,0]
  v_exp_f32 v82, v82
  v_exp_f32 v126, v126
  v_exp_f32 v83, v83
  v_exp_f32 v127, v127
  s_add_u32 m0, s80, 32768
  s_add_u32 s79, s44, 0
  buffer_load_dwordx4 v24, s[28:31], s79 offen lds
  v_exp_f32 v84, v84
  v_exp_f32 v128, v128
  v_exp_f32 v85, v85
  v_exp_f32 v129, v129
  s_waitcnt lgkmcnt(2)
  v_pk_fma_f32 v[86:87], v[190:191], v[166:167], v[86:87] op_sel_hi:[1,0,1] neg_lo:[0,1,0] neg_hi:[0,1,0]
  v_pk_fma_f32 v[130:131], v[190:191], v[170:171], v[130:131] op_sel_hi:[1,0,1] neg_lo:[0,1,0] neg_hi:[0,1,0]
  v_pk_fma_f32 v[88:89], v[192:193], v[166:167], v[88:89] op_sel_hi:[1,0,1] neg_lo:[0,1,0] neg_hi:[0,1,0]
  s_add_u32 m0, s80, 36864
  s_add_u32 s79, s44, 720896
  buffer_load_dwordx4 v24, s[28:31], s79 offen lds
  v_pk_fma_f32 v[132:133], v[192:193], v[170:171], v[132:133] op_sel_hi:[1,0,1] neg_lo:[0,1,0] neg_hi:[0,1,0]
  v_pk_fma_f32 v[82:83], v[82:83], v[168:169], v[168:169] op_sel:[0,1,1] op_sel_hi:[1,1,1]
  v_pk_fma_f32 v[126:127], v[126:127], v[172:173], v[172:173] op_sel:[0,1,1] op_sel_hi:[1,1,1]
  v_pk_fma_f32 v[84:85], v[84:85], v[168:169], v[168:169] op_sel:[0,1,1] op_sel_hi:[1,1,1]
  v_pk_fma_f32 v[128:129], v[128:129], v[172:173], v[172:173] op_sel:[0,1,1] op_sel_hi:[1,1,1]
  v_rcp_f32 v82, v82
  v_rcp_f32 v126, v126
  s_add_u32 m0, s80, 40960
  s_add_u32 s79, s45, 0
  buffer_load_dwordx4 v24, s[28:31], s79 offen lds
  v_rcp_f32 v83, v83
  v_rcp_f32 v127, v127
  v_rcp_f32 v84, v84
  v_rcp_f32 v128, v128
  v_rcp_f32 v85, v85
  v_rcp_f32 v129, v129
  v_pk_mul_f32 v[86:87], v[86:87], v[82:83]
  s_add_u32 m0, s80, 45056
  s_add_u32 s79, s45, 720896
  buffer_load_dwordx4 v24, s[28:31], s79 offen lds
  v_pk_mul_f32 v[130:131], v[130:131], v[126:127]
  v_pk_mul_f32 v[88:89], v[88:89], v[84:85]
  v_pk_mul_f32 v[132:133], v[132:133], v[128:129]
  v_cvt_pk_bf16_f32 v174, v86, v87
  v_cvt_pk_bf16_f32 v178, v130, v131
  v_cvt_pk_bf16_f32 v175, v88, v89
  v_cvt_pk_bf16_f32 v179, v132, v133
  s_add_u32 m0, s80, 49152
  s_add_u32 s79, s46, 0
  buffer_load_dwordx4 v24, s[28:31], s79 offen lds
  ds_read_b128 v[182:185], v162 offset:896
  ds_read_b128 v[190:193], v162 offset:960
  s_waitcnt lgkmcnt(3)
  v_pk_fma_f32 v[90:91], v[186:187], v[166:167], v[90:91] op_sel_hi:[1,0,1] neg_lo:[0,1,0] neg_hi:[0,1,0]
  v_pk_fma_f32 v[134:135], v[186:187], v[170:171], v[134:135] op_sel_hi:[1,0,1] neg_lo:[0,1,0] neg_hi:[0,1,0]
  v_pk_fma_f32 v[92:93], v[188:189], v[166:167], v[92:93] op_sel_hi:[1,0,1] neg_lo:[0,1,0] neg_hi:[0,1,0]
  v_pk_fma_f32 v[136:137], v[188:189], v[170:171], v[136:137] op_sel_hi:[1,0,1] neg_lo:[0,1,0] neg_hi:[0,1,0]
  v_pk_mul_f32 v[90:91], v[90:91], v[168:169] op_sel_hi:[1,0]
  s_add_u32 m0, s80, 53248
  s_add_u32 s79, s46, 720896
  buffer_load_dwordx4 v24, s[28:31], s79 offen lds
  v_pk_mul_f32 v[134:135], v[134:135], v[172:173] op_sel_hi:[1,0]
  v_pk_mul_f32 v[92:93], v[92:93], v[168:169] op_sel_hi:[1,0]
  v_pk_mul_f32 v[136:137], v[136:137], v[172:173] op_sel_hi:[1,0]
  v_exp_f32 v90, v90
  v_exp_f32 v134, v134
  v_exp_f32 v91, v91
  v_exp_f32 v135, v135
  v_exp_f32 v92, v92
  v_exp_f32 v136, v136
  v_exp_f32 v93, v93
  v_exp_f32 v137, v137
  s_waitcnt lgkmcnt(2)
  v_pk_fma_f32 v[94:95], v[194:195], v[166:167], v[94:95] op_sel_hi:[1,0,1] neg_lo:[0,1,0] neg_hi:[0,1,0]
  v_pk_fma_f32 v[138:139], v[194:195], v[170:171], v[138:139] op_sel_hi:[1,0,1] neg_lo:[0,1,0] neg_hi:[0,1,0]
  v_pk_fma_f32 v[96:97], v[196:197], v[166:167], v[96:97] op_sel_hi:[1,0,1] neg_lo:[0,1,0] neg_hi:[0,1,0]
  v_pk_fma_f32 v[140:141], v[196:197], v[170:171], v[140:141] op_sel_hi:[1,0,1] neg_lo:[0,1,0] neg_hi:[0,1,0]
  v_pk_fma_f32 v[90:91], v[90:91], v[168:169], v[168:169] op_sel:[0,1,1] op_sel_hi:[1,1,1]
  v_pk_fma_f32 v[134:135], v[134:135], v[172:173], v[172:173] op_sel:[0,1,1] op_sel_hi:[1,1,1]
  v_pk_fma_f32 v[92:93], v[92:93], v[168:169], v[168:169] op_sel:[0,1,1] op_sel_hi:[1,1,1]
  v_pk_fma_f32 v[136:137], v[136:137], v[172:173], v[172:173] op_sel:[0,1,1] op_sel_hi:[1,1,1]
  v_rcp_f32 v90, v90
  v_rcp_f32 v134, v134
  v_rcp_f32 v91, v91
  v_rcp_f32 v135, v135
  v_rcp_f32 v92, v92
  v_rcp_f32 v136, v136
  v_rcp_f32 v93, v93
  v_rcp_f32 v137, v137
  v_pk_mul_f32 v[94:95], v[94:95], v[90:91]
  v_pk_mul_f32 v[138:139], v[138:139], v[134:135]
  v_pk_mul_f32 v[96:97], v[96:97], v[92:93]
  v_pk_mul_f32 v[140:141], v[140:141], v[136:137]
  v_cvt_pk_bf16_f32 v176, v94, v95
  v_cvt_pk_bf16_f32 v180, v138, v139
  v_cvt_pk_bf16_f32 v177, v96, v97
  v_cvt_pk_bf16_f32 v181, v140, v141
  s_cmp_eq_u32 s69, 0
  s_cbranch_scc1 Lsl_104
  buffer_store_dwordx4 v[174:177], v5, s[36:39], s87 offen offset:1024
  buffer_store_dwordx4 v[178:181], v5, s[36:39], s88 offen offset:1024
Lsb_105:
  ds_read_b128 v[186:189], v162 offset:1024
  s_waitcnt lgkmcnt(2)
  v_pk_fma_f32 v[98:99], v[182:183], v[166:167], v[98:99] op_sel_hi:[1,0,1] neg_lo:[0,1,0] neg_hi:[0,1,0]
  v_pk_fma_f32 v[142:143], v[182:183], v[170:171], v[142:143] op_sel_hi:[1,0,1] neg_lo:[0,1,0] neg_hi:[0,1,0]
  v_pk_fma_f32 v[100:101], v[184:185], v[166:167], v[100:101] op_sel_hi:[1,0,1] neg_lo:[0,1,0] neg_hi:[0,1,0]
  v_pk_fma_f32 v[144:145], v[184:185], v[170:171], v[144:145] op_sel_hi:[1,0,1] neg_lo:[0,1,0] neg_hi:[0,1,0]
  v_pk_mul_f32 v[98:99], v[98:99], v[168:169] op_sel_hi:[1,0]
  v_pk_mul_f32 v[142:143], v[142:143], v[172:173] op_sel_hi:[1,0]
  v_pk_mul_f32 v[100:101], v[100:101], v[168:169] op_sel_hi:[1,0]
  v_pk_mul_f32 v[144:145], v[144:145], v[172:173] op_sel_hi:[1,0]
  v_exp_f32 v98, v98
  v_exp_f32 v142, v142
  v_exp_f32 v99, v99
  v_exp_f32 v143, v143
  v_exp_f32 v100, v100
  v_exp_f32 v144, v144
  v_exp_f32 v101, v101
  v_exp_f32 v145, v145
  s_waitcnt lgkmcnt(1)
  v_pk_fma_f32 v[102:103], v[190:191], v[166:167], v[102:103] op_sel_hi:[1,0,1] neg_lo:[0,1,0] neg_hi:[0,1,0]
  v_pk_fma_f32 v[146:147], v[190:191], v[170:171], v[146:147] op_sel_hi:[1,0,1] neg_lo:[0,1,0] neg_hi:[0,1,0]
  v_pk_fma_f32 v[104:105], v[192:193], v[166:167], v[104:105] op_sel_hi:[1,0,1] neg_lo:[0,1,0] neg_hi:[0,1,0]
  v_pk_fma_f32 v[148:149], v[192:193], v[170:171], v[148:149] op_sel_hi:[1,0,1] neg_lo:[0,1,0] neg_hi:[0,1,0]
  v_pk_fma_f32 v[98:99], v[98:99], v[168:169], v[168:169] op_sel:[0,1,1] op_sel_hi:[1,1,1]
  v_pk_fma_f32 v[142:143], v[142:143], v[172:173], v[172:173] op_sel:[0,1,1] op_sel_hi:[1,1,1]
  v_pk_fma_f32 v[100:101], v[100:101], v[168:169], v[168:169] op_sel:[0,1,1] op_sel_hi:[1,1,1]
  v_pk_fma_f32 v[144:145], v[144:145], v[172:173], v[172:173] op_sel:[0,1,1] op_sel_hi:[1,1,1]
  v_rcp_f32 v98, v98
  v_rcp_f32 v142, v142
  v_rcp_f32 v99, v99
  v_rcp_f32 v143, v143
  v_rcp_f32 v100, v100
  v_rcp_f32 v144, v144
  v_rcp_f32 v101, v101
  v_rcp_f32 v145, v145
  v_pk_mul_f32 v[102:103], v[102:103], v[98:99]
  v_pk_mul_f32 v[146:147], v[146:147], v[142:143]
  v_pk_mul_f32 v[104:105], v[104:105], v[100:101]
  v_pk_mul_f32 v[148:149], v[148:149], v[144:145]
  v_cvt_pk_bf16_f32 v174, v102, v103
  v_cvt_pk_bf16_f32 v178, v146, v147
  v_cvt_pk_bf16_f32 v175, v104, v105
  v_cvt_pk_bf16_f32 v179, v148, v149
  s_cmp_eq_u32 s69, 0
  s_cbranch_scc1 Lsl_106
  buffer_store_dwordx2 v[174:175], v19, s[36:39], s85 offen
  buffer_store_dwordx2 v[178:179], v19, s[36:39], s86 offen
Lsb_107:
  s_waitcnt lgkmcnt(0)
  v_pk_fma_f32 v[106:107], v[186:187], v[166:167], v[106:107] op_sel_hi:[1,0,1] neg_lo:[0,1,0] neg_hi:[0,1,0]
  v_pk_fma_f32 v[108:109], v[188:189], v[166:167], v[108:109] op_sel_hi:[1,0,1] neg_lo:[0,1,0] neg_hi:[0,1,0]
  v_pk_mul_f32 v[106:107], v[106:107], v[166:167] op_sel:[0,1] op_sel_hi:[1,1]
  v_pk_mul_f32 v[108:109], v[108:109], v[166:167] op_sel:[0,1] op_sel_hi:[1,1]
  v_pk_fma_f32 v[150:151], v[186:187], v[170:171], v[150:151] op_sel_hi:[1,0,1] neg_lo:[0,1,0] neg_hi:[0,1,0]
  v_pk_fma_f32 v[152:153], v[188:189], v[170:171], v[152:153] op_sel_hi:[1,0,1] neg_lo:[0,1,0] neg_hi:[0,1,0]
  v_pk_mul_f32 v[150:151], v[150:151], v[170:171] op_sel:[0,1] op_sel_hi:[1,1]
  v_pk_mul_f32 v[152:153], v[152:153], v[170:171] op_sel:[0,1] op_sel_hi:[1,1]
  s_nop 0
  v_permlane32_swap_b32 v106, v150
  v_permlane32_swap_b32 v107, v151
  v_permlane32_swap_b32 v108, v152
  v_permlane32_swap_b32 v109, v153
  v_mul_f32 v106, s59, v106
  v_mul_f32 v107, s59, v107
  v_mul_f32 v108, s59, v108
  v_mul_f32 v109, s59, v109
  v_exp_f32 v106, v106
  v_exp_f32 v107, v107
  v_exp_f32 v108, v108
  v_exp_f32 v109, v109
  v_pk_add_f32 v[106:107], v[106:107], 1.0 op_sel_hi:[1,0]
  v_pk_add_f32 v[108:109], v[108:109], 1.0 op_sel_hi:[1,0]
  v_rcp_f32 v106, v106
  v_rcp_f32 v107, v107
  v_rcp_f32 v108, v108
  v_rcp_f32 v109, v109
  v_pk_mul_f32 v[150:151], v[150:151], v[106:107]
  v_pk_mul_f32 v[152:153], v[152:153], v[108:109]
  v_cvt_pk_bf16_f32 v198, v150, v151
  v_cvt_pk_bf16_f32 v199, v152, v153
  s_cmp_eq_u32 s69, 0
  s_cbranch_scc1 Lsl_108
  buffer_store_dwordx2 v[198:199], v20, s[36:39], s85 offen
Lsb_109:
  s_add_u32 s4, s83, 4
  s_lshl_b32 s4, s4, 4
  s_sub_u32 s86, 256, s4
  s_add_u32 s85, s4, s68
  s_add_u32 s4, s85, s67
  v_mov_b32 v66, s4
  s_waitcnt vmcnt(0)
  s_barrier
  s_cmp_lg_u32 s66, 0
  s_cbranch_scc1 Lh_110
  s_mov_b64 exec, 1
  s_cmp_eq_u32 s69, 0
  s_cbranch_scc1 Lsl_112
  buffer_store_dword v66, v64, s[36:39], 0 offen
Lsb_113:
  s_mov_b64 exec, -1
  buffer_load_dword v67, v65, s[36:39], 0 offen sc1
  s_waitcnt vmcnt(0)
  v_subrev_u32 v68, s85, v67
  v_cmp_gt_u32 vcc, s86, v68
  s_nop 3
  s_cmp_eq_u64 vcc, exec
  s_cbranch_scc1 Lok_115
  s_mov_b32 s78, 0
Lpoll_114:
  s_add_u32 s78, s78, 1
  s_cmp_gt_u32 s78, 400000
  s_cbranch_scc1 L_exit
  buffer_load_dword v67, v65, s[36:39], 0 offen sc1
  s_waitcnt vmcnt(0)
  v_subrev_u32 v68, s85, v67
  v_cmp_gt_u32 vcc, s86, v68
  s_nop 3
  s_cmp_eq_u64 vcc, exec
  s_cbranch_scc0 Lpoll_114
Lok_115:
  s_branch Lhe_111
Lh_110:
Lhe_111:
  s_barrier
  s_lshl_b32 s4, s71, 2
  s_mul_i32 s4, s4, 45056
  s_add_u32 s85, s4, s63
  s_mul_i32 s4, s74, 22528
  s_add_u32 s85, s85, s4
  s_add_u32 s85, s85, 131072
  s_add_u32 s86, s51, s81
  s_lshl_b32 s4, s73, 1
  s_add_u32 s5, s4, s74
  s_mul_i32 s5, s5, 45056
  s_add_u32 s87, s85, s5
  s_add_u32 s4, s4, 1
  s_sub_u32 s4, s4, s74
  s_mul_i32 s5, s4, 45056
  s_add_u32 s88, s85, s5
  buffer_load_dwordx4 a[0:3], v5, s[36:39], s87 offen offset:0 sc1
  buffer_load_dwordx4 a[88:91], v5, s[36:39], s88 offen offset:0 sc1
  buffer_load_dwordx4 a[4:7], v5, s[36:39], s87 offen offset:1024 sc1
  buffer_load_dwordx4 a[92:95], v5, s[36:39], s88 offen offset:1024 sc1
  buffer_load_dwordx4 a[8:11], v5, s[36:39], s87 offen offset:2048 sc1
  buffer_load_dwordx4 a[96:99], v5, s[36:39], s88 offen offset:2048 sc1
  buffer_load_dwordx4 a[12:15], v5, s[36:39], s87 offen offset:3072 sc1
  buffer_load_dwordx4 a[100:103], v5, s[36:39], s88 offen offset:3072 sc1
  s_add_u32 s87, s87, 4096
  buffer_load_dwordx4 a[16:19], v5, s[36:39], s87 offen offset:0 sc1
  s_add_u32 s88, s88, 4096
  buffer_load_dwordx4 a[104:107], v5, s[36:39], s88 offen offset:0 sc1
  v_add_u32 v98, 65536, v32
  v_add_u32 v99, 65536, v33
  v_add_u32 v100, 65536, v34
  v_add_u32 v101, 65536, v35
  v_add_u32 v102, 131072, v32
  v_add_u32 v103, 131072, v33
  v_add_u32 v104, 131072, v34
  v_add_u32 v105, 131072, v35
  ds_read_b64_tr_b16 a[176:177], v98 offset:8192
  ds_read_b64_tr_b16 a[178:179], v98 offset:10240
  ds_read_b64_tr_b16 a[180:181], v99 offset:8192
  ds_read_b64_tr_b16 a[182:183], v99 offset:10240
  ds_read_b64_tr_b16 a[184:185], v100 offset:8192
  ds_read_b64_tr_b16 a[186:187], v100 offset:10240
  s_waitcnt vmcnt(8)
  s_waitcnt lgkmcnt(4)
  v_mfma_f32_16x16x32_bf16 v[66:69], a[176:179], a[0:3], 0
  ds_read_b64_tr_b16 a[188:189], v101 offset:8192
  buffer_load_dwordx4 a[20:23], v5, s[36:39], s87 offen offset:1024 sc1
  v_mfma_f32_16x16x32_bf16 v[82:85], a[176:179], a[88:91], 0
  ds_read_b64_tr_b16 a[190:191], v101 offset:10240
  s_waitcnt lgkmcnt(4)
  v_mfma_f32_16x16x32_bf16 v[70:73], a[180:183], a[0:3], 0
  ds_read_b64_tr_b16 a[176:177], v98 offset:16384
  v_mfma_f32_16x16x32_bf16 v[86:89], a[180:183], a[88:91], 0
  ds_read_b64_tr_b16 a[178:179], v98 offset:18432
  s_waitcnt lgkmcnt(4)
  v_mfma_f32_16x16x32_bf16 v[74:77], a[184:187], a[0:3], 0
  ds_read_b64_tr_b16 a[180:181], v99 offset:16384
  buffer_load_dwordx4 a[108:111], v5, s[36:39], s88 offen offset:1024 sc1
  v_mfma_f32_16x16x32_bf16 v[90:93], a[184:187], a[88:91], 0
  ds_read_b64_tr_b16 a[182:183], v99 offset:18432
  s_waitcnt lgkmcnt(4)
  v_mfma_f32_16x16x32_bf16 v[78:81], a[188:191], a[0:3], 0
  ds_read_b64_tr_b16 a[184:185], v100 offset:16384
  v_mfma_f32_16x16x32_bf16 v[94:97], a[188:191], a[88:91], 0
  ds_read_b64_tr_b16 a[186:187], v100 offset:18432
  s_waitcnt vmcnt(8) lgkmcnt(4)
  v_mfma_f32_16x16x32_bf16 v[66:69], a[176:179], a[4:7], v[66:69]
  ds_read_b64_tr_b16 a[188:189], v101 offset:16384
  buffer_load_dwordx4 a[24:27], v5, s[36:39], s87 offen offset:2048 sc1
  v_mfma_f32_16x16x32_bf16 v[82:85], a[176:179], a[92:95], v[82:85]
  ds_read_b64_tr_b16 a[190:191], v101 offset:18432
  s_waitcnt lgkmcnt(4)
  v_mfma_f32_16x16x32_bf16 v[70:73], a[180:183], a[4:7], v[70:73]
  ds_read_b64_tr_b16 a[176:177], v98 offset:24576
  v_mfma_f32_16x16x32_bf16 v[86:89], a[180:183], a[92:95], v[86:89]
  ds_read_b64_tr_b16 a[178:179], v98 offset:26624
  s_waitcnt lgkmcnt(4)
  v_mfma_f32_16x16x32_bf16 v[74:77], a[184:187], a[4:7], v[74:77]
  ds_read_b64_tr_b16 a[180:181], v99 offset:24576
  buffer_load_dwordx4 a[112:115], v5, s[36:39], s88 offen offset:2048 sc1
  v_mfma_f32_16x16x32_bf16 v[90:93], a[184:187], a[92:95], v[90:93]
  ds_read_b64_tr_b16 a[182:183], v99 offset:26624
  s_waitcnt lgkmcnt(4)
  v_mfma_f32_16x16x32_bf16 v[78:81], a[188:191], a[4:7], v[78:81]
  ds_read_b64_tr_b16 a[184:185], v100 offset:24576
  v_mfma_f32_16x16x32_bf16 v[94:97], a[188:191], a[92:95], v[94:97]
  ds_read_b64_tr_b16 a[186:187], v100 offset:26624
  s_waitcnt vmcnt(8) lgkmcnt(4)
  v_mfma_f32_16x16x32_bf16 v[66:69], a[176:179], a[8:11], v[66:69]
  ds_read_b64_tr_b16 a[188:189], v101 offset:24576
  buffer_load_dwordx4 a[28:31], v5, s[36:39], s87 offen offset:3072 sc1
  v_mfma_f32_16x16x32_bf16 v[82:85], a[176:179], a[96:99], v[82:85]
  ds_read_b64_tr_b16 a[190:191], v101 offset:26624
  s_waitcnt lgkmcnt(4)
  v_mfma_f32_16x16x32_bf16 v[70:73], a[180:183], a[8:11], v[70:73]
  ds_read_b64_tr_b16 a[176:177], v98 offset:32768
  v_mfma_f32_16x16x32_bf16 v[86:89], a[180:183], a[96:99], v[86:89]
  ds_read_b64_tr_b16 a[178:179], v98 offset:34816
  s_waitcnt lgkmcnt(4)
  v_mfma_f32_16x16x32_bf16 v[74:77], a[184:187], a[8:11], v[74:77]
  ds_read_b64_tr_b16 a[180:181], v99 offset:32768
  buffer_load_dwordx4 a[116:119], v5, s[36:39], s88 offen offset:3072 sc1
  v_mfma_f32_16x16x32_bf16 v[90:93], a[184:187], a[96:99], v[90:93]
  ds_read_b64_tr_b16 a[182:183], v99 offset:34816
  s_waitcnt lgkmcnt(4)
  v_mfma_f32_16x16x32_bf16 v[78:81], a[188:191], a[8:11], v[78:81]
  ds_read_b64_tr_b16 a[184:185], v100 offset:32768
  v_mfma_f32_16x16x32_bf16 v[94:97], a[188:191], a[96:99], v[94:97]
  ds_read_b64_tr_b16 a[186:187], v100 offset:34816
  s_waitcnt vmcnt(8) lgkmcnt(4)
  v_mfma_f32_16x16x32_bf16 v[66:69], a[176:179], a[12:15], v[66:69]
  ds_read_b64_tr_b16 a[188:189], v101 offset:32768
  s_add_u32 s87, s87, 4096
  buffer_load_dwordx4 a[32:35], v5, s[36:39], s87 offen offset:0 sc1
  v_mfma_f32_16x16x32_bf16 v[82:85], a[176:179], a[100:103], v[82:85]
  ds_read_b64_tr_b16 a[190:191], v101 offset:34816
  s_waitcnt lgkmcnt(4)
  v_mfma_f32_16x16x32_bf16 v[70:73], a[180:183], a[12:15], v[70:73]
  ds_read_b64_tr_b16 a[176:177], v32 offset:57344
  v_mfma_f32_16x16x32_bf16 v[86:89], a[180:183], a[100:103], v[86:89]
  ds_read_b64_tr_b16 a[178:179], v32 offset:59392
  s_waitcnt lgkmcnt(4)
  v_mfma_f32_16x16x32_bf16 v[74:77], a[184:187], a[12:15], v[74:77]
  ds_read_b64_tr_b16 a[180:181], v33 offset:57344
  s_add_u32 s88, s88, 4096
  buffer_load_dwordx4 a[120:123], v5, s[36:39], s88 offen offset:0 sc1
  v_mfma_f32_16x16x32_bf16 v[90:93], a[184:187], a[100:103], v[90:93]
  ds_read_b64_tr_b16 a[182:183], v33 offset:59392
  s_waitcnt lgkmcnt(4)
  v_mfma_f32_16x16x32_bf16 v[78:81], a[188:191], a[12:15], v[78:81]
  ds_read_b64_tr_b16 a[184:185], v34 offset:57344
  v_mfma_f32_16x16x32_bf16 v[94:97], a[188:191], a[100:103], v[94:97]
  ds_read_b64_tr_b16 a[186:187], v34 offset:59392
  s_waitcnt lgkmcnt(4)
  s_barrier
  s_waitcnt vmcnt(8)
  v_mfma_f32_16x16x32_bf16 v[66:69], a[176:179], a[16:19], v[66:69]
  ds_read_b64_tr_b16 a[188:189], v35 offset:57344
  buffer_load_dwordx4 a[36:39], v5, s[36:39], s87 offen offset:1024 sc1
  v_mfma_f32_16x16x32_bf16 v[82:85], a[176:179], a[104:107], v[82:85]
  ds_read_b64_tr_b16 a[190:191], v35 offset:59392
  s_waitcnt lgkmcnt(4)
  v_mfma_f32_16x16x32_bf16 v[70:73], a[180:183], a[16:19], v[70:73]
  ds_read_b64_tr_b16 a[176:177], v98 offset:0
  s_add_u32 m0, s80, 73728
  s_add_u32 s79, s47, 0
  buffer_load_dwordx4 v24, s[28:31], s79 offen lds
  v_mfma_f32_16x16x32_bf16 v[86:89], a[180:183], a[104:107], v[86:89]
  ds_read_b64_tr_b16 a[178:179], v98 offset:2048
  s_waitcnt lgkmcnt(4)
  v_mfma_f32_16x16x32_bf16 v[74:77], a[184:187], a[16:19], v[74:77]
  ds_read_b64_tr_b16 a[180:181], v99 offset:0
  buffer_load_dwordx4 a[124:127], v5, s[36:39], s88 offen offset:1024 sc1
  v_mfma_f32_16x16x32_bf16 v[90:93], a[184:187], a[104:107], v[90:93]
  ds_read_b64_tr_b16 a[182:183], v99 offset:2048
  s_waitcnt lgkmcnt(4)
  v_mfma_f32_16x16x32_bf16 v[78:81], a[188:191], a[16:19], v[78:81]
  ds_read_b64_tr_b16 a[184:185], v100 offset:0
  v_mfma_f32_16x16x32_bf16 v[94:97], a[188:191], a[104:107], v[94:97]
  ds_read_b64_tr_b16 a[186:187], v100 offset:2048
  s_waitcnt vmcnt(9) lgkmcnt(4)
  v_mfma_f32_16x16x32_bf16 v[66:69], a[176:179], a[20:23], v[66:69]
  ds_read_b64_tr_b16 a[188:189], v101 offset:0
  buffer_load_dwordx4 a[40:43], v5, s[36:39], s87 offen offset:2048 sc1
  v_mfma_f32_16x16x32_bf16 v[82:85], a[176:179], a[108:111], v[82:85]
  ds_read_b64_tr_b16 a[190:191], v101 offset:2048
  s_waitcnt lgkmcnt(4)
  v_mfma_f32_16x16x32_bf16 v[70:73], a[180:183], a[20:23], v[70:73]
  ds_read_b64_tr_b16 a[176:177], v98 offset:40960
  v_mfma_f32_16x16x32_bf16 v[86:89], a[180:183], a[108:111], v[86:89]
  ds_read_b64_tr_b16 a[178:179], v98 offset:43008
  s_waitcnt lgkmcnt(4)
  v_mfma_f32_16x16x32_bf16 v[74:77], a[184:187], a[20:23], v[74:77]
  ds_read_b64_tr_b16 a[180:181], v99 offset:40960
  buffer_load_dwordx4 a[128:131], v5, s[36:39], s88 offen offset:2048 sc1
  v_mfma_f32_16x16x32_bf16 v[90:93], a[184:187], a[108:111], v[90:93]
  ds_read_b64_tr_b16 a[182:183], v99 offset:43008
  s_waitcnt lgkmcnt(4)
  v_mfma_f32_16x16x32_bf16 v[78:81], a[188:191], a[20:23], v[78:81]
  ds_read_b64_tr_b16 a[184:185], v100 offset:40960
  s_add_u32 m0, s80, 77824
  s_add_u32 s79, s47, 720896
  buffer_load_dwordx4 v24, s[28:31], s79 offen lds
  v_mfma_f32_16x16x32_bf16 v[94:97], a[188:191], a[108:111], v[94:97]
  ds_read_b64_tr_b16 a[186:187], v100 offset:43008
  s_waitcnt vmcnt(10) lgkmcnt(4)
  v_mfma_f32_16x16x32_bf16 v[66:69], a[176:179], a[24:27], v[66:69]
  ds_read_b64_tr_b16 a[188:189], v101 offset:40960
  buffer_load_dwordx4 a[44:47], v5, s[36:39], s87 offen offset:3072 sc1
  v_mfma_f32_16x16x32_bf16 v[82:85], a[176:179], a[112:115], v[82:85]
  ds_read_b64_tr_b16 a[190:191], v101 offset:43008
  s_waitcnt lgkmcnt(4)
  v_mfma_f32_16x16x32_bf16 v[70:73], a[180:183], a[24:27], v[70:73]
  ds_read_b64_tr_b16 a[176:177], v98 offset:49152
  s_add_u32 m0, s80, 81920
  s_add_u32 s79, s48, 0
  buffer_load_dwordx4 v24, s[28:31], s79 offen lds
  v_mfma_f32_16x16x32_bf16 v[86:89], a[180:183], a[112:115], v[86:89]
  ds_read_b64_tr_b16 a[178:179], v98 offset:51200
  s_waitcnt lgkmcnt(4)
  v_mfma_f32_16x16x32_bf16 v[74:77], a[184:187], a[24:27], v[74:77]
  ds_read_b64_tr_b16 a[180:181], v99 offset:49152
  buffer_load_dwordx4 a[132:135], v5, s[36:39], s88 offen offset:3072 sc1
  v_mfma_f32_16x16x32_bf16 v[90:93], a[184:187], a[112:115], v[90:93]
  ds_read_b64_tr_b16 a[182:183], v99 offset:51200
  s_waitcnt lgkmcnt(4)
  v_mfma_f32_16x16x32_bf16 v[78:81], a[188:191], a[24:27], v[78:81]
  ds_read_b64_tr_b16 a[184:185], v100 offset:49152
  v_mfma_f32_16x16x32_bf16 v[94:97], a[188:191], a[112:115], v[94:97]
  ds_read_b64_tr_b16 a[186:187], v100 offset:51200
  s_waitcnt vmcnt(11) lgkmcnt(4)
  v_mfma_f32_16x16x32_bf16 v[66:69], a[176:179], a[28:31], v[66:69]
  ds_read_b64_tr_b16 a[188:189], v101 offset:49152
  s_add_u32 s87, s87, 4096
  buffer_load_dwordx4 a[48:51], v5, s[36:39], s87 offen offset:0 sc1
  v_mfma_f32_16x16x32_bf16 v[82:85], a[176:179], a[116:119], v[82:85]
  ds_read_b64_tr_b16 a[190:191], v101 offset:51200
  s_waitcnt lgkmcnt(4)
  v_mfma_f32_16x16x32_bf16 v[70:73], a[180:183], a[28:31], v[70:73]
  ds_read_b64_tr_b16 a[176:177], v32 offset:0
  v_mfma_f32_16x16x32_bf16 v[86:89], a[180:183], a[116:119], v[86:89]
  ds_read_b64_tr_b16 a[178:179], v32 offset:2048
  s_waitcnt lgkmcnt(4)
  v_mfma_f32_16x16x32_bf16 v[74:77], a[184:187], a[28:31], v[74:77]
  ds_read_b64_tr_b16 a[180:181], v33 offset:0
  s_add_u32 s88, s88, 4096
  buffer_load_dwordx4 a[136:139], v5, s[36:39], s88 offen offset:0 sc1
  v_mfma_f32_16x16x32_bf16 v[90:93], a[184:187], a[116:119], v[90:93]
  ds_read_b64_tr_b16 a[182:183], v33 offset:2048
  s_waitcnt lgkmcnt(4)
  v_mfma_f32_16x16x32_bf16 v[78:81], a[188:191], a[28:31], v[78:81]
  ds_read_b64_tr_b16 a[184:185], v34 offset:0
  s_add_u32 m0, s80, 86016
  s_add_u32 s79, s48, 720896
  buffer_load_dwordx4 v24, s[28:31], s79 offen lds
  v_mfma_f32_16x16x32_bf16 v[94:97], a[188:191], a[116:119], v[94:97]
  ds_read_b64_tr_b16 a[186:187], v34 offset:2048
  s_waitcnt vmcnt(12) lgkmcnt(4)
  v_mfma_f32_16x16x32_bf16 v[66:69], a[176:179], a[32:35], v[66:69]
  ds_read_b64_tr_b16 a[188:189], v35 offset:0
  buffer_load_dwordx4 a[52:55], v5, s[36:39], s87 offen offset:1024 sc1
  v_mfma_f32_16x16x32_bf16 v[82:85], a[176:179], a[120:123], v[82:85]
  ds_read_b64_tr_b16 a[190:191], v35 offset:2048
  s_waitcnt lgkmcnt(4)
  v_mfma_f32_16x16x32_bf16 v[70:73], a[180:183], a[32:35], v[70:73]
  ds_read_b64_tr_b16 a[176:177], v32 offset:8192
  s_add_u32 m0, s80, 90112
  s_add_u32 s79, s49, 0
  buffer_load_dwordx4 v24, s[28:31], s79 offen lds
  v_mfma_f32_16x16x32_bf16 v[86:89], a[180:183], a[120:123], v[86:89]
  ds_read_b64_tr_b16 a[178:179], v32 offset:10240
  s_waitcnt lgkmcnt(4)
  v_mfma_f32_16x16x32_bf16 v[74:77], a[184:187], a[32:35], v[74:77]
  ds_read_b64_tr_b16 a[180:181], v33 offset:8192
  buffer_load_dwordx4 a[140:143], v5, s[36:39], s88 offen offset:1024 sc1
  v_mfma_f32_16x16x32_bf16 v[90:93], a[184:187], a[120:123], v[90:93]
  ds_read_b64_tr_b16 a[182:183], v33 offset:10240
  s_waitcnt lgkmcnt(4)
  v_mfma_f32_16x16x32_bf16 v[78:81], a[188:191], a[32:35], v[78:81]
  ds_read_b64_tr_b16 a[184:185], v34 offset:8192
  v_mfma_f32_16x16x32_bf16 v[94:97], a[188:191], a[120:123], v[94:97]
  ds_read_b64_tr_b16 a[186:187], v34 offset:10240
  s_waitcnt vmcnt(12) lgkmcnt(4)
  v_mfma_f32_16x16x32_bf16 v[66:69], a[176:179], a[36:39], v[66:69]
  ds_read_b64_tr_b16 a[188:189], v35 offset:8192
  buffer_load_dwordx4 a[56:59], v5, s[36:39], s87 offen offset:2048 sc1
  v_mfma_f32_16x16x32_bf16 v[82:85], a[176:179], a[124:127], v[82:85]
  ds_read_b64_tr_b16 a[190:191], v35 offset:10240
  s_waitcnt lgkmcnt(4)
  v_mfma_f32_16x16x32_bf16 v[70:73], a[180:183], a[36:39], v[70:73]
  ds_read_b64_tr_b16 a[176:177], v32 offset:16384
  v_mfma_f32_16x16x32_bf16 v[86:89], a[180:183], a[124:127], v[86:89]
  ds_read_b64_tr_b16 a[178:179], v32 offset:18432
  s_waitcnt lgkmcnt(4)
  v_mfma_f32_16x16x32_bf16 v[74:77], a[184:187], a[36:39], v[74:77]
  ds_read_b64_tr_b16 a[180:181], v33 offset:16384
  buffer_load_dwordx4 a[144:147], v5, s[36:39], s88 offen offset:2048 sc1
  v_mfma_f32_16x16x32_bf16 v[90:93], a[184:187], a[124:127], v[90:93]
  ds_read_b64_tr_b16 a[182:183], v33 offset:18432
  s_waitcnt lgkmcnt(4)
  v_mfma_f32_16x16x32_bf16 v[78:81], a[188:191], a[36:39], v[78:81]
  ds_read_b64_tr_b16 a[184:185], v34 offset:16384
  s_add_u32 m0, s80, 94208
  s_add_u32 s79, s49, 720896
  buffer_load_dwordx4 v24, s[28:31], s79 offen lds
  v_mfma_f32_16x16x32_bf16 v[94:97], a[188:191], a[124:127], v[94:97]
  ds_read_b64_tr_b16 a[186:187], v34 offset:18432
  s_waitcnt vmcnt(13) lgkmcnt(4)
  v_mfma_f32_16x16x32_bf16 v[66:69], a[176:179], a[40:43], v[66:69]
  ds_read_b64_tr_b16 a[188:189], v35 offset:16384
  buffer_load_dwordx4 a[60:63], v5, s[36:39], s87 offen offset:3072 sc1
  v_mfma_f32_16x16x32_bf16 v[82:85], a[176:179], a[128:131], v[82:85]
  ds_read_b64_tr_b16 a[190:191], v35 offset:18432
  s_waitcnt lgkmcnt(4)
  v_mfma_f32_16x16x32_bf16 v[70:73], a[180:183], a[40:43], v[70:73]
  ds_read_b64_tr_b16 a[176:177], v32 offset:24576
  v_mfma_f32_16x16x32_bf16 v[86:89], a[180:183], a[128:131], v[86:89]
  ds_read_b64_tr_b16 a[178:179], v32 offset:26624
  s_waitcnt lgkmcnt(4)
  v_mfma_f32_16x16x32_bf16 v[74:77], a[184:187], a[40:43], v[74:77]
  ds_read_b64_tr_b16 a[180:181], v33 offset:24576
  buffer_load_dwordx4 a[148:151], v5, s[36:39], s88 offen offset:3072 sc1
  v_mfma_f32_16x16x32_bf16 v[90:93], a[184:187], a[128:131], v[90:93]
  ds_read_b64_tr_b16 a[182:183], v33 offset:26624
  s_waitcnt lgkmcnt(4)
  v_mfma_f32_16x16x32_bf16 v[78:81], a[188:191], a[40:43], v[78:81]
  ds_read_b64_tr_b16 a[184:185], v34 offset:24576
  v_mfma_f32_16x16x32_bf16 v[94:97], a[188:191], a[128:131], v[94:97]
  ds_read_b64_tr_b16 a[186:187], v34 offset:26624
  s_waitcnt vmcnt(11) lgkmcnt(4)
  v_mfma_f32_16x16x32_bf16 v[66:69], a[176:179], a[44:47], v[66:69]
  ds_read_b64_tr_b16 a[188:189], v35 offset:24576
  s_add_u32 s87, s87, 4096
  buffer_load_dwordx4 a[64:67], v5, s[36:39], s87 offen offset:0 sc1
  v_mfma_f32_16x16x32_bf16 v[82:85], a[176:179], a[132:135], v[82:85]
  ds_read_b64_tr_b16 a[190:191], v35 offset:26624
  s_waitcnt lgkmcnt(4)
  v_mfma_f32_16x16x32_bf16 v[70:73], a[180:183], a[44:47], v[70:73]
  ds_read_b64_tr_b16 a[176:177], v98 offset:61440
  v_mfma_f32_16x16x32_bf16 v[86:89], a[180:183], a[132:135], v[86:89]
  ds_read_b64_tr_b16 a[178:179], v98 offset:63488
  s_waitcnt lgkmcnt(4)
  v_mfma_f32_16x16x32_bf16 v[74:77], a[184:187], a[44:47], v[74:77]
  ds_read_b64_tr_b16 a[180:181], v99 offset:61440
  s_add_u32 s88, s88, 4096
  buffer_load_dwordx4 a[152:155], v5, s[36:39], s88 offen offset:0 sc1
  v_mfma_f32_16x16x32_bf16 v[90:93], a[184:187], a[132:135], v[90:93]
  ds_read_b64_tr_b16 a[182:183], v99 offset:63488
  s_waitcnt lgkmcnt(4)
  v_mfma_f32_16x16x32_bf16 v[78:81], a[188:191], a[44:47], v[78:81]
  ds_read_b64_tr_b16 a[184:185], v100 offset:61440
  v_mfma_f32_16x16x32_bf16 v[94:97], a[188:191], a[132:135], v[94:97]
  ds_read_b64_tr_b16 a[186:187], v100 offset:63488
  s_waitcnt vmcnt(11) lgkmcnt(4)
  v_mfma_f32_16x16x32_bf16 v[66:69], a[176:179], a[48:51], v[66:69]
  ds_read_b64_tr_b16 a[188:189], v101 offset:61440
  buffer_load_dwordx4 a[68:71], v5, s[36:39], s87 offen offset:1024 sc1
  v_mfma_f32_16x16x32_bf16 v[82:85], a[176:179], a[136:139], v[82:85]
  ds_read_b64_tr_b16 a[190:191], v101 offset:63488
  s_waitcnt lgkmcnt(4)
  v_mfma_f32_16x16x32_bf16 v[70:73], a[180:183], a[48:51], v[70:73]
  ds_read_b64_tr_b16 a[176:177], v102 offset:4096
  v_mfma_f32_16x16x32_bf16 v[86:89], a[180:183], a[136:139], v[86:89]
  ds_read_b64_tr_b16 a[178:179], v102 offset:6144
  s_waitcnt lgkmcnt(4)
  v_mfma_f32_16x16x32_bf16 v[74:77], a[184:187], a[48:51], v[74:77]
  ds_read_b64_tr_b16 a[180:181], v103 offset:4096
  buffer_load_dwordx4 a[156:159], v5, s[36:39], s88 offen offset:1024 sc1
  v_mfma_f32_16x16x32_bf16 v[90:93], a[184:187], a[136:139], v[90:93]
  ds_read_b64_tr_b16 a[182:183], v103 offset:6144
  s_waitcnt lgkmcnt(4)
  v_mfma_f32_16x16x32_bf16 v[78:81], a[188:191], a[48:51], v[78:81]
  ds_read_b64_tr_b16 a[184:185], v104 offset:4096
  v_mfma_f32_16x16x32_bf16 v[94:97], a[188:191], a[136:139], v[94:97]
  ds_read_b64_tr_b16 a[186:187], v104 offset:6144
  s_waitcnt vmcnt(9) lgkmcnt(4)
  v_mfma_f32_16x16x32_bf16 v[66:69], a[176:179], a[52:55], v[66:69]
  ds_read_b64_tr_b16 a[188:189], v105 offset:4096
  buffer_load_dwordx4 a[72:75], v5, s[36:39], s87 offen offset:2048 sc1
  v_mfma_f32_16x16x32_bf16 v[82:85], a[176:179], a[140:143], v[82:85]
  ds_read_b64_tr_b16 a[190:191], v105 offset:6144
  s_waitcnt lgkmcnt(4)
  v_mfma_f32_16x16x32_bf16 v[70:73], a[180:183], a[52:55], v[70:73]
  ds_read_b64_tr_b16 a[176:177], v102 offset:12288
  v_mfma_f32_16x16x32_bf16 v[86:89], a[180:183], a[140:143], v[86:89]
  ds_read_b64_tr_b16 a[178:179], v102 offset:14336
  s_waitcnt lgkmcnt(4)
  v_mfma_f32_16x16x32_bf16 v[74:77], a[184:187], a[52:55], v[74:77]
  ds_read_b64_tr_b16 a[180:181], v103 offset:12288
  buffer_load_dwordx4 a[160:163], v5, s[36:39], s88 offen offset:2048 sc1
  v_mfma_f32_16x16x32_bf16 v[90:93], a[184:187], a[140:143], v[90:93]
  ds_read_b64_tr_b16 a[182:183], v103 offset:14336
  s_waitcnt lgkmcnt(4)
  v_mfma_f32_16x16x32_bf16 v[78:81], a[188:191], a[52:55], v[78:81]
  ds_read_b64_tr_b16 a[184:185], v104 offset:12288
  v_mfma_f32_16x16x32_bf16 v[94:97], a[188:191], a[140:143], v[94:97]
  ds_read_b64_tr_b16 a[186:187], v104 offset:14336
  s_waitcnt lgkmcnt(4)
  s_barrier
  s_waitcnt vmcnt(9)
  v_mfma_f32_16x16x32_bf16 v[66:69], a[176:179], a[56:59], v[66:69]
  ds_read_b64_tr_b16 a[188:189], v105 offset:12288
  buffer_load_dwordx4 a[76:79], v5, s[36:39], s87 offen offset:3072 sc1
  v_mfma_f32_16x16x32_bf16 v[82:85], a[176:179], a[144:147], v[82:85]
  ds_read_b64_tr_b16 a[190:191], v105 offset:14336
  s_waitcnt lgkmcnt(4)
  v_mfma_f32_16x16x32_bf16 v[70:73], a[180:183], a[56:59], v[70:73]
  ds_read_b64_tr_b16 a[176:177], v102 offset:20480
  v_mfma_f32_16x16x32_bf16 v[86:89], a[180:183], a[144:147], v[86:89]
  ds_read_b64_tr_b16 a[178:179], v102 offset:22528
  s_waitcnt lgkmcnt(4)
  v_mfma_f32_16x16x32_bf16 v[74:77], a[184:187], a[56:59], v[74:77]
  ds_read_b64_tr_b16 a[180:181], v103 offset:20480
  buffer_load_dwordx4 a[164:167], v5, s[36:39], s88 offen offset:3072 sc1
  v_mfma_f32_16x16x32_bf16 v[90:93], a[184:187], a[144:147], v[90:93]
  ds_read_b64_tr_b16 a[182:183], v103 offset:22528
  s_waitcnt lgkmcnt(4)
  v_mfma_f32_16x16x32_bf16 v[78:81], a[188:191], a[56:59], v[78:81]
  ds_read_b64_tr_b16 a[184:185], v104 offset:20480
  v_mfma_f32_16x16x32_bf16 v[94:97], a[188:191], a[144:147], v[94:97]
  ds_read_b64_tr_b16 a[186:187], v104 offset:22528
  s_waitcnt vmcnt(8) lgkmcnt(4)
  v_mfma_f32_16x16x32_bf16 v[66:69], a[176:179], a[60:63], v[66:69]
  ds_read_b64_tr_b16 a[188:189], v105 offset:20480
  s_add_u32 s87, s87, 4096
  buffer_load_dwordx4 a[80:83], v5, s[36:39], s87 offen offset:0 sc1
  v_mfma_f32_16x16x32_bf16 v[82:85], a[176:179], a[148:151], v[82:85]
  ds_read_b64_tr_b16 a[190:191], v105 offset:22528
  s_waitcnt lgkmcnt(4)
  v_mfma_f32_16x16x32_bf16 v[70:73], a[180:183], a[60:63], v[70:73]
  ds_read_b64_tr_b16 a[176:177], v32 offset:32768
  v_mfma_f32_16x16x32_bf16 v[86:89], a[180:183], a[148:151], v[86:89]
  ds_read_b64_tr_b16 a[178:179], v32 offset:34816
  s_waitcnt lgkmcnt(4)
  v_mfma_f32_16x16x32_bf16 v[74:77], a[184:187], a[60:63], v[74:77]
  ds_read_b64_tr_b16 a[180:181], v33 offset:32768
  s_add_u32 s88, s88, 4096
  buffer_load_dwordx4 a[168:171], v5, s[36:39], s88 offen offset:0 sc1
  v_mfma_f32_16x16x32_bf16 v[90:93], a[184:187], a[148:151], v[90:93]
  ds_read_b64_tr_b16 a[182:183], v33 offset:34816
  s_waitcnt lgkmcnt(4)
  v_mfma_f32_16x16x32_bf16 v[78:81], a[188:191], a[60:63], v[78:81]
  ds_read_b64_tr_b16 a[184:185], v34 offset:32768
  v_mfma_f32_16x16x32_bf16 v[94:97], a[188:191], a[148:151], v[94:97]
  ds_read_b64_tr_b16 a[186:187], v34 offset:34816
  s_waitcnt vmcnt(8) lgkmcnt(4)
  v_mfma_f32_16x16x32_bf16 v[66:69], a[176:179], a[64:67], v[66:69]
  ds_read_b64_tr_b16 a[188:189], v35 offset:32768
  buffer_load_dwordx4 a[84:87], v5, s[36:39], s87 offen offset:1024 sc1
  v_mfma_f32_16x16x32_bf16 v[82:85], a[176:179], a[152:155], v[82:85]
  ds_read_b64_tr_b16 a[190:191], v35 offset:34816
  s_waitcnt lgkmcnt(4)
  v_mfma_f32_16x16x32_bf16 v[70:73], a[180:183], a[64:67], v[70:73]
  ds_read_b64_tr_b16 a[176:177], v32 offset:40960
  v_mfma_f32_16x16x32_bf16 v[86:89], a[180:183], a[152:155], v[86:89]
  ds_read_b64_tr_b16 a[178:179], v32 offset:43008
  s_waitcnt lgkmcnt(4)
  v_mfma_f32_16x16x32_bf16 v[74:77], a[184:187], a[64:67], v[74:77]
  ds_read_b64_tr_b16 a[180:181], v33 offset:40960
  buffer_load_dwordx4 a[172:175], v5, s[36:39], s88 offen offset:1024 sc1
  v_mfma_f32_16x16x32_bf16 v[90:93], a[184:187], a[152:155], v[90:93]
  ds_read_b64_tr_b16 a[182:183], v33 offset:43008
  s_waitcnt lgkmcnt(4)
  v_mfma_f32_16x16x32_bf16 v[78:81], a[188:191], a[64:67], v[78:81]
  ds_read_b64_tr_b16 a[184:185], v34 offset:40960
  v_mfma_f32_16x16x32_bf16 v[94:97], a[188:191], a[152:155], v[94:97]
  ds_read_b64_tr_b16 a[186:187], v34 offset:43008
  s_waitcnt lgkmcnt(4)
  s_barrier
  s_waitcnt vmcnt(8)
  v_mfma_f32_16x16x32_bf16 v[66:69], a[176:179], a[68:71], v[66:69]
  ds_read_b64_tr_b16 a[188:189], v35 offset:40960
  v_mfma_f32_16x16x32_bf16 v[82:85], a[176:179], a[156:159], v[82:85]
  ds_read_b64_tr_b16 a[190:191], v35 offset:43008
  s_waitcnt lgkmcnt(4)
  v_mfma_f32_16x16x32_bf16 v[70:73], a[180:183], a[68:71], v[70:73]
  ds_read_b64_tr_b16 a[176:177], v32 offset:49152
  s_cmp_lg_u32 s70, 0
  s_cbranch_scc1 Li_116
  s_add_u32 m0, s81, 0
  s_add_u32 s79, s86, 0
  buffer_load_dwordx4 v5, s[36:39], s79 offen sc1 lds
Li_116:
  v_mfma_f32_16x16x32_bf16 v[86:89], a[180:183], a[156:159], v[86:89]
  ds_read_b64_tr_b16 a[178:179], v32 offset:51200
  s_waitcnt lgkmcnt(4)
  v_mfma_f32_16x16x32_bf16 v[74:77], a[184:187], a[68:71], v[74:77]
  ds_read_b64_tr_b16 a[180:181], v33 offset:49152
  v_mfma_f32_16x16x32_bf16 v[90:93], a[184:187], a[156:159], v[90:93]
  ds_read_b64_tr_b16 a[182:183], v33 offset:51200
  s_waitcnt lgkmcnt(4)
  v_mfma_f32_16x16x32_bf16 v[78:81], a[188:191], a[68:71], v[78:81]
  ds_read_b64_tr_b16 a[184:185], v34 offset:49152
  s_cmp_lg_u32 s70, 0
  s_cbranch_scc1 Li_117
  buffer_load_dwordx4 v5, s[36:39], s79 offen offset:1024 sc1 lds
Li_117:
  v_mfma_f32_16x16x32_bf16 v[94:97], a[188:191], a[156:159], v[94:97]
  ds_read_b64_tr_b16 a[186:187], v34 offset:51200
  s_waitcnt vmcnt(6) lgkmcnt(4)
  v_mfma_f32_16x16x32_bf16 v[66:69], a[176:179], a[72:75], v[66:69]
  ds_read_b64_tr_b16 a[188:189], v35 offset:49152
  v_mfma_f32_16x16x32_bf16 v[82:85], a[176:179], a[160:163], v[82:85]
  ds_read_b64_tr_b16 a[190:191], v35 offset:51200
  s_waitcnt lgkmcnt(4)
  v_mfma_f32_16x16x32_bf16 v[70:73], a[180:183], a[72:75], v[70:73]
  ds_read_b64_tr_b16 a[176:177], v98 offset:8192
  s_cmp_lg_u32 s70, 0
  s_cbranch_scc1 Li_118
  buffer_load_dwordx4 v5, s[36:39], s79 offen offset:2048 sc1 lds
Li_118:
  v_mfma_f32_16x16x32_bf16 v[86:89], a[180:183], a[160:163], v[86:89]
  ds_read_b64_tr_b16 a[178:179], v98 offset:10240
  s_waitcnt lgkmcnt(4)
  v_mfma_f32_16x16x32_bf16 v[74:77], a[184:187], a[72:75], v[74:77]
  ds_read_b64_tr_b16 a[180:181], v99 offset:8192
  v_mfma_f32_16x16x32_bf16 v[90:93], a[184:187], a[160:163], v[90:93]
  ds_read_b64_tr_b16 a[182:183], v99 offset:10240
  s_waitcnt lgkmcnt(4)
  v_mfma_f32_16x16x32_bf16 v[78:81], a[188:191], a[72:75], v[78:81]
  ds_read_b64_tr_b16 a[184:185], v100 offset:8192
  s_cmp_lg_u32 s70, 0
  s_cbranch_scc1 Li_119
  s_add_u32 m0, s81, 12288
  s_add_u32 s79, s86, 12288
  buffer_load_dwordx4 v5, s[36:39], s79 offen sc1 lds
Li_119:
  v_mfma_f32_16x16x32_bf16 v[94:97], a[188:191], a[160:163], v[94:97]
  ds_read_b64_tr_b16 a[186:187], v100 offset:10240
  s_waitcnt vmcnt(4) lgkmcnt(4)
  v_mfma_f32_16x16x32_bf16 v[66:69], a[176:179], a[76:79], v[66:69]
  ds_read_b64_tr_b16 a[188:189], v101 offset:8192
  v_mfma_f32_16x16x32_bf16 v[82:85], a[176:179], a[164:167], v[82:85]
  ds_read_b64_tr_b16 a[190:191], v101 offset:10240
  s_waitcnt lgkmcnt(4)
  v_mfma_f32_16x16x32_bf16 v[70:73], a[180:183], a[76:79], v[70:73]
  ds_read_b64_tr_b16 a[176:177], v98 offset:16384
  s_cmp_lg_u32 s70, 0
  s_cbranch_scc1 Li_120
  buffer_load_dwordx4 v5, s[36:39], s79 offen offset:1024 sc1 lds
Li_120:
  v_mfma_f32_16x16x32_bf16 v[86:89], a[180:183], a[164:167], v[86:89]
  ds_read_b64_tr_b16 a[178:179], v98 offset:18432
  s_waitcnt lgkmcnt(4)
  v_mfma_f32_16x16x32_bf16 v[74:77], a[184:187], a[76:79], v[74:77]
  ds_read_b64_tr_b16 a[180:181], v99 offset:16384
  v_mfma_f32_16x16x32_bf16 v[90:93], a[184:187], a[164:167], v[90:93]
  ds_read_b64_tr_b16 a[182:183], v99 offset:18432
  s_waitcnt lgkmcnt(4)
  v_mfma_f32_16x16x32_bf16 v[78:81], a[188:191], a[76:79], v[78:81]
  ds_read_b64_tr_b16 a[184:185], v100 offset:16384
  s_cmp_lg_u32 s70, 0
  s_cbranch_scc1 Li_121
  buffer_load_dwordx4 v5, s[36:39], s79 offen offset:2048 sc1 lds
Li_121:
  v_mfma_f32_16x16x32_bf16 v[94:97], a[188:191], a[164:167], v[94:97]
  ds_read_b64_tr_b16 a[186:187], v100 offset:18432
  s_waitcnt vmcnt(2) lgkmcnt(4)
  v_mfma_f32_16x16x32_bf16 v[66:69], a[176:179], a[80:83], v[66:69]
  ds_read_b64_tr_b16 a[188:189], v101 offset:16384
  v_mfma_f32_16x16x32_bf16 v[82:85], a[176:179], a[168:171], v[82:85]
  ds_read_b64_tr_b16 a[190:191], v101 offset:18432
  s_waitcnt lgkmcnt(4)
  v_mfma_f32_16x16x32_bf16 v[70:73], a[180:183], a[80:83], v[70:73]
  ds_read_b64_tr_b16 a[176:177], v98 offset:24576
  s_cmp_lg_u32 s70, 0
  s_cbranch_scc1 Li_122
  s_add_u32 m0, s81, 61440
  s_add_u32 s79, s86, 61440
  buffer_load_dwordx4 v5, s[36:39], s79 offen sc1 lds
Li_122:
  v_mfma_f32_16x16x32_bf16 v[86:89], a[180:183], a[168:171], v[86:89]
  ds_read_b64_tr_b16 a[178:179], v98 offset:26624
  s_waitcnt lgkmcnt(4)
  v_mfma_f32_16x16x32_bf16 v[74:77], a[184:187], a[80:83], v[74:77]
  ds_read_b64_tr_b16 a[180:181], v99 offset:24576
  v_mfma_f32_16x16x32_bf16 v[90:93], a[184:187], a[168:171], v[90:93]
  ds_read_b64_tr_b16 a[182:183], v99 offset:26624
  s_waitcnt lgkmcnt(4)
  v_mfma_f32_16x16x32_bf16 v[78:81], a[188:191], a[80:83], v[78:81]
  ds_read_b64_tr_b16 a[184:185], v100 offset:24576
  s_cmp_lg_u32 s70, 0
  s_cbranch_scc1 Li_123
  buffer_load_dwordx4 v5, s[36:39], s79 offen offset:1024 sc1 lds
Li_123:
  v_mfma_f32_16x16x32_bf16 v[94:97], a[188:191], a[168:171], v[94:97]
  ds_read_b64_tr_b16 a[186:187], v100 offset:26624
  s_waitcnt vmcnt(0) lgkmcnt(4)
  v_mfma_f32_16x16x32_bf16 v[66:69], a[176:179], a[84:87], v[66:69]
  ds_read_b64_tr_b16 a[188:189], v101 offset:24576
  v_mfma_f32_16x16x32_bf16 v[82:85], a[176:179], a[172:175], v[82:85]
  ds_read_b64_tr_b16 a[190:191], v101 offset:26624
  s_waitcnt lgkmcnt(4)
  v_mfma_f32_16x16x32_bf16 v[70:73], a[180:183], a[84:87], v[70:73]
  s_cmp_lg_u32 s70, 0
  s_cbranch_scc1 Li_124
  buffer_load_dwordx4 v5, s[36:39], s79 offen offset:2048 sc1 lds
Li_124:
  v_mfma_f32_16x16x32_bf16 v[86:89], a[180:183], a[172:175], v[86:89]
  s_waitcnt lgkmcnt(2)
  v_mfma_f32_16x16x32_bf16 v[74:77], a[184:187], a[84:87], v[74:77]
  v_mfma_f32_16x16x32_bf16 v[90:93], a[184:187], a[172:175], v[90:93]
  s_waitcnt lgkmcnt(0)
  v_mfma_f32_16x16x32_bf16 v[78:81], a[188:191], a[84:87], v[78:81]
  v_mfma_f32_16x16x32_bf16 v[94:97], a[188:191], a[172:175], v[94:97]
  s_add_u32 s4, s82, 106496
  v_add_u32 v98, s4, v5
  ds_write_b128 v98, v[82:85] offset:0
  ds_write_b128 v98, v[86:89] offset:1024
  s_nop 0
  ds_write_b128 v98, v[90:93] offset:2048
  s_nop 1
  ds_write_b128 v98, v[94:97] offset:3072
  s_xor_b32 s4, s82, 4096
  s_add_u32 s4, s4, 106496
  v_add_u32 v99, s4, v5
  v_pk_add_f32 v[66:67], v[66:67], v[48:49]
  v_pk_add_f32 v[68:69], v[68:69], v[50:51]
  v_pk_add_f32 v[70:71], v[70:71], v[52:53]
  v_pk_add_f32 v[72:73], v[72:73], v[54:55]
  v_pk_add_f32 v[74:75], v[74:75], v[56:57]
  v_pk_add_f32 v[76:77], v[76:77], v[58:59]
  v_pk_add_f32 v[78:79], v[78:79], v[60:61]
  v_pk_add_f32 v[80:81], v[80:81], v[62:63]
  s_waitcnt lgkmcnt(0)
  s_barrier
  ds_read_b128 v[82:85], v99 offset:0
  ds_read_b128 v[86:89], v99 offset:1024
  ds_read_b128 v[90:93], v99 offset:2048
  ds_read_b128 v[94:97], v99 offset:3072
  s_waitcnt lgkmcnt(3)
  v_pk_add_f32 v[66:67], v[66:67], v[82:83]
  v_pk_add_f32 v[68:69], v[68:69], v[84:85]
  v_cvt_pk_bf16_f32 v100, v66, v67
  v_cvt_pk_bf16_f32 v101, v68, v69
  s_waitcnt lgkmcnt(2)
  v_pk_add_f32 v[70:71], v[70:71], v[86:87]
  v_pk_add_f32 v[72:73], v[72:73], v[88:89]
  v_cvt_pk_bf16_f32 v102, v70, v71
  v_cvt_pk_bf16_f32 v103, v72, v73
  s_waitcnt lgkmcnt(1)
  v_pk_add_f32 v[74:75], v[74:75], v[90:91]
  v_pk_add_f32 v[76:77], v[76:77], v[92:93]
  v_cvt_pk_bf16_f32 v104, v74, v75
  v_cvt_pk_bf16_f32 v105, v76, v77
  s_waitcnt lgkmcnt(0)
  v_pk_add_f32 v[78:79], v[78:79], v[94:95]
  v_pk_add_f32 v[80:81], v[80:81], v[96:97]
  v_cvt_pk_bf16_f32 v106, v78, v79
  v_cvt_pk_bf16_f32 v107, v80, v81
  s_cmp_eq_u32 s70, 1
  s_cbranch_scc1 Lout_125
  s_cmp_eq_u32 s69, 0
  s_cbranch_scc1 Lsl_126
  buffer_store_dwordx4 v[100:103], v5, s[36:39], s61 offen
  buffer_store_dwordx4 v[104:107], v5, s[36:39], s61 offen offset:1024
Lsb_127:
  v_dot2_f32_bf16 v66, v100, v6, v10
  v_dot2_f32_bf16 v67, v100, v100, v10
  v_dot2_f32_bf16 v68, v104, v6, v10
  v_dot2_f32_bf16 v69, v104, v104, v10
  v_dot2_f32_bf16 v66, v101, v6, v66
  v_dot2_f32_bf16 v67, v101, v101, v67
  v_dot2_f32_bf16 v68, v105, v6, v68
  v_dot2_f32_bf16 v69, v105, v105, v69
  v_dot2_f32_bf16 v66, v102, v6, v66
  v_dot2_f32_bf16 v67, v102, v102, v67
  v_dot2_f32_bf16 v68, v106, v6, v68
  v_dot2_f32_bf16 v69, v106, v106, v69
  v_dot2_f32_bf16 v66, v103, v6, v66
  v_dot2_f32_bf16 v67, v103, v103, v67
  v_dot2_f32_bf16 v68, v107, v6, v68
  v_dot2_f32_bf16 v69, v107, v107, v69
  s_nop 1
  v_add_f32 v66, v66, v68
  v_add_f32 v67, v67, v69
  s_nop 1
  v_permlane32_swap_b32 v66, v67
  v_add_f32 v66, v66, v67
  v_mov_b32 v67, v66
  s_nop 1
  v_permlane16_swap_b32 v66, v67
  v_add_f32 v70, v66, v67
  s_cmp_eq_u32 s69, 0
  s_cbranch_scc1 Lsl_128
  buffer_store_dword v70, v14, s[36:39], s62 offen
Lsb_129:
  s_cmp_lg_u32 s77, 8
  s_cbranch_scc1 Li_130
  s_cmp_ge_u32 s64, 15
  s_cbranch_scc1 Li_131
  s_add_u32 s4, s76, 3424256
  s_lshl_b32 s5, s72, 11
  s_add_u32 s3, s4, s5
  buffer_store_dwordx4 v[100:103], v5, s[36:39], s3 offen sc0 sc1
  buffer_store_dwordx4 v[104:107], v5, s[36:39], s3 offen offset:1024 sc0 sc1
  s_add_u32 s4, s76, 3449856
  s_lshl_b32 s5, s72, 7
  s_add_u32 s3, s4, s5
  buffer_store_dword v70, v14, s[36:39], s3 offen sc0 sc1
Li_131:
Li_130:
  s_add_u32 s4, s83, 5
  s_lshl_b32 s4, s4, 4
  s_sub_u32 s86, 256, s4
  s_add_u32 s85, s4, s68
  s_add_u32 s4, s85, s67
  v_mov_b32 v66, s4
  s_waitcnt vmcnt(0)
  s_barrier
  s_cmp_lg_u32 s66, 0
  s_cbranch_scc1 Lh_132
  s_mov_b64 exec, 1
  s_cmp_eq_u32 s69, 0
  s_cbranch_scc1 Lsl_134
  buffer_store_dword v66, v64, s[36:39], 0 offen
Lsb_135:
  s_mov_b64 exec, -1
  buffer_load_dword v67, v65, s[36:39], 0 offen sc1
  v_lshlrev_b32 v48, 16, v100
  v_and_b32 v49, 4294901760, v100
  v_lshlrev_b32 v50, 16, v101
  v_and_b32 v51, 4294901760, v101
  v_lshlrev_b32 v52, 16, v102
  v_and_b32 v53, 4294901760, v102
  v_lshlrev_b32 v54, 16, v103
  v_and_b32 v55, 4294901760, v103
  v_lshlrev_b32 v56, 16, v104
  v_and_b32 v57, 4294901760, v104
  v_lshlrev_b32 v58, 16, v105
  v_and_b32 v59, 4294901760, v105
  v_lshlrev_b32 v60, 16, v106
  v_and_b32 v61, 4294901760, v106
  v_lshlrev_b32 v62, 16, v107
  v_and_b32 v63, 4294901760, v107
  s_waitcnt vmcnt(0)
  v_subrev_u32 v68, s85, v67
  v_cmp_gt_u32 vcc, s86, v68
  s_nop 3
  s_cmp_eq_u64 vcc, exec
  s_cbranch_scc1 Lok_137
  s_mov_b32 s78, 0
Lpoll_136:
  s_add_u32 s78, s78, 1
  s_cmp_gt_u32 s78, 400000
  s_cbranch_scc1 L_exit
  buffer_load_dword v67, v65, s[36:39], 0 offen sc1
  s_waitcnt vmcnt(0)
  v_subrev_u32 v68, s85, v67
  v_cmp_gt_u32 vcc, s86, v68
  s_nop 3
  s_cmp_eq_u64 vcc, exec
  s_cbranch_scc0 Lpoll_136
Lok_137:
  s_branch Lhe_133
Lh_132:
  s_cmp_lg_u32 s66, 1
  s_cbranch_scc1 Lw_138
  s_cmp_lg_u32 s71, 1
  s_cbranch_scc1 Li_139
  s_cmp_ge_u32 s64, 15
  s_cbranch_scc1 Li_140
  s_add_u32 s87, s64, 1
  s_lshl_b32 s88, s87, 8
  s_lshl_b32 s5, s72, 2
  s_add_u32 s88, s88, s5
  s_add_u32 s88, s88, 16384
  v_mov_b32 v68, s88
  s_add_u32 s4, s68, 80
  s_add_u32 s4, s4, s67
  v_mov_b32 v69, s4
  s_mov_b64 exec, 1
  buffer_store_dword v69, v68, s[36:39], 0 offen sc0 sc1
  s_mov_b64 exec, -1
Li_140:
Li_139:
Lw_138:
  s_cmp_lg_u32 s66, 1
  s_cbranch_scc1 Lw_142
  s_mov_b32 m0, 24576
  s_add_u32 s79, s51, 24576
  buffer_load_dwordx4 v5, s[36:39], s79 offen sc1 lds
  buffer_load_dwordx4 v5, s[36:39], s79 offen offset:1024 sc1 lds
  buffer_load_dwordx4 v5, s[36:39], s79 offen offset:2048 sc1 lds
  buffer_load_dwordx4 v5, s[36:39], s79 offen offset:3072 sc1 lds
  s_mov_b32 m0, 36864
  s_add_u32 s79, s51, 36864
  buffer_load_dwordx4 v5, s[36:39], s79 offen sc1 lds
  buffer_load_dwordx4 v5, s[36:39], s79 offen offset:1024 sc1 lds
  buffer_load_dwordx4 v5, s[36:39], s79 offen offset:2048 sc1 lds
  buffer_load_dwordx4 v5, s[36:39], s79 offen offset:3072 sc1 lds
  s_mov_b32 m0, 49152
  s_add_u32 s79, s51, 49152
  buffer_load_dwordx4 v5, s[36:39], s79 offen sc1 lds
  buffer_load_dwordx4 v5, s[36:39], s79 offen offset:1024 sc1 lds
  buffer_load_dwordx4 v5, s[36:39], s79 offen offset:2048 sc1 lds
  buffer_load_dwordx4 v5, s[36:39], s79 offen offset:3072 sc1 lds
  s_branch Lwe_141
Lw_142:
  s_cmp_lg_u32 s66, 2
  s_cbranch_scc1 Lw_143
  s_mov_b32 m0, 28672
  s_add_u32 s79, s51, 28672
  buffer_load_dwordx4 v5, s[36:39], s79 offen sc1 lds
  buffer_load_dwordx4 v5, s[36:39], s79 offen offset:1024 sc1 lds
  buffer_load_dwordx4 v5, s[36:39], s79 offen offset:2048 sc1 lds
  buffer_load_dwordx4 v5, s[36:39], s79 offen offset:3072 sc1 lds
  s_mov_b32 m0, 40960
  s_add_u32 s79, s51, 40960
  buffer_load_dwordx4 v5, s[36:39], s79 offen sc1 lds
  buffer_load_dwordx4 v5, s[36:39], s79 offen offset:1024 sc1 lds
  buffer_load_dwordx4 v5, s[36:39], s79 offen offset:2048 sc1 lds
  buffer_load_dwordx4 v5, s[36:39], s79 offen offset:3072 sc1 lds
  s_mov_b32 m0, 53248
  s_add_u32 s79, s51, 53248
  buffer_load_dwordx4 v5, s[36:39], s79 offen sc1 lds
  buffer_load_dwordx4 v5, s[36:39], s79 offen offset:1024 sc1 lds
  buffer_load_dwordx4 v5, s[36:39], s79 offen offset:2048 sc1 lds
  buffer_load_dwordx4 v5, s[36:39], s79 offen offset:3072 sc1 lds
  s_branch Lwe_141
Lw_143:
  s_cmp_lg_u32 s66, 3
  s_cbranch_scc1 Lw_144
  s_mov_b32 m0, 32768
  s_add_u32 s79, s51, 32768
  buffer_load_dwordx4 v5, s[36:39], s79 offen sc1 lds
  buffer_load_dwordx4 v5, s[36:39], s79 offen offset:1024 sc1 lds
  buffer_load_dwordx4 v5, s[36:39], s79 offen offset:2048 sc1 lds
  buffer_load_dwordx4 v5, s[36:39], s79 offen offset:3072 sc1 lds
  s_mov_b32 m0, 45056
  s_add_u32 s79, s51, 45056
  buffer_load_dwordx4 v5, s[36:39], s79 offen sc1 lds
  buffer_load_dwordx4 v5, s[36:39], s79 offen offset:1024 sc1 lds
  buffer_load_dwordx4 v5, s[36:39], s79 offen offset:2048 sc1 lds
  buffer_load_dwordx4 v5, s[36:39], s79 offen offset:3072 sc1 lds
  s_mov_b32 m0, 57344
  s_add_u32 s79, s51, 57344
  buffer_load_dwordx4 v5, s[36:39], s79 offen sc1 lds
  buffer_load_dwordx4 v5, s[36:39], s79 offen offset:1024 sc1 lds
  buffer_load_dwordx4 v5, s[36:39], s79 offen offset:2048 sc1 lds
  buffer_load_dwordx4 v5, s[36:39], s79 offen offset:3072 sc1 lds
Lw_144:
Lwe_141:
  v_lshlrev_b32 v48, 16, v100
  v_and_b32 v49, 4294901760, v100
  v_lshlrev_b32 v50, 16, v101
  v_and_b32 v51, 4294901760, v101
  v_lshlrev_b32 v52, 16, v102
  v_and_b32 v53, 4294901760, v102
  v_lshlrev_b32 v54, 16, v103
  v_and_b32 v55, 4294901760, v103
  v_lshlrev_b32 v56, 16, v104
  v_and_b32 v57, 4294901760, v104
  v_lshlrev_b32 v58, 16, v105
  v_and_b32 v59, 4294901760, v105
  v_lshlrev_b32 v60, 16, v106
  v_and_b32 v61, 4294901760, v106
  v_lshlrev_b32 v62, 16, v107
  v_and_b32 v63, 4294901760, v107
Lhe_133:
  s_barrier
  s_mov_b32 s70, 1
  s_branch L_layer
Lout_125:
  v_permlane16_swap_b32 v100, v102
  v_permlane16_swap_b32 v101, v103
  v_permlane16_swap_b32 v104, v106
  v_permlane16_swap_b32 v105, v107
  s_lshl_b32 s4, s64, 7
  s_lshl_b32 s5, s77, 4
  s_add_u32 s4, s4, s5
  s_sub_u32 s4, s4, 16
  v_add_u32 v66, s4, v3
  v_lshlrev_b32 v66, 10, v66
  v_and_b32 v67, 1, v4
  v_lshlrev_b32 v67, 5, v67
  v_add_u32 v66, v66, v67
  v_lshrrev_b32 v67, 1, v4
  v_lshlrev_b32 v67, 4, v67
  v_add_u32 v66, v66, v67
  s_lshl_b32 s4, s72, 7
  buffer_store_dwordx4 v[100:103], v66, s[32:35], s4 offen
  buffer_store_dwordx4 v[104:107], v66, s[32:35], s4 offen offset:64
L_fin:
L_exit:
  s_endpgm
Lnonce_10:
  s_add_u32 s78, s78, 1
  s_cmp_gt_u32 s78, 40
  s_cbranch_scc1 Lngu_13
  buffer_load_dword v102, v103, s[40:43], 0 offen sc1
  s_waitcnt vmcnt(0)
  v_readfirstlane_b32 s63, v102
  s_nop 3
  s_cmp_eq_u32 s63, 0
  s_cbranch_scc1 Lnag_12
  s_waitcnt lgkmcnt(0)
  s_memrealtime s[6:7]
  s_waitcnt lgkmcnt(0)
  s_sub_u32 s4, s6, s63
  s_add_u32 s4, s4, 200
  s_cmp_gt_u32 s4, 1900
  s_cbranch_scc0 Lnok_11
Lnag_12:
  s_branch Lnonce_10
Lngu_13:
  s_mov_b32 s63, 0
  s_branch Lnok_11
Lnonce_15:
  s_add_u32 s78, s78, 1
  s_cmp_gt_u32 s78, 400000
  s_cbranch_scc1 L_exit
  buffer_load_dword v83, v10, s[40:43], 0 offen sc1
  s_waitcnt vmcnt(0)
  v_readfirstlane_b32 s68, v83
  s_nop 3
  s_cmp_eq_u32 s68, 0
  s_cbranch_scc1 Lnag_17
  s_cmp_gt_u32 s78, 4000
  s_cbranch_scc1 Lnok_16
  s_waitcnt lgkmcnt(0)
  s_memrealtime s[6:7]
  s_waitcnt lgkmcnt(0)
  s_sub_u32 s4, s6, s68
  s_add_u32 s4, s4, 200
  s_cmp_gt_u32 s4, 1900
  s_cbranch_scc0 Lnok_16
Lnag_17:
  s_branch Lnonce_15
Lsl_64:
  buffer_store_dwordx4 v[142:145], v5, s[36:39], s85 offen sc0 sc1
  buffer_store_dwordx4 v[178:181], v5, s[36:39], s86 offen sc0 sc1
  s_branch Lsb_65
Lsl_72:
  buffer_store_dword v66, v64, s[36:39], 0 offen sc0 sc1
  s_branch Lsb_73
Lsl_86:
  buffer_store_dwordx4 v[116:119], v5, s[36:39], s61 offen sc0 sc1
  buffer_store_dwordx4 v[120:123], v5, s[36:39], s61 offen offset:1024 sc0 sc1
  s_branch Lsb_87
Lsl_88:
  buffer_store_dword v86, v14, s[36:39], s62 offen sc0 sc1
  s_branch Lsb_89
Lsl_92:
  buffer_store_dword v66, v64, s[36:39], 0 offen sc0 sc1
  s_branch Lsb_93
Lsl_102:
  buffer_store_dwordx4 v[174:177], v5, s[36:39], s87 offen offset:0 sc0 sc1
  buffer_store_dwordx4 v[178:181], v5, s[36:39], s88 offen offset:0 sc0 sc1
  s_branch Lsb_103
Lsl_104:
  buffer_store_dwordx4 v[174:177], v5, s[36:39], s87 offen offset:1024 sc0 sc1
  buffer_store_dwordx4 v[178:181], v5, s[36:39], s88 offen offset:1024 sc0 sc1
  s_branch Lsb_105
Lsl_106:
  buffer_store_dwordx2 v[174:175], v19, s[36:39], s85 offen sc0 sc1
  buffer_store_dwordx2 v[178:179], v19, s[36:39], s86 offen sc0 sc1
  s_branch Lsb_107
Lsl_108:
  buffer_store_dwordx2 v[198:199], v20, s[36:39], s85 offen sc0 sc1
  s_branch Lsb_109
Lsl_112:
  buffer_store_dword v66, v64, s[36:39], 0 offen sc0 sc1
  s_branch Lsb_113
Lsl_126:
  buffer_store_dwordx4 v[100:103], v5, s[36:39], s61 offen sc0 sc1
  buffer_store_dwordx4 v[104:107], v5, s[36:39], s61 offen offset:1024 sc0 sc1
  s_branch Lsb_127
Lsl_128:
  buffer_store_dword v70, v14, s[36:39], s62 offen sc0 sc1
  s_branch Lsb_129
Lsl_134:
  buffer_store_dword v66, v64, s[36:39], 0 offen sc0 sc1
  s_branch Lsb_135
L_codeend:
  s_endpgm
.section .rodata,"a"
.p2align 6
.amdhsa_kernel interleave_layers__sliding_local_dilated__glu_gated_glu__prompt_kernel
  .amdhsa_next_free_vgpr 512
  .amdhsa_next_free_sgpr 102
  .amdhsa_accum_offset 256
  .amdhsa_group_segment_fixed_size 0
  .amdhsa_kernarg_size 80
  .amdhsa_user_sgpr_count 2
  .amdhsa_user_sgpr_kernarg_segment_ptr 1
  .amdhsa_system_sgpr_workgroup_id_x 1
  .amdhsa_float_denorm_mode_32 3
.end_amdhsa_kernel
```
